```python
import torch

def _softmax(x, axis=-1):
    return torch.softmax(x, dim=axis)
def _gelu(x):
    return torch.nn.functional.gelu(x, approximate="tanh")
def _silu(x):
    return torch.nn.functional.silu(x)
def _sigmoid(x):
    return torch.sigmoid(x)
def _layernorm(x, axis=-1, eps=1e-5):
    m = x.mean(dim=axis, keepdim=True)
    v = x.var(dim=axis, keepdim=True, unbiased=False)
    return (x - m) / torch.sqrt(v + eps)
def _scatter_add(tgt, idx, src, axis=0):
    return tgt.clone().index_add_(axis, idx, src)
def _segment_sum(src, seg, n):
    out = torch.zeros((n,) + src.shape[1:], dtype=src.dtype)
    return out.index_add_(0, seg, src)
def _pad(x, pw):
    flat = tuple(v for pair in reversed(pw) for v in pair)
    return torch.nn.functional.pad(x, flat)

kernel_name = 'parallel_sum__linear_attn_block__mixer_s_mlp__prompt'

def setup_inputs():

    _w = (lambda a: (lambda t: t.to(torch.bfloat16) if t.is_floating_point() else t)(torch.as_tensor(a)))
    def _A_setup():
        B, S, D = 1, 2048, 512
        return {
            "x": _w((lambda *s: torch.randn(*s, dtype=torch.bfloat16) * 0.05)(B, S, D)),
            "wqkv": _w((lambda *s: torch.randn(*s, dtype=torch.bfloat16) * 0.4)(D, 3 * D)),
            "wo": _w((lambda *s: torch.randn(*s, dtype=torch.bfloat16) * 0.1)(D, D)),
        }
    _A_in = _A_setup()

    def _B_setup():
        B, S, D, F = 1, 2048, 512, 1792
        return {
            "x":  _w((lambda *s: torch.randn(*s, dtype=torch.bfloat16) * 0.05)(B, S, D)),
            "w1": _w((lambda *s: torch.randn(*s, dtype=torch.bfloat16) * 0.8)(D, D) * (D ** -0.5)),
            "w2": _w((lambda *s: torch.randn(*s, dtype=torch.bfloat16) * 0.8)(D, D) * (D ** -0.5)),
            "w3": _w((lambda *s: torch.randn(*s, dtype=torch.bfloat16) * 0.8)(D, F) * (D ** -0.5)),
            "w4": _w((lambda *s: torch.randn(*s, dtype=torch.bfloat16) * 0.8)(F, D) * (F ** -0.5)),
        }
    _B_in = _B_setup()

    return {
        "A_x": _A_in["x"],
        "A_wqkv": _A_in["wqkv"],
        "A_wo": _A_in["wo"],
        "B_x": _B_in["x"],
        "B_w1": _B_in["w1"],
        "B_w2": _B_in["w2"],
        "B_w3": _B_in["w3"],
        "B_w4": _B_in["w4"],
    }

def reference(A_x, A_wqkv, A_wo, B_x, B_w1, B_w2, B_w3, B_w4):
    def _A_ref(x, wqkv, wo):
        B, S, D = x.shape
        H = 32; Dh = D // H
        qkv = (lambda x, *d: x.permute(*d))((x @ wqkv).reshape(B, S, 3, H, Dh), 2, 0, 3, 1, 4)
        q, k, v = qkv[0], qkv[1], qkv[2]
        phi = lambda t: torch.where(t > 0, t + 1, torch.exp(t)) + 1e-6
        pq, pk = phi(q), phi(k)
        kv = torch.einsum("bhsd,bhse->bhde", pk, v)
        z = torch.einsum("bhsd->bhd", pk)
        num = torch.einsum("bhqd,bhde->bhqe", pq, kv)
        den = torch.einsum("bhqd,bhd->bhq", pq, z)[..., None] + 1e-6
        o = num / den
        return (lambda x, *d: x.permute(*d))(o, 0, 2, 1, 3).reshape(B, S, D) @ wo

    def _B_ref(x, w1, w2, w3, w4):
        B, S, D = x.shape
        h = _gelu(_layernorm(x, axis=-1) @ w1)
        c = D // 4
        g0 = _pad(h[:, :, 0*c:1*c], ((0, 0), (1, 0), (0, 0)))[:, :S, :]
        g1 = _pad(h[:, :, 1*c:2*c], ((0, 0), (0, 1), (0, 0)))[:, 1:, :]
        g2 = _pad(h[:, :, 2*c:3*c], ((0, 0), (2, 0), (0, 0)))[:, :S, :]
        g3 = _pad(h[:, :, 3*c:   ], ((0, 0), (0, 2), (0, 0)))[:, 2:, :]
        hs = torch.concatenate([g0, g1, g2, g3], axis=-1) @ w2
        x1 = x + hs
        h2 = _gelu(_layernorm(x1, axis=-1) @ w3) @ w4
        return x1 + h2

    x = A_x
    xn = _layernorm(x, axis=-1)
    return x + _A_ref(xn, A_wqkv, A_wo) + _B_ref(xn, B_w1, B_w2, B_w3, B_w4)
```

```asm
; @launch grid=(256,1,1) block=(256,1,1) lds=163840
.amdgcn_target "amdgcn-amd-amdhsa--gfx950"
.text
.globl parallel_sum__linear_attn_block__mixer_s_mlp__prompt_kernel
.p2align 8
.type parallel_sum__linear_attn_block__mixer_s_mlp__prompt_kernel,@function
parallel_sum__linear_attn_block__mixer_s_mlp__prompt_kernel:
    s_cmp_ge_u32 s2, 0x100
    s_cbranch_scc1 L_exit
    s_load_dwordx2 s[4:5], s[0:1], 0
    s_load_dwordx2 s[40:41], s[0:1], 32
    s_load_dwordx2 s[8:9], s[0:1], 8
    s_load_dwordx2 s[36:37], s[0:1], 80
    v_lshrrev_b32 v2, 6, v0
    v_and_b32 v1, 63, v0
    v_readfirstlane_b32 s62, v2
    v_lshlrev_b32 v2, 4, v1
    s_mov_b32 s6, 0x200000
    s_mov_b32 s7, 0x20000
    s_mov_b32 s42, 0x80000
    s_mov_b32 s43, 0x20000
    s_mov_b32 s10, 0x180000
    s_mov_b32 s11, 0x20000
    s_mov_b32 s38, 0x1100000
    s_mov_b32 s39, 0x20000
    s_mov_b32 s14, 0x80000
    s_mov_b32 s15, 0x20000
    s_mov_b32 s34, 0x100
    s_mov_b32 s35, 0x20000
    s_mov_b32 s18, 0x1c0000
    s_mov_b32 s19, 0x20000
    s_mov_b32 s22, 0x1c0000
    s_mov_b32 s23, 0x20000
    s_mov_b32 s26, 0x80000
    s_mov_b32 s27, 0x20000
    s_mov_b32 s30, 0x200000
    s_mov_b32 s31, 0x20000
    s_and_b32 s67, s2, 7
    s_lshr_b32 s68, s2, 3
    s_and_b32 s64, s68, 15
    s_lshr_b32 s68, s68, 4
    s_and_b32 s69, s64, 1
    s_lshl_b32 s69, s69, 3
    s_lshr_b32 s64, s64, 1
    s_or_b32 s64, s64, s69
    s_lshl_b32 s63, s67, 1
    s_add_u32 s63, s63, s68
    s_lshl_b32 s65, s63, 7
    s_cmp_ge_u32 s64, 8
    s_cbranch_scc1 L_roleA
    s_and_b32 s89, s64, 3
    s_lshr_b32 s67, s64, 2
    s_lshl_b32 s67, s67, 6
    s_add_u32 s88, s65, s67
    s_lshr_b32 s67, s89, 1
    s_add_u32 s67, s67, 1
    s_add_u32 s68, s88, s67
    s_sub_u32 s69, s88, s67
    s_bitcmp1_b32 s89, 0
    s_cselect_b32 s90, s68, s69
    s_lshl_b32 s67, s62, 4
    s_add_u32 s68, s90, s67
    v_lshrrev_b32 v3, 3, v1
    v_add_u32 v3, s68, v3
    v_lshrrev_b32 v4, 4, v1
    v_xor_b32 v4, v4, v1
    v_and_b32 v4, 7, v4
    v_lshlrev_b32 v4, 4, v4
    v_add_u32 v5, 0, v3
    v_lshl_add_u32 v6, v5, 10, v4
    v_cmp_gt_u32 vcc, 0x800, v5
    v_mov_b32 v5, 0x80000000
    s_nop 0
    v_cndmask_b32 v6, v5, v6, vcc
    v_add_u32 v5, 8, v3
    v_lshl_add_u32 v7, v5, 10, v4
    v_xor_b32 v7, 64, v7
    v_subrev_u32 v7, 1024, v7
    v_cmp_gt_u32 vcc, 0x800, v5
    v_mov_b32 v5, 0x80000000
    s_nop 0
    v_cndmask_b32 v7, v5, v7, vcc
    v_lshrrev_b32 v3, 3, v1
    v_add_u32 v3, s67, v3
    v_bfe_u32 v4, v1, 4, 1
    v_lshlrev_b32 v4, 2, v4
    v_xor_b32 v4, v4, v1
    v_and_b32 v4, 7, v4
    v_lshlrev_b32 v4, 4, v4
    v_lshl_add_u32 v3, v3, 10, v4
    s_lshl_b32 s69, s89, 8
    v_add_u32 v8, s69, v3
    v_add_u32 v9, 7168, v8
    s_lshl_b32 s72, s62, 11
    s_and_b32 s67, s63, 1
    s_lshl_b32 s67, s67, 3
    s_and_b32 s68, s64, 7
    s_add_u32 s67, s67, s68
    s_lshl_b32 s68, s62, 4
    s_add_u32 s67, s67, s68
    s_mov_b32 s44, s67
    s_lshl_b32 s67, s67, 3
    s_lshr_b32 s68, s63, 1
    s_add_u32 s67, s67, s68
    s_lshl_b32 s67, s67, 13
    v_lshl_add_u32 v14, v1, 7, s67
    s_waitcnt lgkmcnt(0)
    s_load_dwordx2 s[12:13], s[0:1], 40
    s_load_dwordx2 s[32:33], s[0:1], 72
    s_load_dwordx2 s[16:17], s[0:1], 48
    s_load_dwordx2 s[20:21], s[0:1], 56
    s_load_dwordx2 s[24:25], s[0:1], 16
    s_load_dwordx2 s[28:29], s[0:1], 64
    s_add_u32 m0, s72, 0
    s_mov_b32 s70, 0
    buffer_load_dwordx4 v6, s[4:7], s70 offen lds
    buffer_load_dwordx4 v7, s[4:7], s70 offen offset:1024 lds
    s_add_u32 m0, s72, 8192
    s_mov_b32 s71, 0
    buffer_load_dwordx4 v8, s[40:43], s71 offen lds
    buffer_load_dwordx4 v9, s[40:43], s71 offen offset:1024 lds
    s_waitcnt lgkmcnt(0)
    s_lshl_b32 s67, s63, 8
    s_add_u32 s67, s67, 0xf40000
    v_lshl_add_u32 v56, v1, 2, s67
    s_lshl_b32 s68, s64, 2
    s_add_u32 s68, s68, s62
    s_lshl_b32 s68, s68, 2
    s_add_u32 s67, s67, s68
    v_mov_b32 v59, 0x80000000
    s_add_u32 m0, s72, 16384
    s_mov_b32 s70, 128
    buffer_load_dwordx4 v6, s[4:7], s70 offen lds
    v_mov_b32 v55, s67
    v_cmp_eq_u32 vcc, 0, v1
    v_mov_b32 v60, 0
    s_mov_b32 s1, 0
    v_cndmask_b32 v55, v59, v55, vcc
    s_getreg_b32 s101, hwreg(HW_REG_XCC_ID, 0, 4)
    s_lshl_b32 s101, s101, 3
    v_add_u32 v62, 0x1000, v55
    buffer_load_dwordx4 v7, s[4:7], s70 offen offset:1024 lds
    s_mov_b32 s74, 0x3f800008
    s_mov_b32 s75, 0x358637bd
    s_mov_b32 s76, 0x3fb8aa3b
    s_mov_b32 s77, 0xbfb8aa47
    s_mov_b32 s80, 0x22222222
    s_mov_b32 s81, 0x22222222
    s_mov_b32 s82, 0x44444444
    s_mov_b32 s83, 0x44444444
    s_add_u32 m0, s72, 24576
    s_mov_b32 s71, 65536
    buffer_load_dwordx4 v8, s[40:43], s71 offen lds
    s_mov_b32 s84, 0x88888888
    s_mov_b32 s85, 0x88888888
    s_mov_b32 s86, 0
    s_mov_b32 s87, -1
    s_lshr_b32 s92, s64, 3
    s_and_b32 s93, s64, 7
    s_lshr_b32 s67, s62, 1
    s_lshl_b32 s67, s67, 12
    buffer_load_dwordx4 v9, s[40:43], s71 offen offset:1024 lds
    v_and_b32 v3, 31, v1
    v_lshl_add_u32 v3, v3, 7, s67
    v_bfe_u32 v4, v1, 1, 3
    v_lshrrev_b32 v5, 5, v1
    v_xor_b32 v4, v4, v5
    s_xor_b32 s67, s62, 0
    s_lshl_b32 s67, s67, 1
    v_xor_b32 v5, s67, v4
    s_add_u32 m0, s72, 32768
    s_mov_b32 s70, 256
    buffer_load_dwordx4 v6, s[4:7], s70 offen lds
    v_lshl_add_u32 v17, v5, 4, v3
    s_xor_b32 s67, s62, 1
    s_lshl_b32 s67, s67, 1
    v_xor_b32 v5, s67, v4
    v_lshl_add_u32 v18, v5, 4, v3
    s_xor_b32 s67, s62, 2
    s_lshl_b32 s67, s67, 1
    v_xor_b32 v5, s67, v4
    buffer_load_dwordx4 v7, s[4:7], s70 offen offset:1024 lds
    v_lshl_add_u32 v19, v5, 4, v3
    s_xor_b32 s67, s62, 3
    s_lshl_b32 s67, s67, 1
    v_xor_b32 v5, s67, v4
    v_lshl_add_u32 v20, v5, 4, v3
    v_bfe_u32 v3, v1, 2, 2
    v_lshrrev_b32 v4, 5, v1
    v_mul_u32_u24 v4, 8, v4
    s_add_u32 m0, s72, 40960
    s_mov_b32 s71, 131072
    buffer_load_dwordx4 v8, s[40:43], s71 offen lds
    v_add_u32 v3, v3, v4
    v_mul_u32_u24 v3, 128, v3
    v_bfe_u32 v4, v1, 4, 1
    v_lshl_add_u32 v3, v4, 5, v3
    v_and_b32 v4, 3, v1
    v_lshl_add_u32 v3, v4, 3, v3
    v_bfe_u32 v4, v1, 3, 1
    s_and_b32 s67, s62, 1
    buffer_load_dwordx4 v9, s[40:43], s71 offen offset:1024 lds
    v_xor_b32 v4, s67, v4
    v_lshl_add_u32 v3, v4, 6, v3
    s_xor_b32 s67, s62, 0
    s_lshl_b32 s67, s67, 11
    v_add_u32 v21, s67, v3
    s_xor_b32 s67, s62, 1
    s_lshl_b32 s67, s67, 11
    v_add_u32 v22, s67, v3
    s_add_u32 m0, s72, 49152
    s_mov_b32 s70, 384
    buffer_load_dwordx4 v6, s[4:7], s70 offen lds
    s_xor_b32 s67, s62, 2
    s_lshl_b32 s67, s67, 11
    v_add_u32 v23, s67, v3
    s_xor_b32 s67, s62, 3
    s_lshl_b32 s67, s67, 11
    v_add_u32 v24, s67, v3
    v_lshrrev_b32 v3, 2, v1
    v_lshrrev_b32 v4, 4, v1
    buffer_load_dwordx4 v7, s[4:7], s70 offen offset:1024 lds
    v_xor_b32 v3, v3, v4
    v_and_b32 v3, 1, v3
    v_cmp_eq_u32 vcc, 0, v3
    v_mov_b32 v4, 0x3f803f80
    s_nop 0
    v_cndmask_b32 v28, 0, v4, vcc
    v_mov_b32 v29, v28
    v_mov_b32 v30, v28
    v_mov_b32 v31, v28
    s_add_u32 m0, s72, 57344
    s_mov_b32 s71, 196608
    buffer_load_dwordx4 v8, s[40:43], s71 offen lds
    buffer_load_dwordx4 v9, s[40:43], s71 offen offset:1024 lds
    s_waitcnt vmcnt(12)
    s_barrier
    ds_read_b128 a[0:3], v17
    ds_read_b64_tr_b16 v[96:97], v21 offset:8192
    ds_read_b64_tr_b16 v[98:99], v21 offset:8704
    ds_read_b128 a[4:7], v18
    ds_read_b64_tr_b16 v[100:101], v22 offset:8192
    ds_read_b64_tr_b16 v[102:103], v22 offset:8704
    s_waitcnt lgkmcnt(3)
    v_mfma_f32_32x32x16_bf16 v[64:79], v[96:99], a[0:3], 0
    ds_read_b128 a[8:11], v19
    ds_read_b64_tr_b16 v[104:105], v23 offset:8192
    ds_read_b64_tr_b16 v[106:107], v23 offset:8704
    s_add_u32 m0, s72, 65536
    s_mov_b32 s70, 512
    buffer_load_dwordx4 v6, s[4:7], s70 offen lds
    buffer_load_dwordx4 v7, s[4:7], s70 offen offset:1024 lds
    s_lshl_b32 s69, s89, 8
    v_lshrrev_b32 v3, 4, v1
    v_lshlrev_b32 v4, 2, v3
    v_mfma_f32_4x4x4_16b_bf16 v[116:119], a[0:1], a[0:1], 0
    v_mfma_f32_16x16x32_bf16 v[112:115], v[28:31], a[0:3], 0
    v_mfma_f32_16x16x32_bf16 v[120:123], v[28:31], v[96:99], 0
    v_mfma_f32_4x4x4_16b_bf16 v[116:119], a[2:3], a[2:3], v[116:119]
    s_waitcnt lgkmcnt(3)
    v_mfma_f32_32x32x16_bf16 v[64:79], v[100:103], a[4:7], v[64:79]
    ds_read_b128 a[12:15], v20
    ds_read_b64_tr_b16 v[108:109], v24 offset:8192
    ds_read_b64_tr_b16 v[110:111], v24 offset:8704
    s_add_u32 m0, s72, 73728
    s_mov_b32 s71, 262144
    buffer_load_dwordx4 v8, s[40:43], s71 offen lds
    buffer_load_dwordx4 v9, s[40:43], s71 offen offset:1024 lds
    v_xor_b32 v4, v4, v1
    v_and_b32 v4, 15, v4
    v_lshlrev_b32 v4, 4, v4
    v_mfma_f32_16x16x32_bf16 v[120:123], v[28:31], v[100:103], v[120:123]
    s_waitcnt vmcnt(12)
    s_barrier
    s_waitcnt lgkmcnt(3)
    v_mfma_f32_32x32x16_bf16 v[64:79], v[104:107], a[8:11], v[64:79]
    ds_read_b128 a[16:19], v17 offset:16384
    ds_read_b64_tr_b16 v[96:97], v21 offset:24576
    ds_read_b64_tr_b16 v[98:99], v21 offset:25088
    s_add_u32 m0, s72, 81920
    s_mov_b32 s70, 640
    buffer_load_dwordx4 v6, s[4:7], s70 offen lds
    buffer_load_dwordx4 v7, s[4:7], s70 offen offset:1024 lds
    s_lshl_b32 s67, s62, 4
    v_add_u32 v3, s67, v3
    v_mul_u32_u24 v3, 1024, v3
    v_mfma_f32_4x4x4_16b_bf16 v[116:119], a[8:9], a[8:9], v[116:119]
    v_mfma_f32_16x16x32_bf16 v[112:115], v[28:31], a[8:11], v[112:115]
    s_waitcnt lgkmcnt(3)
    v_mfma_f32_32x32x16_bf16 v[64:79], v[108:111], a[12:15], v[64:79]
    ds_read_b128 a[20:23], v18 offset:16384
    ds_read_b64_tr_b16 v[100:101], v22 offset:24576
    ds_read_b64_tr_b16 v[102:103], v22 offset:25088
    s_add_u32 m0, s72, 90112
    s_mov_b32 s71, 327680
    buffer_load_dwordx4 v8, s[40:43], s71 offen lds
    buffer_load_dwordx4 v9, s[40:43], s71 offen offset:1024 lds
    v_add3_u32 v10, v3, v4, s69
    v_add_u32 v11, 3072, v10
    v_add_u32 v12, 6144, v10
    v_mfma_f32_4x4x4_16b_bf16 v[116:119], a[10:11], a[10:11], v[116:119]
    s_waitcnt vmcnt(12)
    s_barrier
    s_waitcnt lgkmcnt(3)
    v_mfma_f32_32x32x16_bf16 v[64:79], v[96:99], a[16:19], v[64:79]
    ds_read_b128 a[24:27], v19 offset:16384
    ds_read_b64_tr_b16 v[104:105], v23 offset:24576
    ds_read_b64_tr_b16 v[106:107], v23 offset:25088
    s_add_u32 m0, s72, 0
    s_mov_b32 s70, 768
    buffer_load_dwordx4 v6, s[4:7], s70 offen lds
    buffer_load_dwordx4 v7, s[4:7], s70 offen offset:1024 lds
    v_add_u32 v13, 9216, v10
    s_lshl_b32 s73, s62, 12
    s_add_u32 s73, s73, 8192
    v_mfma_f32_4x4x4_16b_bf16 v[116:119], a[16:17], a[16:17], v[116:119]
    v_mfma_f32_16x16x32_bf16 v[112:115], v[28:31], a[16:19], v[112:115]
    v_mfma_f32_16x16x32_bf16 v[120:123], v[28:31], v[96:99], v[120:123]
    v_mfma_f32_4x4x4_16b_bf16 v[116:119], a[18:19], a[18:19], v[116:119]
    s_waitcnt lgkmcnt(3)
    v_mfma_f32_32x32x16_bf16 v[64:79], v[100:103], a[20:23], v[64:79]
    ds_read_b128 a[28:31], v20 offset:16384
    ds_read_b64_tr_b16 v[108:109], v24 offset:24576
    ds_read_b64_tr_b16 v[110:111], v24 offset:25088
    s_add_u32 m0, s72, 8192
    s_mov_b32 s71, 393216
    buffer_load_dwordx4 v8, s[40:43], s71 offen lds
    buffer_load_dwordx4 v9, s[40:43], s71 offen offset:1024 lds
    v_bfe_u32 v3, v1, 2, 2
    v_lshrrev_b32 v4, 5, v1
    v_mul_u32_u24 v4, 4, v4
    v_mfma_f32_16x16x32_bf16 v[120:123], v[28:31], v[100:103], v[120:123]
    s_waitcnt lgkmcnt(3)
    v_mfma_f32_32x32x16_bf16 v[64:79], v[104:107], a[24:27], v[64:79]
    ds_read_b128 a[32:35], v17 offset:32768
    ds_read_b64_tr_b16 v[96:97], v21 offset:40960
    ds_read_b64_tr_b16 v[98:99], v21 offset:41472
    v_add_u32 v3, v3, v4
    v_mul_u32_u24 v3, 256, v3
    v_bfe_u32 v4, v1, 4, 1
    v_lshl_add_u32 v3, v4, 5, v3
    v_and_b32 v4, 3, v1
    v_lshl_add_u32 v3, v4, 3, v3
    v_bfe_u32 v4, v1, 2, 2
    v_mfma_f32_4x4x4_16b_bf16 v[116:119], a[24:25], a[24:25], v[116:119]
    v_mfma_f32_16x16x32_bf16 v[112:115], v[28:31], a[24:27], v[112:115]
    s_waitcnt lgkmcnt(3)
    v_mfma_f32_32x32x16_bf16 v[64:79], v[108:111], a[28:31], v[64:79]
    ds_read_b128 a[36:39], v18 offset:32768
    ds_read_b64_tr_b16 v[100:101], v22 offset:40960
    ds_read_b64_tr_b16 v[102:103], v22 offset:41472
    s_and_b32 s67, s62, 1
    s_lshl_b32 s67, s67, 1
    v_xor_b32 v4, s67, v4
    v_lshl_add_u32 v3, v4, 6, v3
    v_add_u32 v42, 0x2000, v3
    v_xor_b32 v43, 64, v42
    s_lshr_b32 s67, s62, 1
    v_mfma_f32_4x4x4_16b_bf16 v[116:119], a[26:27], a[26:27], v[116:119]
    s_waitcnt vmcnt(12)
    s_barrier
    s_waitcnt lgkmcnt(3)
    v_mfma_f32_32x32x16_bf16 v[64:79], v[96:99], a[32:35], v[64:79]
    ds_read_b128 a[40:43], v19 offset:32768
    ds_read_b64_tr_b16 v[104:105], v23 offset:40960
    ds_read_b64_tr_b16 v[106:107], v23 offset:41472
    s_add_u32 m0, s72, 16384
    s_mov_b32 s70, 896
    buffer_load_dwordx4 v6, s[4:7], s70 offen lds
    buffer_load_dwordx4 v7, s[4:7], s70 offen offset:1024 lds
    s_lshl_b32 s67, s67, 5
    s_add_u32 s68, s67, s88
    v_lshrrev_b32 v3, 3, v1
    v_mfma_f32_4x4x4_16b_bf16 v[116:119], a[32:33], a[32:33], v[116:119]
    v_mfma_f32_16x16x32_bf16 v[112:115], v[28:31], a[32:35], v[112:115]
    v_mfma_f32_16x16x32_bf16 v[120:123], v[28:31], v[96:99], v[120:123]
    v_mfma_f32_4x4x4_16b_bf16 v[116:119], a[34:35], a[34:35], v[116:119]
    s_waitcnt lgkmcnt(3)
    v_mfma_f32_32x32x16_bf16 v[64:79], v[100:103], a[36:39], v[64:79]
    ds_read_b128 a[44:47], v20 offset:32768
    ds_read_b64_tr_b16 v[108:109], v24 offset:40960
    ds_read_b64_tr_b16 v[110:111], v24 offset:41472
    s_add_u32 m0, s72, 24576
    s_mov_b32 s71, 458752
    buffer_load_dwordx4 v8, s[40:43], s71 offen lds
    buffer_load_dwordx4 v9, s[40:43], s71 offen offset:1024 lds
    v_add_u32 v3, s68, v3
    v_lshrrev_b32 v4, 4, v1
    v_xor_b32 v4, v4, v1
    v_mfma_f32_16x16x32_bf16 v[120:123], v[28:31], v[100:103], v[120:123]
    s_waitcnt lgkmcnt(3)
    v_mfma_f32_32x32x16_bf16 v[64:79], v[104:107], a[40:43], v[64:79]
    ds_read_b128 a[48:51], v17 offset:49152
    ds_read_b64_tr_b16 v[96:97], v21 offset:57344
    ds_read_b64_tr_b16 v[98:99], v21 offset:57856
    v_and_b32 v4, 7, v4
    v_lshlrev_b32 v4, 4, v4
    v_add_u32 v5, 0, v3
    v_lshl_add_u32 v63, v5, 10, v4
    v_add_u32 v5, 8, v3
    v_lshl_add_u32 v142, v5, 10, v4
    v_xor_b32 v142, 64, v142
    v_mfma_f32_4x4x4_16b_bf16 v[116:119], a[40:41], a[40:41], v[116:119]
    v_mfma_f32_16x16x32_bf16 v[112:115], v[28:31], a[40:43], v[112:115]
    s_waitcnt lgkmcnt(3)
    v_mfma_f32_32x32x16_bf16 v[64:79], v[108:111], a[44:47], v[64:79]
    ds_read_b128 a[52:55], v18 offset:49152
    ds_read_b64_tr_b16 v[100:101], v22 offset:57344
    ds_read_b64_tr_b16 v[102:103], v22 offset:57856
    v_subrev_u32 v142, 1024, v142
    v_add_u32 v5, 16, v3
    v_lshl_add_u32 v143, v5, 10, v4
    v_subrev_u32 v143, 2048, v143
    v_add_u32 v5, 24, v3
    v_lshl_add_u32 v160, v5, 10, v4
    v_xor_b32 v160, 64, v160
    v_mfma_f32_4x4x4_16b_bf16 v[116:119], a[42:43], a[42:43], v[116:119]
    s_waitcnt vmcnt(12)
    s_barrier
    s_waitcnt lgkmcnt(3)
    v_mfma_f32_32x32x16_bf16 v[64:79], v[96:99], a[48:51], v[64:79]
    ds_read_b128 a[56:59], v19 offset:49152
    ds_read_b64_tr_b16 v[104:105], v23 offset:57344
    ds_read_b64_tr_b16 v[106:107], v23 offset:57856
    s_add_u32 m0, s72, 98304
    s_mov_b32 s71, 128
    buffer_load_dwordx4 v8, s[40:43], s71 offen lds
    buffer_load_dwordx4 v9, s[40:43], s71 offen offset:1024 lds
    v_subrev_u32 v160, 3072, v160
    s_lshl_b32 s67, s62, 12
    s_add_u32 s67, s67, 147456
    v_mfma_f32_4x4x4_16b_bf16 v[116:119], a[48:49], a[48:49], v[116:119]
    v_mfma_f32_16x16x32_bf16 v[112:115], v[28:31], a[48:51], v[112:115]
    v_mfma_f32_16x16x32_bf16 v[120:123], v[28:31], v[96:99], v[120:123]
    v_mfma_f32_4x4x4_16b_bf16 v[116:119], a[50:51], a[50:51], v[116:119]
    s_waitcnt lgkmcnt(3)
    v_mfma_f32_32x32x16_bf16 v[64:79], v[100:103], a[52:55], v[64:79]
    ds_read_b128 a[60:63], v20 offset:49152
    ds_read_b64_tr_b16 v[108:109], v24 offset:57344
    ds_read_b64_tr_b16 v[110:111], v24 offset:57856
    s_add_u32 m0, s72, 106496
    s_mov_b32 s71, 65664
    buffer_load_dwordx4 v8, s[40:43], s71 offen lds
    buffer_load_dwordx4 v9, s[40:43], s71 offen offset:1024 lds
    v_and_b32 v3, 31, v1
    v_lshl_add_u32 v44, v3, 7, s67
    v_lshrrev_b32 v4, 5, v1
    v_mfma_f32_16x16x32_bf16 v[120:123], v[28:31], v[100:103], v[120:123]
    v_add_u32 v17, 0x10000, v17
    v_add_u32 v18, 0x10000, v18
    v_add_u32 v19, 0x10000, v19
    v_add_u32 v20, 0x10000, v20
    v_add_u32 v21, 0x10000, v21
    v_add_u32 v22, 0x10000, v22
    v_add_u32 v23, 0x10000, v23
    v_add_u32 v24, 0x10000, v24
    s_waitcnt lgkmcnt(3)
    v_mfma_f32_32x32x16_bf16 v[64:79], v[104:107], a[56:59], v[64:79]
    ds_read_b128 a[64:67], v17
    ds_read_b64_tr_b16 v[96:97], v21 offset:8192
    ds_read_b64_tr_b16 v[98:99], v21 offset:8704
    s_add_u32 m0, s72, 114688
    s_mov_b32 s71, 131200
    buffer_load_dwordx4 v8, s[40:43], s71 offen lds
    buffer_load_dwordx4 v9, s[40:43], s71 offen offset:1024 lds
    v_lshl_add_u32 v44, v4, 3, v44
    v_bfe_u32 v45, v1, 1, 3
    s_lshl_b32 s67, s89, 8
    v_mfma_f32_4x4x4_16b_bf16 v[116:119], a[56:57], a[56:57], v[116:119]
    v_mfma_f32_16x16x32_bf16 v[112:115], v[28:31], a[56:59], v[112:115]
    s_waitcnt lgkmcnt(3)
    v_mfma_f32_32x32x16_bf16 v[64:79], v[108:111], a[60:63], v[64:79]
    ds_read_b128 a[68:71], v18
    ds_read_b64_tr_b16 v[100:101], v22 offset:8192
    ds_read_b64_tr_b16 v[102:103], v22 offset:8704
    s_add_u32 m0, s72, 122880
    s_mov_b32 s71, 196736
    buffer_load_dwordx4 v8, s[40:43], s71 offen lds
    buffer_load_dwordx4 v9, s[40:43], s71 offen offset:1024 lds
    s_and_b32 s68, s62, 1
    s_lshl_b32 s68, s68, 7
    s_add_u32 s0, s67, s68
    v_mfma_f32_4x4x4_16b_bf16 v[116:119], a[58:59], a[58:59], v[116:119]
    s_waitcnt vmcnt(16)
    s_barrier
    s_waitcnt lgkmcnt(3)
    v_mfma_f32_32x32x16_bf16 v[64:79], v[96:99], a[64:67], v[64:79]
    ds_read_b128 a[72:75], v19
    ds_read_b64_tr_b16 v[104:105], v23 offset:8192
    ds_read_b64_tr_b16 v[106:107], v23 offset:8704
    s_add_u32 m0, s72, 131072
    s_mov_b32 s71, 262272
    buffer_load_dwordx4 v8, s[40:43], s71 offen lds
    buffer_load_dwordx4 v9, s[40:43], s71 offen offset:1024 lds
    s_lshl_b32 s67, s62, 8
    s_add_u32 s67, s67, 0
    v_lshl_add_u32 v25, v1, 2, s67
    v_mfma_f32_4x4x4_16b_bf16 v[116:119], a[64:65], a[64:65], v[116:119]
    v_mfma_f32_16x16x32_bf16 v[112:115], v[28:31], a[64:67], v[112:115]
    v_mfma_f32_16x16x32_bf16 v[120:123], v[28:31], v[96:99], v[120:123]
    v_mfma_f32_4x4x4_16b_bf16 v[116:119], a[66:67], a[66:67], v[116:119]
    s_waitcnt lgkmcnt(3)
    v_mfma_f32_32x32x16_bf16 v[64:79], v[100:103], a[68:71], v[64:79]
    ds_read_b128 a[76:79], v20
    ds_read_b64_tr_b16 v[108:109], v24 offset:8192
    ds_read_b64_tr_b16 v[110:111], v24 offset:8704
    s_add_u32 m0, s72, 139264
    s_mov_b32 s71, 327808
    buffer_load_dwordx4 v8, s[40:43], s71 offen lds
    buffer_load_dwordx4 v9, s[40:43], s71 offen offset:1024 lds
    s_xor_b32 s68, s67, 256
    v_lshl_add_u32 v26, v3, 2, s68
    s_lshl_b32 s67, s62, 7
    v_mfma_f32_16x16x32_bf16 v[120:123], v[28:31], v[100:103], v[120:123]
    s_waitcnt lgkmcnt(3)
    v_mfma_f32_32x32x16_bf16 v[64:79], v[104:107], a[72:75], v[64:79]
    ds_read_b128 a[80:83], v17 offset:16384
    ds_read_b64_tr_b16 v[96:97], v21 offset:24576
    ds_read_b64_tr_b16 v[98:99], v21 offset:25088
    s_add_u32 m0, s72, 147456
    s_mov_b32 s71, 393344
    buffer_load_dwordx4 v8, s[40:43], s71 offen lds
    buffer_load_dwordx4 v9, s[40:43], s71 offen offset:1024 lds
    s_add_u32 s67, s67, 1024
    v_lshl_add_u32 v27, v3, 2, s67
    v_and_b32 v32, 0xfffffeff, v27
    v_mfma_f32_4x4x4_16b_bf16 v[116:119], a[72:73], a[72:73], v[116:119]
    v_mfma_f32_16x16x32_bf16 v[112:115], v[28:31], a[72:75], v[112:115]
    s_waitcnt lgkmcnt(3)
    v_mfma_f32_32x32x16_bf16 v[64:79], v[108:111], a[76:79], v[64:79]
    ds_read_b128 a[84:87], v18 offset:16384
    ds_read_b64_tr_b16 v[100:101], v22 offset:24576
    ds_read_b64_tr_b16 v[102:103], v22 offset:25088
    s_add_u32 m0, s72, 155648
    s_mov_b32 s71, 458880
    buffer_load_dwordx4 v8, s[40:43], s71 offen lds
    buffer_load_dwordx4 v9, s[40:43], s71 offen offset:1024 lds
    s_lshr_b32 s67, s88, 5
    s_lshr_b32 s68, s62, 1
    s_add_u32 s67, s67, s68
    v_mfma_f32_4x4x4_16b_bf16 v[116:119], a[74:75], a[74:75], v[116:119]
    s_waitcnt vmcnt(20)
    s_barrier
    s_waitcnt lgkmcnt(3)
    v_mfma_f32_32x32x16_bf16 v[64:79], v[96:99], a[80:83], v[64:79]
    ds_read_b128 a[88:91], v19 offset:16384
    ds_read_b64_tr_b16 v[104:105], v23 offset:24576
    ds_read_b64_tr_b16 v[106:107], v23 offset:25088
    s_lshl_b32 s67, s67, 15
    s_lshl_b32 s68, s68, 12
    v_add_u32 v39, s68, v2
    s_and_b32 s69, s62, 1
    s_lshl_b32 s68, s69, 11
    s_add_u32 s68, s68, s67
    v_add_u32 v38, s68, v2
    v_mfma_f32_4x4x4_16b_bf16 v[116:119], a[80:81], a[80:81], v[116:119]
    v_mfma_f32_16x16x32_bf16 v[112:115], v[28:31], a[80:83], v[112:115]
    v_mfma_f32_16x16x32_bf16 v[120:123], v[28:31], v[96:99], v[120:123]
    v_mfma_f32_4x4x4_16b_bf16 v[116:119], a[82:83], a[82:83], v[116:119]
    s_waitcnt lgkmcnt(3)
    v_mfma_f32_32x32x16_bf16 v[64:79], v[100:103], a[84:87], v[64:79]
    ds_read_b128 a[92:95], v20 offset:16384
    ds_read_b64_tr_b16 v[108:109], v24 offset:24576
    ds_read_b64_tr_b16 v[110:111], v24 offset:25088
    s_lshl_b32 s68, s89, 12
    v_add_u32 v36, s68, v38
    s_lshl_b32 s68, s89, 13
    s_add_u32 s67, s67, s68
    s_lshl_b32 s68, s69, 12
    s_add_u32 s67, s67, s68
    v_add_u32 v33, s67, v2
    v_mfma_f32_16x16x32_bf16 v[120:123], v[28:31], v[100:103], v[120:123]
    v_add_u32 v17, 0xffff0000, v17
    v_add_u32 v18, 0xffff0000, v18
    v_add_u32 v19, 0xffff0000, v19
    v_add_u32 v20, 0xffff0000, v20
    v_add_u32 v21, 0xffff0000, v21
    v_add_u32 v22, 0xffff0000, v22
    v_add_u32 v23, 0xffff0000, v23
    v_add_u32 v24, 0xffff0000, v24
    s_waitcnt lgkmcnt(3)
    v_mfma_f32_32x32x16_bf16 v[64:79], v[104:107], a[88:91], v[64:79]
    ds_read_b128 a[96:99], v17
    ds_read_b64_tr_b16 v[96:97], v21 offset:8192
    ds_read_b64_tr_b16 v[98:99], v21 offset:8704
    s_lshr_b32 s67, s62, 1
    s_lshl_b32 s67, s67, 5
    s_add_u32 s68, s67, s88
    s_lshl_b32 s68, s68, 2
    v_lshl_add_u32 v40, v3, 2, s68
    v_add_u32 v3, s67, v3
    s_lshl_b32 s67, s89, 1
    v_mfma_f32_4x4x4_16b_bf16 v[116:119], a[88:89], a[88:89], v[116:119]
    v_mfma_f32_16x16x32_bf16 v[112:115], v[28:31], a[88:91], v[112:115]
    s_waitcnt lgkmcnt(3)
    v_mfma_f32_32x32x16_bf16 v[64:79], v[108:111], a[92:95], v[64:79]
    ds_read_b128 a[100:103], v18
    ds_read_b64_tr_b16 v[100:101], v22 offset:8192
    ds_read_b64_tr_b16 v[102:103], v22 offset:8704
    s_add_u32 s67, s67, s69
    s_lshl_b32 s68, s67, 13
    s_add_u32 s68, s68, 0xf20000
    v_lshl_add_u32 v41, v4, 16, v40
    v_add_u32 v41, s68, v41
    s_cmp_eq_u32 s67, 0
    s_cselect_b32 s68, 63, 0
    s_cselect_b32 s69, 1, 62
    v_mfma_f32_4x4x4_16b_bf16 v[116:119], a[90:91], a[90:91], v[116:119]
    s_waitcnt vmcnt(16)
    s_barrier
    s_waitcnt lgkmcnt(3)
    v_mfma_f32_32x32x16_bf16 v[64:79], v[96:99], a[96:99], v[64:79]
    ds_read_b128 a[104:107], v19
    ds_read_b64_tr_b16 v[104:105], v23 offset:8192
    ds_read_b64_tr_b16 v[106:107], v23 offset:8704
    s_cmp_eq_u32 s67, 2
    s_cselect_b32 s68, 1, s68
    v_subrev_u32 v5, s69, v3
    v_cmp_gt_u32 vcc, s68, v5
    v_add_u32 v3, s90, v3
    v_lshlrev_b32 v3, 2, v3
    v_mfma_f32_4x4x4_16b_bf16 v[116:119], a[96:97], a[96:97], v[116:119]
    v_mfma_f32_16x16x32_bf16 v[112:115], v[28:31], a[96:99], v[112:115]
    v_mfma_f32_16x16x32_bf16 v[120:123], v[28:31], v[96:99], v[120:123]
    v_mfma_f32_4x4x4_16b_bf16 v[116:119], a[98:99], a[98:99], v[116:119]
    s_waitcnt lgkmcnt(3)
    v_mfma_f32_32x32x16_bf16 v[64:79], v[100:103], a[100:103], v[64:79]
    ds_read_b128 a[108:111], v20
    ds_read_b64_tr_b16 v[108:109], v24 offset:8192
    ds_read_b64_tr_b16 v[110:111], v24 offset:8704
    v_lshl_add_u32 v3, v4, 13, v3
    v_add_u32 v3, 0xf10000, v3
    v_mov_b32 v5, 0x80000000
    v_cndmask_b32 v34, v5, v3, vcc
    s_lshl_b32 s69, s64, 8
    v_lshrrev_b32 v3, 3, v1
    s_lshl_b32 s67, s62, 4
    v_mfma_f32_16x16x32_bf16 v[120:123], v[28:31], v[100:103], v[120:123]
    s_waitcnt lgkmcnt(3)
    v_mfma_f32_32x32x16_bf16 v[64:79], v[104:107], a[104:107], v[64:79]
    ds_read_b128 a[112:115], v17 offset:16384
    ds_read_b64_tr_b16 v[96:97], v21 offset:24576
    ds_read_b64_tr_b16 v[98:99], v21 offset:25088
    v_add_u32 v3, s67, v3
    v_mul_u32_u24 v3, 3584, v3
    v_bfe_u32 v4, v1, 4, 1
    v_lshlrev_b32 v4, 2, v4
    v_xor_b32 v4, v4, v1
    v_and_b32 v4, 7, v4
    v_lshlrev_b32 v4, 4, v4
    v_mfma_f32_4x4x4_16b_bf16 v[116:119], a[104:105], a[104:105], v[116:119]
    v_mfma_f32_16x16x32_bf16 v[112:115], v[28:31], a[104:107], v[112:115]
    s_waitcnt lgkmcnt(3)
    v_mfma_f32_32x32x16_bf16 v[64:79], v[108:111], a[108:111], v[64:79]
    ds_read_b128 a[116:119], v18 offset:16384
    ds_read_b64_tr_b16 v[100:101], v22 offset:24576
    ds_read_b64_tr_b16 v[102:103], v22 offset:25088
    v_add3_u32 v46, v3, v4, s69
    v_add_u32 v47, 27648, v46
    s_lshl_b32 s3, s62, 12
    v_lshrrev_b32 v3, 3, v1
    s_lshl_b32 s67, s62, 5
    v_add_u32 v3, s67, v3
    v_bfe_u32 v4, v1, 4, 1
    v_mfma_f32_4x4x4_16b_bf16 v[116:119], a[106:107], a[106:107], v[116:119]
    s_waitcnt lgkmcnt(3)
    v_mfma_f32_32x32x16_bf16 v[64:79], v[96:99], a[112:115], v[64:79]
    ds_read_b128 a[120:123], v19 offset:16384
    ds_read_b64_tr_b16 v[104:105], v23 offset:24576
    ds_read_b64_tr_b16 v[106:107], v23 offset:25088
    v_lshlrev_b32 v4, 2, v4
    v_xor_b32 v4, v4, v1
    v_and_b32 v4, 7, v4
    v_lshlrev_b32 v4, 4, v4
    v_lshl_add_u32 v3, v3, 10, v4
    s_lshl_b32 s67, s93, 7
    v_add_u32 v48, s67, v3
    v_mfma_f32_4x4x4_16b_bf16 v[116:119], a[112:113], a[112:113], v[116:119]
    v_mfma_f32_16x16x32_bf16 v[112:115], v[28:31], a[112:115], v[112:115]
    v_mfma_f32_16x16x32_bf16 v[120:123], v[28:31], v[96:99], v[120:123]
    v_mfma_f32_4x4x4_16b_bf16 v[116:119], a[114:115], a[114:115], v[116:119]
    s_waitcnt lgkmcnt(3)
    v_mfma_f32_32x32x16_bf16 v[64:79], v[100:103], a[116:119], v[64:79]
    ds_read_b128 a[124:127], v20 offset:16384
    ds_read_b64_tr_b16 v[108:109], v24 offset:24576
    ds_read_b64_tr_b16 v[110:111], v24 offset:25088
    v_add_u32 v49, 7168, v48
    v_add_u32 v50, 14336, v48
    v_add_u32 v51, 21504, v48
    s_lshr_b32 s79, s62, 1
    s_lshl_b32 s79, s79, 16
    s_lshr_b32 s61, s79, 1
    s_lshl_b32 s47, s62, 16
    v_mfma_f32_16x16x32_bf16 v[120:123], v[28:31], v[100:103], v[120:123]
    s_waitcnt lgkmcnt(3)
    v_mfma_f32_32x32x16_bf16 v[64:79], v[104:107], a[120:123], v[64:79]
    s_lshl_b32 s68, s64, 12
    s_add_u32 s68, s68, 49152
    s_lshr_b32 s67, s65, 5
    s_add_u32 s67, s67, s62
    s_mul_i32 s67, s67, 147456
    s_add_u32 s67, s67, s68
    s_add_u32 s67, s67, 0x400000
    v_and_b32 v3, 31, v1
    v_lshrrev_b32 v4, 5, v1
    v_lshl_add_u32 v3, v3, 7, s67
    v_mfma_f32_4x4x4_16b_bf16 v[116:119], a[120:121], a[120:121], v[116:119]
    v_mfma_f32_16x16x32_bf16 v[112:115], v[28:31], a[120:123], v[112:115]
    s_waitcnt lgkmcnt(0)
    v_mfma_f32_32x32x16_bf16 v[64:79], v[108:111], a[124:127], v[64:79]
    v_lshl_add_u32 v54, v4, 15, v3
    s_and_b32 s68, s62, 1
    s_lshl_b32 s68, s68, 11
    s_add_u32 s67, s67, s68
    v_add_u32 v52, s67, v2
    v_xor_b32 v53, 2048, v52
    v_mfma_f32_4x4x4_16b_bf16 v[116:119], a[122:123], a[122:123], v[116:119]
    s_nop 4
    v_cndmask_b32_e64 v116, v116, v117, s[80:81]
    v_cndmask_b32_e64 v116, v116, v118, s[82:83]
    v_cndmask_b32_e64 v116, v116, v119, s[84:85]
    v_mov_b32 v117, v116
    ds_write_b32 v27, v120
    s_nop 0
    v_permlane32_swap_b32 v116, v117
    v_add_f32 v113, v116, v117
    v_cndmask_b32_e64 v114, v112, v113, s[86:87]
    ds_write_b32 v25, v114
    v_add_u32 v21, 0x18000, v21
    v_add_u32 v22, 0x18000, v22
    v_add_u32 v23, 0x18000, v23
    v_add_u32 v24, 0x18000, v24
    s_waitcnt vmcnt(14) lgkmcnt(0)
    s_barrier
    ds_read_b64_tr_b16 v[96:97], v21
    ds_read_b64_tr_b16 v[98:99], v21 offset:512
    ds_read_b64_tr_b16 v[100:101], v22
    ds_read_b64_tr_b16 v[102:103], v22 offset:512
    s_waitcnt lgkmcnt(2)
    v_mfma_f32_32x32x16_bf16 v[80:95], v[96:99], a[0:3], 0
    ds_read_b64_tr_b16 v[104:105], v23
    ds_read_b64_tr_b16 v[106:107], v23 offset:512
    ds_read2_b32 v[114:115], v26 offset1:32
    ds_read2_b32 v[140:141], v32 offset0:0 offset1:64
    s_waitcnt lgkmcnt(0)
    v_add_f32 v112, v112, v114
    v_add_f32 v113, v113, v115
    v_mul_f32 v116, 0x3b000000, v112
    v_mul_f32 v117, 0x3b000000, v113
    v_fma_f32 v117, -v116, v116, v117
    v_max_f32 v117, 0, v117
    v_mfma_f32_16x16x32_bf16 v[124:127], v[28:31], v[96:99], 0
    v_mfma_f32_32x32x16_bf16 v[80:95], v[100:103], a[4:7], v[80:95]
    ds_read_b64_tr_b16 v[108:109], v24
    ds_read_b64_tr_b16 v[110:111], v24 offset:512
    buffer_load_dword v35, v60, s[32:35], 0 offen sc1
    v_add_f32 v118, 0x3727c5ac, v117
    v_rsq_f32 v118, v118
    v_mov_b32 v138, 0
    v_mul_f32 v3, v118, v118
    v_mov_b32 v4, 0x3727c5ac
    v_fma_f32 v3, v3, v117, v4
    v_rsq_f32 v3, v3
    v_cndmask_b32_e64 v112, v116, v118, s[86:87]
    v_mfma_f32_16x16x32_bf16 v[124:127], v[28:31], v[100:103], v[124:127]
    s_waitcnt vmcnt(13)
    s_barrier
    v_mfma_f32_32x32x16_bf16 v[80:95], v[104:107], a[8:11], v[80:95]
    ds_read_b64_tr_b16 v[96:97], v21 offset:8192
    ds_read_b64_tr_b16 v[98:99], v21 offset:8704
    v_mov_b32 v139, 0
    v_mul_f32 v3, v3, v118
    v_mul_f32 v128, 0xc0135761, v3
    v_mul_f32 v4, v3, v3
    v_mul_f32 v4, v4, v3
    v_mul_f32 v129, 0xbdd2d3e8, v4
    v_sub_f32 v130, 0, v116
    v_rcp_f32 v131, v3
    s_waitcnt lgkmcnt(2)
    v_mfma_f32_32x32x16_bf16 v[80:95], v[108:111], a[12:15], v[80:95]
    ds_read_b64_tr_b16 v[100:101], v22 offset:8192
    ds_read_b64_tr_b16 v[102:103], v22 offset:8704
    s_add_u32 m0, s73, 0
    s_mov_b32 s71, 0
    buffer_load_dwordx4 v10, s[12:15], s71 offen lds
    v_and_b32 v4, 0xffff0000, v130
    v_cvt_pk_bf16_f32 v132, v4, v4
    v_sub_f32 v4, v130, v4
    v_cvt_pk_bf16_f32 v133, v4, 0
    v_mov_b32 v134, 0
    v_mov_b32 v135, 0
    s_waitcnt vmcnt(12)
    s_barrier
    s_waitcnt lgkmcnt(2)
    v_mfma_f32_32x32x16_bf16 v[80:95], v[96:99], a[16:19], v[80:95]
    ds_read_b64_tr_b16 v[104:105], v23 offset:8192
    ds_read_b64_tr_b16 v[106:107], v23 offset:8704
    v_add_f32 v140, v140, v141
    v_cndmask_b32_e64 v140, v140, 0, s[86:87]
    v_and_b32 v141, 0xffff0000, v140
    v_sub_f32 v140, v140, v141
    v_lshrrev_b32 v137, 16, v141
    v_cvt_pk_bf16_f32 v136, v141, v140
    s_nop 1
    v_mfma_f32_32x32x16_bf16 v[64:79], v[136:139], v[132:135], v[64:79]
    buffer_store_dword v112, v34, s[36:39], 0 offen sc1
    s_nop 10
    v_mul_f32 v144, v64, v64
    v_mfma_f32_16x16x32_bf16 v[124:127], v[28:31], v[96:99], v[124:127]
    s_waitcnt lgkmcnt(2)
    v_mfma_f32_32x32x16_bf16 v[80:95], v[100:103], a[20:23], v[80:95]
    ds_read_b64_tr_b16 v[108:109], v24 offset:8192
    ds_read_b64_tr_b16 v[110:111], v24 offset:8704
    buffer_load_dwordx4 v11, s[12:15], s71 offen offset:1024 lds
    v_mul_f32 v145, v65, v65
    v_mul_f32 v146, v66, v66
    v_mul_f32 v147, v67, v67
    v_mul_f32 v148, v68, v68
    v_mul_f32 v149, v69, v69
    v_mul_f32 v150, v70, v70
    v_mul_f32 v151, v71, v71
    v_fma_f32 v144, v144, v129, v128
    v_mfma_f32_16x16x32_bf16 v[124:127], v[28:31], v[100:103], v[124:127]
    s_waitcnt lgkmcnt(2)
    v_mfma_f32_32x32x16_bf16 v[80:95], v[104:107], a[24:27], v[80:95]
    ds_read_b64_tr_b16 v[96:97], v21 offset:16384
    ds_read_b64_tr_b16 v[98:99], v21 offset:16896
    v_fma_f32 v145, v145, v129, v128
    v_fma_f32 v146, v146, v129, v128
    v_fma_f32 v147, v147, v129, v128
    v_fma_f32 v148, v148, v129, v128
    v_fma_f32 v149, v149, v129, v128
    v_fma_f32 v150, v150, v129, v128
    v_fma_f32 v151, v151, v129, v128
    v_mul_f32 v144, v144, v64
    v_mul_f32 v145, v145, v65
    s_waitcnt lgkmcnt(2)
    v_mfma_f32_32x32x16_bf16 v[80:95], v[108:111], a[28:31], v[80:95]
    ds_read_b64_tr_b16 v[100:101], v22 offset:16384
    ds_read_b64_tr_b16 v[102:103], v22 offset:16896
    buffer_load_dwordx4 v12, s[12:15], s71 offen offset:2048 lds
    v_mul_f32 v146, v146, v66
    v_mul_f32 v147, v147, v67
    v_mul_f32 v148, v148, v68
    v_mul_f32 v149, v149, v69
    v_mul_f32 v150, v150, v70
    v_mul_f32 v151, v151, v71
    v_exp_f32 v144, v144
    s_waitcnt vmcnt(13)
    s_barrier
    s_waitcnt lgkmcnt(2)
    v_mfma_f32_32x32x16_bf16 v[80:95], v[96:99], a[32:35], v[80:95]
    ds_read_b64_tr_b16 v[104:105], v23 offset:16384
    ds_read_b64_tr_b16 v[106:107], v23 offset:16896
    v_exp_f32 v145, v145
    v_exp_f32 v146, v146
    v_exp_f32 v147, v147
    v_exp_f32 v148, v148
    v_exp_f32 v149, v149
    v_mfma_f32_16x16x32_bf16 v[124:127], v[28:31], v[96:99], v[124:127]
    s_waitcnt lgkmcnt(2)
    v_mfma_f32_32x32x16_bf16 v[80:95], v[100:103], a[36:39], v[80:95]
    ds_read_b64_tr_b16 v[108:109], v24 offset:16384
    ds_read_b64_tr_b16 v[110:111], v24 offset:16896
    buffer_load_dwordx4 v13, s[12:15], s71 offen offset:3072 lds
    v_exp_f32 v150, v150
    v_exp_f32 v151, v151
    v_fma_f32 v144, v144, v131, v131
    v_fma_f32 v145, v145, v131, v131
    v_fma_f32 v146, v146, v131, v131
    v_mfma_f32_16x16x32_bf16 v[124:127], v[28:31], v[100:103], v[124:127]
    s_waitcnt lgkmcnt(2)
    v_mfma_f32_32x32x16_bf16 v[80:95], v[104:107], a[40:43], v[80:95]
    ds_read_b64_tr_b16 v[96:97], v21 offset:24576
    ds_read_b64_tr_b16 v[98:99], v21 offset:25088
    v_fma_f32 v147, v147, v131, v131
    v_fma_f32 v148, v148, v131, v131
    v_fma_f32 v149, v149, v131, v131
    v_fma_f32 v150, v150, v131, v131
    v_fma_f32 v151, v151, v131, v131
    v_rcp_f32 v144, v144
    v_rcp_f32 v145, v145
    s_waitcnt lgkmcnt(2)
    v_mfma_f32_32x32x16_bf16 v[80:95], v[108:111], a[44:47], v[80:95]
    ds_read_b64_tr_b16 v[100:101], v22 offset:24576
    ds_read_b64_tr_b16 v[102:103], v22 offset:25088
    s_add_u32 m0, s73, 24576
    s_mov_b32 s71, 131072
    buffer_load_dwordx4 v10, s[12:15], s71 offen lds
    v_rcp_f32 v146, v146
    v_rcp_f32 v147, v147
    v_rcp_f32 v148, v148
    s_waitcnt vmcnt(13)
    s_barrier
    s_waitcnt lgkmcnt(2)
    v_mfma_f32_32x32x16_bf16 v[80:95], v[96:99], a[48:51], v[80:95]
    ds_read_b64_tr_b16 v[104:105], v23 offset:24576
    ds_read_b64_tr_b16 v[106:107], v23 offset:25088
    v_rcp_f32 v149, v149
    v_rcp_f32 v150, v150
    v_rcp_f32 v151, v151
    v_mul_f32 v144, v144, v64
    v_mul_f32 v145, v145, v65
    v_mul_f32 v146, v146, v66
    v_mfma_f32_16x16x32_bf16 v[124:127], v[28:31], v[96:99], v[124:127]
    s_waitcnt lgkmcnt(2)
    v_mfma_f32_32x32x16_bf16 v[80:95], v[100:103], a[52:55], v[80:95]
    ds_read_b64_tr_b16 v[108:109], v24 offset:24576
    ds_read_b64_tr_b16 v[110:111], v24 offset:25088
    buffer_load_dwordx4 v11, s[12:15], s71 offen offset:1024 lds
    v_mul_f32 v147, v147, v67
    v_mul_f32 v148, v148, v68
    v_mul_f32 v149, v149, v69
    v_mul_f32 v150, v150, v70
    v_mul_f32 v151, v151, v71
    v_cvt_pk_bf16_f32 v152, v144, v145
    v_cvt_pk_bf16_f32 v153, v146, v147
    v_cvt_pk_bf16_f32 v154, v148, v149
    v_mfma_f32_16x16x32_bf16 v[124:127], v[28:31], v[100:103], v[124:127]
    s_waitcnt lgkmcnt(2)
    v_mfma_f32_32x32x16_bf16 v[80:95], v[104:107], a[56:59], v[80:95]
    ds_read_b64_tr_b16 v[96:97], v21 offset:32768
    ds_read_b64_tr_b16 v[98:99], v21 offset:33280
    v_cvt_pk_bf16_f32 v155, v150, v151
    buffer_store_dwordx4 v[152:155], v36, s[36:39], 0 offen sc1
    v_mul_f32 v144, v72, v72
    v_mul_f32 v145, v73, v73
    v_mul_f32 v146, v74, v74
    v_mul_f32 v147, v75, v75
    v_mul_f32 v148, v76, v76
    v_mul_f32 v149, v77, v77
    v_mul_f32 v150, v78, v78
    s_waitcnt lgkmcnt(2)
    v_mfma_f32_32x32x16_bf16 v[80:95], v[108:111], a[60:63], v[80:95]
    ds_read_b64_tr_b16 v[100:101], v22 offset:32768
    ds_read_b64_tr_b16 v[102:103], v22 offset:33280
    buffer_load_dwordx4 v12, s[12:15], s71 offen offset:2048 lds
    v_mul_f32 v151, v79, v79
    v_fma_f32 v144, v144, v129, v128
    v_fma_f32 v145, v145, v129, v128
    v_fma_f32 v146, v146, v129, v128
    v_fma_f32 v147, v147, v129, v128
    v_fma_f32 v148, v148, v129, v128
    v_fma_f32 v149, v149, v129, v128
    v_fma_f32 v150, v150, v129, v128
    s_waitcnt vmcnt(14)
    s_barrier
    s_waitcnt lgkmcnt(2)
    v_mfma_f32_32x32x16_bf16 v[80:95], v[96:99], a[64:67], v[80:95]
    ds_read_b64_tr_b16 v[104:105], v23 offset:32768
    ds_read_b64_tr_b16 v[106:107], v23 offset:33280
    v_fma_f32 v151, v151, v129, v128
    v_mul_f32 v144, v144, v72
    v_mul_f32 v145, v145, v73
    v_mul_f32 v146, v146, v74
    v_mul_f32 v147, v147, v75
    v_mul_f32 v148, v148, v76
    v_mul_f32 v149, v149, v77
    v_mul_f32 v150, v150, v78
    v_mul_f32 v151, v151, v79
    v_mfma_f32_16x16x32_bf16 v[124:127], v[28:31], v[96:99], v[124:127]
    s_waitcnt lgkmcnt(2)
    v_mfma_f32_32x32x16_bf16 v[80:95], v[100:103], a[68:71], v[80:95]
    ds_read_b64_tr_b16 v[108:109], v24 offset:32768
    ds_read_b64_tr_b16 v[110:111], v24 offset:33280
    buffer_load_dwordx4 v13, s[12:15], s71 offen offset:3072 lds
    v_exp_f32 v144, v144
    v_exp_f32 v145, v145
    v_exp_f32 v146, v146
    v_exp_f32 v147, v147
    v_mfma_f32_16x16x32_bf16 v[124:127], v[28:31], v[100:103], v[124:127]
    s_waitcnt lgkmcnt(2)
    v_mfma_f32_32x32x16_bf16 v[80:95], v[104:107], a[72:75], v[80:95]
    ds_read_b64_tr_b16 v[96:97], v21 offset:40960
    ds_read_b64_tr_b16 v[98:99], v21 offset:41472
    v_exp_f32 v148, v148
    v_exp_f32 v149, v149
    v_exp_f32 v150, v150
    v_exp_f32 v151, v151
    v_fma_f32 v144, v144, v131, v131
    s_waitcnt lgkmcnt(2)
    v_mfma_f32_32x32x16_bf16 v[80:95], v[108:111], a[76:79], v[80:95]
    ds_read_b64_tr_b16 v[100:101], v22 offset:40960
    ds_read_b64_tr_b16 v[102:103], v22 offset:41472
    s_add_u32 m0, s73, 49152
    s_mov_b32 s71, 262144
    buffer_load_dwordx4 v10, s[12:15], s71 offen lds
    v_fma_f32 v145, v145, v131, v131
    v_fma_f32 v146, v146, v131, v131
    v_fma_f32 v147, v147, v131, v131
    v_fma_f32 v148, v148, v131, v131
    v_fma_f32 v149, v149, v131, v131
    v_fma_f32 v150, v150, v131, v131
    s_waitcnt vmcnt(14)
    s_barrier
    s_waitcnt lgkmcnt(2)
    v_mfma_f32_32x32x16_bf16 v[80:95], v[96:99], a[80:83], v[80:95]
    ds_read_b64_tr_b16 v[104:105], v23 offset:40960
    ds_read_b64_tr_b16 v[106:107], v23 offset:41472
    v_fma_f32 v151, v151, v131, v131
    v_rcp_f32 v144, v144
    v_rcp_f32 v145, v145
    v_rcp_f32 v146, v146
    v_rcp_f32 v147, v147
    v_mfma_f32_16x16x32_bf16 v[124:127], v[28:31], v[96:99], v[124:127]
    s_waitcnt lgkmcnt(2)
    v_mfma_f32_32x32x16_bf16 v[80:95], v[100:103], a[84:87], v[80:95]
    ds_read_b64_tr_b16 v[108:109], v24 offset:40960
    ds_read_b64_tr_b16 v[110:111], v24 offset:41472
    buffer_load_dwordx4 v11, s[12:15], s71 offen offset:1024 lds
    v_rcp_f32 v148, v148
    v_rcp_f32 v149, v149
    v_rcp_f32 v150, v150
    v_rcp_f32 v151, v151
    v_mfma_f32_16x16x32_bf16 v[124:127], v[28:31], v[100:103], v[124:127]
    s_waitcnt lgkmcnt(2)
    v_mfma_f32_32x32x16_bf16 v[80:95], v[104:107], a[88:91], v[80:95]
    ds_read_b64_tr_b16 v[96:97], v21 offset:49152
    ds_read_b64_tr_b16 v[98:99], v21 offset:49664
    v_mul_f32 v144, v144, v72
    v_mul_f32 v145, v145, v73
    v_mul_f32 v146, v146, v74
    v_mul_f32 v147, v147, v75
    v_mul_f32 v148, v148, v76
    v_mul_f32 v149, v149, v77
    v_mul_f32 v150, v150, v78
    v_mul_f32 v151, v151, v79
    v_cvt_pk_bf16_f32 v156, v144, v145
    s_waitcnt lgkmcnt(2)
    v_mfma_f32_32x32x16_bf16 v[80:95], v[108:111], a[92:95], v[80:95]
    ds_read_b64_tr_b16 v[100:101], v22 offset:49152
    ds_read_b64_tr_b16 v[102:103], v22 offset:49664
    buffer_load_dwordx4 v12, s[12:15], s71 offen offset:2048 lds
    v_cvt_pk_bf16_f32 v157, v146, v147
    v_cvt_pk_bf16_f32 v158, v148, v149
    v_cvt_pk_bf16_f32 v159, v150, v151
    buffer_store_dwordx4 v[156:159], v36, s[36:39], 0 offen offset:1024 sc1
    s_waitcnt vmcnt(15)
    s_barrier
    s_waitcnt lgkmcnt(2)
    v_mfma_f32_32x32x16_bf16 v[80:95], v[96:99], a[96:99], v[80:95]
    ds_read_b64_tr_b16 v[104:105], v23 offset:49152
    ds_read_b64_tr_b16 v[106:107], v23 offset:49664
    v_mfma_f32_16x16x32_bf16 v[124:127], v[28:31], v[96:99], v[124:127]
    s_waitcnt lgkmcnt(2)
    v_mfma_f32_32x32x16_bf16 v[80:95], v[100:103], a[100:103], v[80:95]
    ds_read_b64_tr_b16 v[108:109], v24 offset:49152
    ds_read_b64_tr_b16 v[110:111], v24 offset:49664
    buffer_load_dwordx4 v13, s[12:15], s71 offen offset:3072 lds
    v_mfma_f32_16x16x32_bf16 v[124:127], v[28:31], v[100:103], v[124:127]
    s_waitcnt lgkmcnt(2)
    v_mfma_f32_32x32x16_bf16 v[80:95], v[104:107], a[104:107], v[80:95]
    ds_read_b64_tr_b16 v[96:97], v21 offset:57344
    ds_read_b64_tr_b16 v[98:99], v21 offset:57856
    s_waitcnt lgkmcnt(2)
    v_mfma_f32_32x32x16_bf16 v[80:95], v[108:111], a[108:111], v[80:95]
    ds_read_b64_tr_b16 v[100:101], v22 offset:57344
    ds_read_b64_tr_b16 v[102:103], v22 offset:57856
    s_add_u32 m0, s73, 73728
    s_mov_b32 s71, 393216
    buffer_load_dwordx4 v10, s[12:15], s71 offen lds
    s_waitcnt lgkmcnt(2)
    v_mfma_f32_32x32x16_bf16 v[80:95], v[96:99], a[112:115], v[80:95]
    ds_read_b64_tr_b16 v[104:105], v23 offset:57344
    ds_read_b64_tr_b16 v[106:107], v23 offset:57856
    v_mfma_f32_16x16x32_bf16 v[124:127], v[28:31], v[96:99], v[124:127]
    s_waitcnt lgkmcnt(2)
    v_mfma_f32_32x32x16_bf16 v[80:95], v[100:103], a[116:119], v[80:95]
    ds_read_b64_tr_b16 v[108:109], v24 offset:57344
    ds_read_b64_tr_b16 v[110:111], v24 offset:57856
    buffer_load_dwordx4 v11, s[12:15], s71 offen offset:1024 lds
    v_mfma_f32_16x16x32_bf16 v[124:127], v[28:31], v[100:103], v[124:127]
    s_waitcnt lgkmcnt(2)
    v_mfma_f32_32x32x16_bf16 v[80:95], v[104:107], a[120:123], v[80:95]
    s_waitcnt lgkmcnt(0)
    v_mfma_f32_32x32x16_bf16 v[80:95], v[108:111], a[124:127], v[80:95]
    buffer_load_dwordx4 v12, s[12:15], s71 offen offset:2048 lds
    s_nop 2
    ds_write_b32 v27, v124 offset:512
    s_waitcnt lgkmcnt(0)
    s_barrier
    ds_read2_b32 v[140:141], v32 offset0:128 offset1:192
    s_waitcnt vmcnt(18)
    v_readfirstlane_b32 s66, v35
    s_nop 1
    s_cmp_eq_u32 s66, 0
    s_cbranch_scc1 L_nslow_1
L_nback_2:
    s_add_u32 s101, s101, s66
    s_waitcnt lgkmcnt(0)
    s_add_u32 s67, s101, 1
    v_mov_b32 v59, s67
    s_add_u32 s67, s66, 1
    v_mov_b32 v61, s67
    s_waitcnt vmcnt(4)
    buffer_store_dword v59, v55, s[36:39], 0 offen
    v_add_f32 v140, v140, v141
    v_cndmask_b32_e64 v140, v140, 0, s[86:87]
    v_and_b32 v141, 0xffff0000, v140
    v_sub_f32 v140, v140, v141
    v_lshrrev_b32 v137, 16, v141
    v_cvt_pk_bf16_f32 v136, v141, v140
    s_nop 1
    v_mfma_f32_32x32x16_bf16 v[80:95], v[136:139], v[132:135], v[80:95]
    s_movk_i32 s100, 0x4000
    s_lshr_b32 s68, s64, 2
    v_lshrrev_b32 v3, 4, v1
    v_cmp_eq_u32 vcc, s68, v3
    s_nop 1
    v_cndmask_b32_e64 v58, 0, 1, vcc
    v_lshlrev_b32 v6, 1, v58
    buffer_load_dword v57, v56, s[36:39], 0 offen sc1
    s_nop 2
    v_pk_mul_f32 v[144:145], v[80:81], v[80:81]
    v_pk_mul_f32 v[146:147], v[82:83], v[82:83]
    v_pk_mul_f32 v[148:149], v[84:85], v[84:85]
    v_pk_mul_f32 v[150:151], v[86:87], v[86:87]
    buffer_load_dwordx4 v13, s[12:15], s71 offen offset:3072 lds
    v_pk_fma_f32 v[144:145], v[144:145], v[128:129], v[128:129] op_sel:[0,1,0] op_sel_hi:[1,1,0]
    v_pk_fma_f32 v[146:147], v[146:147], v[128:129], v[128:129] op_sel:[0,1,0] op_sel_hi:[1,1,0]
    v_pk_fma_f32 v[148:149], v[148:149], v[128:129], v[128:129] op_sel:[0,1,0] op_sel_hi:[1,1,0]
    v_pk_fma_f32 v[150:151], v[150:151], v[128:129], v[128:129] op_sel:[0,1,0] op_sel_hi:[1,1,0]
    v_pk_mul_f32 v[144:145], v[144:145], v[80:81]
    v_pk_mul_f32 v[146:147], v[146:147], v[82:83]
    v_pk_mul_f32 v[148:149], v[148:149], v[84:85]
    v_pk_mul_f32 v[150:151], v[150:151], v[86:87]
    v_exp_f32 v144, v144
    v_exp_f32 v145, v145
    v_exp_f32 v146, v146
    v_exp_f32 v147, v147
    v_exp_f32 v148, v148
    v_exp_f32 v149, v149
    v_exp_f32 v150, v150
    v_exp_f32 v151, v151
    s_add_u32 m0, s73, 139264
    s_add_u32 s70, s0, 0x0
    buffer_load_dwordx4 v63, s[4:7], s70 offen lds
    v_pk_fma_f32 v[144:145], v[144:145], v[130:131], v[130:131] op_sel:[0,1,1] op_sel_hi:[1,1,1]
    v_pk_fma_f32 v[146:147], v[146:147], v[130:131], v[130:131] op_sel:[0,1,1] op_sel_hi:[1,1,1]
    v_pk_fma_f32 v[148:149], v[148:149], v[130:131], v[130:131] op_sel:[0,1,1] op_sel_hi:[1,1,1]
    v_pk_fma_f32 v[150:151], v[150:151], v[130:131], v[130:131] op_sel:[0,1,1] op_sel_hi:[1,1,1]
    v_rcp_f32 v144, v144
    v_rcp_f32 v145, v145
    v_rcp_f32 v146, v146
    v_rcp_f32 v147, v147
    v_rcp_f32 v148, v148
    v_rcp_f32 v149, v149
    v_rcp_f32 v150, v150
    v_rcp_f32 v151, v151
    buffer_load_dwordx4 v142, s[4:7], s70 offen offset:1024 lds
    v_pk_mul_f32 v[144:145], v[144:145], v[80:81]
    v_pk_mul_f32 v[146:147], v[146:147], v[82:83]
    v_pk_mul_f32 v[148:149], v[148:149], v[84:85]
    v_pk_mul_f32 v[150:151], v[150:151], v[86:87]
    v_cvt_pk_bf16_f32 v152, v144, v145
    v_cvt_pk_bf16_f32 v153, v146, v147
    v_cvt_pk_bf16_f32 v154, v148, v149
    v_cvt_pk_bf16_f32 v155, v150, v151
    buffer_store_dwordx4 v[152:155], v36, s[36:39], s100 offen sc1
    v_pk_mul_f32 v[144:145], v[88:89], v[88:89]
    v_pk_mul_f32 v[146:147], v[90:91], v[90:91]
    v_pk_mul_f32 v[148:149], v[92:93], v[92:93]
    v_pk_mul_f32 v[150:151], v[94:95], v[94:95]
    buffer_load_dwordx4 v143, s[4:7], s70 offen offset:2048 lds
    v_pk_fma_f32 v[144:145], v[144:145], v[128:129], v[128:129] op_sel:[0,1,0] op_sel_hi:[1,1,0]
    v_pk_fma_f32 v[146:147], v[146:147], v[128:129], v[128:129] op_sel:[0,1,0] op_sel_hi:[1,1,0]
    v_pk_fma_f32 v[148:149], v[148:149], v[128:129], v[128:129] op_sel:[0,1,0] op_sel_hi:[1,1,0]
    v_pk_fma_f32 v[150:151], v[150:151], v[128:129], v[128:129] op_sel:[0,1,0] op_sel_hi:[1,1,0]
    v_pk_mul_f32 v[144:145], v[144:145], v[88:89]
    v_pk_mul_f32 v[146:147], v[146:147], v[90:91]
    v_pk_mul_f32 v[148:149], v[148:149], v[92:93]
    v_pk_mul_f32 v[150:151], v[150:151], v[94:95]
    v_exp_f32 v144, v144
    v_exp_f32 v145, v145
    v_exp_f32 v146, v146
    v_exp_f32 v147, v147
    v_exp_f32 v148, v148
    v_exp_f32 v149, v149
    v_exp_f32 v150, v150
    v_exp_f32 v151, v151
    buffer_load_dwordx4 v160, s[4:7], s70 offen offset:3072 lds
    v_pk_fma_f32 v[144:145], v[144:145], v[130:131], v[130:131] op_sel:[0,1,1] op_sel_hi:[1,1,1]
    v_pk_fma_f32 v[146:147], v[146:147], v[130:131], v[130:131] op_sel:[0,1,1] op_sel_hi:[1,1,1]
    v_pk_fma_f32 v[148:149], v[148:149], v[130:131], v[130:131] op_sel:[0,1,1] op_sel_hi:[1,1,1]
    v_pk_fma_f32 v[150:151], v[150:151], v[130:131], v[130:131] op_sel:[0,1,1] op_sel_hi:[1,1,1]
    v_rcp_f32 v144, v144
    v_rcp_f32 v145, v145
    v_rcp_f32 v146, v146
    v_rcp_f32 v147, v147
    v_rcp_f32 v148, v148
    v_rcp_f32 v149, v149
    v_rcp_f32 v150, v150
    v_rcp_f32 v151, v151
    s_add_u32 m0, s73, 98304
    s_mov_b32 s71, 65536
    buffer_load_dwordx4 v10, s[12:15], s71 offen lds
    v_pk_mul_f32 v[144:145], v[144:145], v[88:89]
    v_pk_mul_f32 v[146:147], v[146:147], v[90:91]
    v_pk_mul_f32 v[148:149], v[148:149], v[92:93]
    v_pk_mul_f32 v[150:151], v[150:151], v[94:95]
    v_cvt_pk_bf16_f32 v156, v144, v145
    v_cvt_pk_bf16_f32 v157, v146, v147
    v_cvt_pk_bf16_f32 v158, v148, v149
    v_cvt_pk_bf16_f32 v159, v150, v151
    buffer_store_dwordx4 v[156:159], v36, s[36:39], s100 offen offset:1024 sc1
    s_waitcnt vmcnt(8)
    v_subrev_u32 v57, s101, v57
    v_cmp_gt_u32 vcc, 8, v57
    s_nop 1
    v_cndmask_b32 v57, 0, v57, vcc
    v_cmp_lt_u32 vcc, v57, v58
    s_nop 1
    s_cbranch_vccnz L_slow_3
L_back_4:
    s_add_u32 m0, s72, 0
    s_mov_b32 s70, 0
    buffer_load_dwordx4 v38, s[36:39], s70 offen sc1 lds
    buffer_load_dwordx4 v38, s[36:39], s70 offen offset:1024 sc1 lds
    s_add_u32 m0, s72, 24576
    s_mov_b32 s70, 4096
    buffer_load_dwordx4 v38, s[36:39], s70 offen sc1 lds
    buffer_load_dwordx4 v38, s[36:39], s70 offen offset:1024 sc1 lds
    s_add_u32 m0, s72, 49152
    s_mov_b32 s70, 8192
    buffer_load_dwordx4 v38, s[36:39], s70 offen sc1 lds
    buffer_load_dwordx4 v38, s[36:39], s70 offen offset:1024 sc1 lds
    s_add_u32 m0, s72, 73728
    s_mov_b32 s70, 12288
    buffer_load_dwordx4 v38, s[36:39], s70 offen sc1 lds
    buffer_load_dwordx4 v38, s[36:39], s70 offen offset:1024 sc1 lds
    s_add_u32 s67, s101, 2
    v_mov_b32 v59, s67
    s_add_u32 s67, s66, 2
    v_mov_b32 v61, s67
    s_waitcnt vmcnt(8)
    buffer_store_dword v59, v55, s[36:39], 0 offen
    s_waitcnt vmcnt(7)
    s_barrier
    ds_read_b128 v[180:183], v39
    ds_read_b64_tr_b16 v[184:185], v42
    ds_read_b64_tr_b16 v[186:187], v42 offset:2048
    ds_read_b64_tr_b16 v[188:189], v43
    ds_read_b64_tr_b16 v[190:191], v43 offset:2048
    ds_read_b128 v[192:195], v39 offset:1024
    ds_read_b64_tr_b16 v[196:197], v42 offset:4096
    ds_read_b64_tr_b16 v[198:199], v42 offset:6144
    ds_read_b64_tr_b16 v[200:201], v43 offset:4096
    ds_read_b64_tr_b16 v[202:203], v43 offset:6144
    s_waitcnt lgkmcnt(7)
    v_mfma_f32_32x32x16_bf16 v[64:79], v[184:187], v[180:183], 0
    ds_read_b128 v[204:207], v39 offset:2048
    ds_read_b64_tr_b16 v[208:209], v42 offset:8192
    ds_read_b64_tr_b16 v[210:211], v42 offset:10240
    s_add_u32 m0, s73, 98304
    s_nop 0
    buffer_load_dwordx4 v11, s[12:15], s71 offen offset:1024 lds
    s_waitcnt lgkmcnt(8)
    v_mfma_f32_32x32x16_bf16 v[80:95], v[188:191], v[180:183], 0
    ds_read_b64_tr_b16 v[212:213], v43 offset:8192
    ds_read_b64_tr_b16 v[214:215], v43 offset:10240
    ds_read_b128 v[216:219], v39 offset:3072
    buffer_load_dwordx4 v12, s[12:15], s71 offen offset:2048 lds
    s_waitcnt lgkmcnt(8)
    v_mfma_f32_32x32x16_bf16 v[64:79], v[196:199], v[192:195], v[64:79]
    ds_read_b64_tr_b16 v[220:221], v42 offset:12288
    ds_read_b64_tr_b16 v[222:223], v42 offset:14336
    ds_read_b64_tr_b16 v[224:225], v43 offset:12288
    buffer_load_dwordx4 v13, s[12:15], s71 offen offset:3072 lds
    s_waitcnt lgkmcnt(9)
    v_mfma_f32_32x32x16_bf16 v[80:95], v[200:203], v[192:195], v[80:95]
    ds_read_b64_tr_b16 v[226:227], v43 offset:14336
    s_add_u32 m0, s73, 122880
    s_mov_b32 s71, 196608
    buffer_load_dwordx4 v10, s[12:15], s71 offen lds
    s_waitcnt vmcnt(9)
    s_barrier
    s_waitcnt lgkmcnt(7)
    v_mfma_f32_32x32x16_bf16 v[64:79], v[208:211], v[204:207], v[64:79]
    ds_read_b128 v[180:183], v39 offset:24576
    ds_read_b64_tr_b16 v[184:185], v42 offset:24576
    ds_read_b64_tr_b16 v[186:187], v42 offset:26624
    buffer_load_dwordx4 v11, s[12:15], s71 offen offset:1024 lds
    s_waitcnt lgkmcnt(8)
    v_mfma_f32_32x32x16_bf16 v[80:95], v[212:215], v[204:207], v[80:95]
    ds_read_b64_tr_b16 v[188:189], v43 offset:24576
    ds_read_b64_tr_b16 v[190:191], v43 offset:26624
    ds_read_b128 v[192:195], v39 offset:25600
    buffer_load_dwordx4 v12, s[12:15], s71 offen offset:2048 lds
    s_waitcnt lgkmcnt(8)
    v_mfma_f32_32x32x16_bf16 v[64:79], v[220:223], v[216:219], v[64:79]
    ds_read_b64_tr_b16 v[196:197], v42 offset:28672
    ds_read_b64_tr_b16 v[198:199], v42 offset:30720
    ds_read_b64_tr_b16 v[200:201], v43 offset:28672
    buffer_load_dwordx4 v13, s[12:15], s71 offen offset:3072 lds
    buffer_load_dword v57, v56, s[36:39], 0 offen sc1
    s_waitcnt lgkmcnt(9)
    v_mfma_f32_32x32x16_bf16 v[80:95], v[224:227], v[216:219], v[80:95]
    ds_read_b64_tr_b16 v[202:203], v43 offset:30720
    s_waitcnt vmcnt(11)
    s_barrier
    s_waitcnt lgkmcnt(7)
    v_mfma_f32_32x32x16_bf16 v[64:79], v[184:187], v[180:183], v[64:79]
    ds_read_b128 v[204:207], v39 offset:26624
    ds_read_b64_tr_b16 v[208:209], v42 offset:32768
    ds_read_b64_tr_b16 v[210:211], v42 offset:34816
    s_add_u32 m0, s73, 0
    s_mov_b32 s71, 327680
    buffer_load_dwordx4 v10, s[12:15], s71 offen lds
    s_waitcnt lgkmcnt(8)
    v_mfma_f32_32x32x16_bf16 v[80:95], v[188:191], v[180:183], v[80:95]
    ds_read_b64_tr_b16 v[212:213], v43 offset:32768
    ds_read_b64_tr_b16 v[214:215], v43 offset:34816
    ds_read_b128 v[216:219], v39 offset:27648
    buffer_load_dwordx4 v11, s[12:15], s71 offen offset:1024 lds
    s_waitcnt lgkmcnt(8)
    v_mfma_f32_32x32x16_bf16 v[64:79], v[196:199], v[192:195], v[64:79]
    ds_read_b64_tr_b16 v[220:221], v42 offset:36864
    ds_read_b64_tr_b16 v[222:223], v42 offset:38912
    ds_read_b64_tr_b16 v[224:225], v43 offset:36864
    buffer_load_dwordx4 v12, s[12:15], s71 offen offset:2048 lds
    s_waitcnt lgkmcnt(9)
    v_mfma_f32_32x32x16_bf16 v[80:95], v[200:203], v[192:195], v[80:95]
    ds_read_b64_tr_b16 v[226:227], v43 offset:38912
    v_add_u32 v39, 0xc000, v39
    v_add_u32 v42, 0xc000, v42
    v_add_u32 v43, 0xc000, v43
    buffer_load_dwordx4 v13, s[12:15], s71 offen offset:3072 lds
    s_waitcnt vmcnt(4)
    v_subrev_u32 v57, s101, v57
    v_cmp_gt_u32 vcc, 8, v57
    s_nop 1
    v_cndmask_b32 v57, 0, v57, vcc
    s_cmp_eq_u64 vcc, -1
    s_cselect_b32 s1, 1, s1
    v_cmp_lt_u32 vcc, v57, v6
    s_nop 1
    s_cbranch_vccnz L_slow_6
L_back_7:
    s_waitcnt lgkmcnt(7)
    v_mfma_f32_32x32x16_bf16 v[64:79], v[208:211], v[204:207], v[64:79]
    ds_read_b128 v[180:183], v39
    ds_read_b64_tr_b16 v[184:185], v42
    ds_read_b64_tr_b16 v[186:187], v42 offset:2048
    s_waitcnt lgkmcnt(8)
    v_mfma_f32_32x32x16_bf16 v[80:95], v[212:215], v[204:207], v[80:95]
    ds_read_b64_tr_b16 v[188:189], v43
    ds_read_b64_tr_b16 v[190:191], v43 offset:2048
    ds_read_b128 v[192:195], v39 offset:1024
    s_waitcnt lgkmcnt(8)
    v_mfma_f32_32x32x16_bf16 v[64:79], v[220:223], v[216:219], v[64:79]
    ds_read_b64_tr_b16 v[196:197], v42 offset:4096
    ds_read_b64_tr_b16 v[198:199], v42 offset:6144
    ds_read_b64_tr_b16 v[200:201], v43 offset:4096
    s_add_u32 m0, s72, 98304
    s_mov_b32 s70, 16384
    buffer_load_dwordx4 v38, s[36:39], s70 offen sc1 lds
    s_waitcnt lgkmcnt(9)
    v_mfma_f32_32x32x16_bf16 v[80:95], v[224:227], v[216:219], v[80:95]
    ds_read_b64_tr_b16 v[202:203], v43 offset:6144
    buffer_load_dwordx4 v38, s[36:39], s70 offen offset:1024 sc1 lds
    s_barrier
    s_waitcnt lgkmcnt(7)
    v_mfma_f32_32x32x16_bf16 v[64:79], v[184:187], v[180:183], v[64:79]
    ds_read_b128 v[204:207], v39 offset:2048
    ds_read_b64_tr_b16 v[208:209], v42 offset:8192
    ds_read_b64_tr_b16 v[210:211], v42 offset:10240
    s_mov_b32 s70, 15794176
    buffer_load_dword v9, v40, s[36:39], s70 offen sc1
    s_waitcnt lgkmcnt(8)
    v_mfma_f32_32x32x16_bf16 v[80:95], v[188:191], v[180:183], v[80:95]
    ds_read_b64_tr_b16 v[212:213], v43 offset:8192
    ds_read_b64_tr_b16 v[214:215], v43 offset:10240
    ds_read_b128 v[216:219], v39 offset:3072
    s_mov_b32 s70, 15802368
    buffer_load_dword v8, v40, s[36:39], s70 offen sc1
    s_waitcnt lgkmcnt(8)
    v_mfma_f32_32x32x16_bf16 v[64:79], v[196:199], v[192:195], v[64:79]
    ds_read_b64_tr_b16 v[220:221], v42 offset:12288
    ds_read_b64_tr_b16 v[222:223], v42 offset:14336
    ds_read_b64_tr_b16 v[224:225], v43 offset:12288
    s_add_u32 m0, s72, 122880
    s_mov_b32 s70, 20480
    buffer_load_dwordx4 v38, s[36:39], s70 offen sc1 lds
    s_waitcnt lgkmcnt(9)
    v_mfma_f32_32x32x16_bf16 v[80:95], v[200:203], v[192:195], v[80:95]
    ds_read_b64_tr_b16 v[226:227], v43 offset:14336
    buffer_load_dwordx4 v38, s[36:39], s70 offen offset:1024 sc1 lds
    s_waitcnt lgkmcnt(7)
    v_mfma_f32_32x32x16_bf16 v[64:79], v[208:211], v[204:207], v[64:79]
    ds_read_b128 v[180:183], v39 offset:24576
    ds_read_b64_tr_b16 v[184:185], v42 offset:24576
    ds_read_b64_tr_b16 v[186:187], v42 offset:26624
    s_add_u32 m0, s72, 0
    s_mov_b32 s70, 24576
    buffer_load_dwordx4 v38, s[36:39], s70 offen sc1 lds
    s_waitcnt lgkmcnt(8)
    v_mfma_f32_32x32x16_bf16 v[80:95], v[212:215], v[204:207], v[80:95]
    ds_read_b64_tr_b16 v[188:189], v43 offset:24576
    ds_read_b64_tr_b16 v[190:191], v43 offset:26624
    ds_read_b128 v[192:195], v39 offset:25600
    buffer_load_dwordx4 v38, s[36:39], s70 offen offset:1024 sc1 lds
    s_waitcnt lgkmcnt(8)
    v_mfma_f32_32x32x16_bf16 v[64:79], v[220:223], v[216:219], v[64:79]
    ds_read_b64_tr_b16 v[196:197], v42 offset:28672
    ds_read_b64_tr_b16 v[198:199], v42 offset:30720
    ds_read_b64_tr_b16 v[200:201], v43 offset:28672
    s_add_u32 m0, s72, 24576
    s_mov_b32 s70, 28672
    buffer_load_dwordx4 v38, s[36:39], s70 offen sc1 lds
    s_waitcnt lgkmcnt(9)
    v_mfma_f32_32x32x16_bf16 v[80:95], v[224:227], v[216:219], v[80:95]
    ds_read_b64_tr_b16 v[202:203], v43 offset:30720
    buffer_load_dwordx4 v38, s[36:39], s70 offen offset:1024 sc1 lds
    s_waitcnt vmcnt(8)
    s_barrier
    s_waitcnt lgkmcnt(7)
    v_mfma_f32_32x32x16_bf16 v[64:79], v[184:187], v[180:183], v[64:79]
    ds_read_b128 v[204:207], v39 offset:26624
    ds_read_b64_tr_b16 v[208:209], v42 offset:32768
    ds_read_b64_tr_b16 v[210:211], v42 offset:34816
    s_add_u32 m0, s73, 24576
    s_mov_b32 s71, 458752
    buffer_load_dwordx4 v10, s[12:15], s71 offen lds
    s_waitcnt lgkmcnt(8)
    v_mfma_f32_32x32x16_bf16 v[80:95], v[188:191], v[180:183], v[80:95]
    ds_read_b64_tr_b16 v[212:213], v43 offset:32768
    ds_read_b64_tr_b16 v[214:215], v43 offset:34816
    ds_read_b128 v[216:219], v39 offset:27648
    buffer_load_dwordx4 v11, s[12:15], s71 offen offset:1024 lds
    s_waitcnt lgkmcnt(8)
    v_mfma_f32_32x32x16_bf16 v[64:79], v[196:199], v[192:195], v[64:79]
    ds_read_b64_tr_b16 v[220:221], v42 offset:36864
    ds_read_b64_tr_b16 v[222:223], v42 offset:38912
    ds_read_b64_tr_b16 v[224:225], v43 offset:36864
    buffer_load_dwordx4 v12, s[12:15], s71 offen offset:2048 lds
    s_waitcnt lgkmcnt(9)
    v_mfma_f32_32x32x16_bf16 v[80:95], v[200:203], v[192:195], v[80:95]
    ds_read_b64_tr_b16 v[226:227], v43 offset:38912
    v_add_u32 v39, 0xc000, v39
    v_add_u32 v42, 0xc000, v42
    v_add_u32 v43, 0xc000, v43
    buffer_load_dwordx4 v13, s[12:15], s71 offen offset:3072 lds
    v_xor_b32 v3, 0, v45
    v_lshl_add_u32 v3, v3, 4, v44
    ds_read_b64 v[164:165], v3
    v_xor_b32 v3, 1, v45
    v_lshl_add_u32 v3, v3, 4, v44
    ds_read_b64 v[166:167], v3
    v_xor_b32 v3, 2, v45
    v_lshl_add_u32 v3, v3, 4, v44
    ds_read_b64 v[168:169], v3
    v_xor_b32 v3, 3, v45
    v_lshl_add_u32 v3, v3, 4, v44
    ds_read_b64 v[170:171], v3
    v_xor_b32 v3, 4, v45
    v_lshl_add_u32 v3, v3, 4, v44
    ds_read_b64 v[172:173], v3
    v_xor_b32 v3, 5, v45
    v_lshl_add_u32 v3, v3, 4, v44
    ds_read_b64 v[174:175], v3
    v_xor_b32 v3, 6, v45
    v_lshl_add_u32 v3, v3, 4, v44
    ds_read_b64 v[176:177], v3
    v_xor_b32 v3, 7, v45
    v_lshl_add_u32 v3, v3, 4, v44
    ds_read_b64 v[178:179], v3
    s_waitcnt lgkmcnt(15)
    v_mfma_f32_32x32x16_bf16 v[64:79], v[208:211], v[204:207], v[64:79]
    ds_read_b128 v[180:183], v39
    ds_read_b64_tr_b16 v[184:185], v42
    ds_read_b64_tr_b16 v[186:187], v42 offset:2048
    s_waitcnt lgkmcnt(15)
    v_mfma_f32_32x32x16_bf16 v[80:95], v[212:215], v[204:207], v[80:95]
    ds_read_b64_tr_b16 v[188:189], v43
    ds_read_b64_tr_b16 v[190:191], v43 offset:2048
    ds_read_b128 v[192:195], v39 offset:1024
    s_waitcnt lgkmcnt(15)
    v_mfma_f32_32x32x16_bf16 v[64:79], v[220:223], v[216:219], v[64:79]
    ds_read_b64_tr_b16 v[196:197], v42 offset:4096
    ds_read_b64_tr_b16 v[198:199], v42 offset:6144
    ds_read_b64_tr_b16 v[200:201], v43 offset:4096
    s_waitcnt lgkmcnt(15)
    v_mfma_f32_32x32x16_bf16 v[80:95], v[224:227], v[216:219], v[80:95]
    ds_read_b64_tr_b16 v[202:203], v43 offset:6144
    s_waitcnt vmcnt(8)
    s_barrier
    s_waitcnt lgkmcnt(7)
    v_mfma_f32_32x32x16_bf16 v[64:79], v[184:187], v[180:183], v[64:79]
    ds_read_b128 v[204:207], v39 offset:2048
    ds_read_b64_tr_b16 v[208:209], v42 offset:8192
    ds_read_b64_tr_b16 v[210:211], v42 offset:10240
    s_waitcnt lgkmcnt(8)
    v_mfma_f32_32x32x16_bf16 v[80:95], v[188:191], v[180:183], v[80:95]
    ds_read_b64_tr_b16 v[212:213], v43 offset:8192
    ds_read_b64_tr_b16 v[214:215], v43 offset:10240
    ds_read_b128 v[216:219], v39 offset:3072
    s_add_u32 m0, s72, 49152
    s_mov_b32 s71, 0
    buffer_load_dwordx4 v46, s[16:19], s71 offen lds
    s_waitcnt lgkmcnt(8)
    v_mfma_f32_32x32x16_bf16 v[64:79], v[196:199], v[192:195], v[64:79]
    ds_read_b64_tr_b16 v[220:221], v42 offset:12288
    ds_read_b64_tr_b16 v[222:223], v42 offset:14336
    ds_read_b64_tr_b16 v[224:225], v43 offset:12288
    buffer_load_dwordx4 v47, s[16:19], s71 offen offset:1024 lds
    s_waitcnt lgkmcnt(9)
    v_mfma_f32_32x32x16_bf16 v[80:95], v[200:203], v[192:195], v[80:95]
    ds_read_b64_tr_b16 v[226:227], v43 offset:14336
    s_add_u32 m0, s72, 57344
    s_mov_b32 s71, 229376
    buffer_load_dwordx4 v46, s[16:19], s71 offen lds
    s_waitcnt lgkmcnt(7)
    v_mfma_f32_32x32x16_bf16 v[64:79], v[208:211], v[204:207], v[64:79]
    ds_read_b128 v[180:183], v39 offset:24576
    ds_read_b64_tr_b16 v[184:185], v42 offset:24576
    ds_read_b64_tr_b16 v[186:187], v42 offset:26624
    buffer_load_dwordx4 v47, s[16:19], s71 offen offset:1024 lds
    s_waitcnt lgkmcnt(8)
    v_mfma_f32_32x32x16_bf16 v[80:95], v[212:215], v[204:207], v[80:95]
    ds_read_b64_tr_b16 v[188:189], v43 offset:24576
    ds_read_b64_tr_b16 v[190:191], v43 offset:26624
    ds_read_b128 v[192:195], v39 offset:25600
    s_add_u32 m0, s72, 65536
    s_mov_b32 s71, 458752
    buffer_load_dwordx4 v46, s[16:19], s71 offen lds
    s_waitcnt lgkmcnt(8)
    v_mfma_f32_32x32x16_bf16 v[64:79], v[220:223], v[216:219], v[64:79]
    ds_read_b64_tr_b16 v[196:197], v42 offset:28672
    ds_read_b64_tr_b16 v[198:199], v42 offset:30720
    ds_read_b64_tr_b16 v[200:201], v43 offset:28672
    buffer_load_dwordx4 v47, s[16:19], s71 offen offset:1024 lds
    s_waitcnt lgkmcnt(9)
    v_mfma_f32_32x32x16_bf16 v[80:95], v[224:227], v[216:219], v[80:95]
    ds_read_b64_tr_b16 v[202:203], v43 offset:30720
    s_add_u32 m0, s72, 73728
    s_mov_b32 s71, 688128
    buffer_load_dwordx4 v46, s[16:19], s71 offen lds
    s_waitcnt vmcnt(13)
    s_barrier
    s_waitcnt lgkmcnt(7)
    v_mfma_f32_32x32x16_bf16 v[64:79], v[184:187], v[180:183], v[64:79]
    ds_read_b128 v[204:207], v39 offset:26624
    ds_read_b64_tr_b16 v[208:209], v42 offset:32768
    ds_read_b64_tr_b16 v[210:211], v42 offset:34816
    buffer_load_dwordx4 v47, s[16:19], s71 offen offset:1024 lds
    s_waitcnt lgkmcnt(8)
    v_mfma_f32_32x32x16_bf16 v[80:95], v[188:191], v[180:183], v[80:95]
    ds_read_b64_tr_b16 v[212:213], v43 offset:32768
    ds_read_b64_tr_b16 v[214:215], v43 offset:34816
    ds_read_b128 v[216:219], v39 offset:27648
    s_add_u32 m0, s72, 81920
    s_mov_b32 s71, 917504
    buffer_load_dwordx4 v46, s[16:19], s71 offen lds
    s_waitcnt lgkmcnt(8)
    v_mfma_f32_32x32x16_bf16 v[64:79], v[196:199], v[192:195], v[64:79]
    ds_read_b64_tr_b16 v[220:221], v42 offset:36864
    ds_read_b64_tr_b16 v[222:223], v42 offset:38912
    ds_read_b64_tr_b16 v[224:225], v43 offset:36864
    buffer_load_dwordx4 v47, s[16:19], s71 offen offset:1024 lds
    s_waitcnt lgkmcnt(9)
    v_mfma_f32_32x32x16_bf16 v[80:95], v[200:203], v[192:195], v[80:95]
    ds_read_b64_tr_b16 v[226:227], v43 offset:38912
    v_add_u32 v39, 0xfffe8000, v39
    v_add_u32 v42, 0xfffe8000, v42
    v_add_u32 v43, 0xfffe8000, v43
    s_add_u32 m0, s72, 90112
    s_mov_b32 s71, 1146880
    buffer_load_dwordx4 v46, s[16:19], s71 offen lds
    s_waitcnt lgkmcnt(7)
    v_mfma_f32_32x32x16_bf16 v[64:79], v[208:211], v[204:207], v[64:79]
    ds_read_b128 v[180:183], v39
    ds_read_b64_tr_b16 v[184:185], v42
    ds_read_b64_tr_b16 v[186:187], v42 offset:2048
    buffer_load_dwordx4 v47, s[16:19], s71 offen offset:1024 lds
    v_mul_f32 v9, v9, v8
    v_lshlrev_b32 v96, 16, v164
    v_and_b32 v97, 0xffff0000, v164
    s_waitcnt lgkmcnt(8)
    v_mfma_f32_32x32x16_bf16 v[80:95], v[212:215], v[204:207], v[80:95]
    ds_read_b64_tr_b16 v[188:189], v43
    ds_read_b64_tr_b16 v[190:191], v43 offset:2048
    ds_read_b128 v[192:195], v39 offset:1024
    v_fma_f32 v96, v96, v8, -v9
    v_fma_f32 v97, v97, v8, -v9
    v_lshlrev_b32 v98, 16, v165
    v_and_b32 v99, 0xffff0000, v165
    s_waitcnt lgkmcnt(8)
    v_mfma_f32_32x32x16_bf16 v[64:79], v[220:223], v[216:219], v[64:79]
    ds_read_b64_tr_b16 v[196:197], v42 offset:4096
    ds_read_b64_tr_b16 v[198:199], v42 offset:6144
    ds_read_b64_tr_b16 v[200:201], v43 offset:4096
    v_fma_f32 v98, v98, v8, -v9
    v_fma_f32 v99, v99, v8, -v9
    v_lshlrev_b32 v100, 16, v166
    v_and_b32 v101, 0xffff0000, v166
    s_waitcnt lgkmcnt(9)
    v_mfma_f32_32x32x16_bf16 v[80:95], v[224:227], v[216:219], v[80:95]
    ds_read_b64_tr_b16 v[202:203], v43 offset:6144
    v_fma_f32 v100, v100, v8, -v9
    v_fma_f32 v101, v101, v8, -v9
    v_lshlrev_b32 v102, 16, v167
    v_and_b32 v103, 0xffff0000, v167
    v_fma_f32 v102, v102, v8, -v9
    v_fma_f32 v103, v103, v8, -v9
    s_waitcnt vmcnt(12)
    s_barrier
    s_waitcnt lgkmcnt(7)
    v_mfma_f32_32x32x16_bf16 v[64:79], v[184:187], v[180:183], v[64:79]
    ds_read_b128 v[204:207], v39 offset:2048
    ds_read_b64_tr_b16 v[208:209], v42 offset:8192
    ds_read_b64_tr_b16 v[210:211], v42 offset:10240
    v_lshlrev_b32 v104, 16, v168
    v_and_b32 v105, 0xffff0000, v168
    v_fma_f32 v104, v104, v8, -v9
    v_fma_f32 v105, v105, v8, -v9
    s_waitcnt lgkmcnt(8)
    v_mfma_f32_32x32x16_bf16 v[80:95], v[188:191], v[180:183], v[80:95]
    ds_read_b64_tr_b16 v[212:213], v43 offset:8192
    ds_read_b64_tr_b16 v[214:215], v43 offset:10240
    ds_read_b128 v[216:219], v39 offset:3072
    v_lshlrev_b32 v106, 16, v169
    v_and_b32 v107, 0xffff0000, v169
    v_fma_f32 v106, v106, v8, -v9
    v_fma_f32 v107, v107, v8, -v9
    s_waitcnt lgkmcnt(8)
    v_mfma_f32_32x32x16_bf16 v[64:79], v[196:199], v[192:195], v[64:79]
    ds_read_b64_tr_b16 v[220:221], v42 offset:12288
    ds_read_b64_tr_b16 v[222:223], v42 offset:14336
    ds_read_b64_tr_b16 v[224:225], v43 offset:12288
    v_lshlrev_b32 v108, 16, v170
    v_and_b32 v109, 0xffff0000, v170
    v_fma_f32 v108, v108, v8, -v9
    v_fma_f32 v109, v109, v8, -v9
    s_waitcnt lgkmcnt(9)
    v_mfma_f32_32x32x16_bf16 v[80:95], v[200:203], v[192:195], v[80:95]
    ds_read_b64_tr_b16 v[226:227], v43 offset:14336
    v_lshlrev_b32 v110, 16, v171
    v_and_b32 v111, 0xffff0000, v171
    v_fma_f32 v110, v110, v8, -v9
    v_fma_f32 v111, v111, v8, -v9
    v_lshlrev_b32 v112, 16, v172
    v_and_b32 v113, 0xffff0000, v172
    s_waitcnt lgkmcnt(7)
    v_mfma_f32_32x32x16_bf16 v[64:79], v[208:211], v[204:207], v[64:79]
    ds_read_b128 v[180:183], v39 offset:24576
    ds_read_b64_tr_b16 v[184:185], v42 offset:24576
    ds_read_b64_tr_b16 v[186:187], v42 offset:26624
    v_fma_f32 v112, v112, v8, -v9
    v_fma_f32 v113, v113, v8, -v9
    v_lshlrev_b32 v114, 16, v173
    v_and_b32 v115, 0xffff0000, v173
    s_waitcnt lgkmcnt(8)
    v_mfma_f32_32x32x16_bf16 v[80:95], v[212:215], v[204:207], v[80:95]
    ds_read_b64_tr_b16 v[188:189], v43 offset:24576
    ds_read_b64_tr_b16 v[190:191], v43 offset:26624
    ds_read_b128 v[192:195], v39 offset:25600
    v_fma_f32 v114, v114, v8, -v9
    v_fma_f32 v115, v115, v8, -v9
    v_lshlrev_b32 v116, 16, v174
    v_and_b32 v117, 0xffff0000, v174
    s_waitcnt lgkmcnt(8)
    v_mfma_f32_32x32x16_bf16 v[64:79], v[220:223], v[216:219], v[64:79]
    ds_read_b64_tr_b16 v[196:197], v42 offset:28672
    ds_read_b64_tr_b16 v[198:199], v42 offset:30720
    ds_read_b64_tr_b16 v[200:201], v43 offset:28672
    v_fma_f32 v116, v116, v8, -v9
    v_fma_f32 v117, v117, v8, -v9
    v_lshlrev_b32 v118, 16, v175
    v_and_b32 v119, 0xffff0000, v175
    s_waitcnt lgkmcnt(9)
    v_mfma_f32_32x32x16_bf16 v[80:95], v[224:227], v[216:219], v[80:95]
    ds_read_b64_tr_b16 v[202:203], v43 offset:30720
    v_fma_f32 v118, v118, v8, -v9
    v_fma_f32 v119, v119, v8, -v9
    v_lshlrev_b32 v120, 16, v176
    v_and_b32 v121, 0xffff0000, v176
    v_fma_f32 v120, v120, v8, -v9
    v_fma_f32 v121, v121, v8, -v9
    s_barrier
    s_waitcnt lgkmcnt(7)
    v_mfma_f32_32x32x16_bf16 v[64:79], v[184:187], v[180:183], v[64:79]
    ds_read_b128 v[204:207], v39 offset:26624
    ds_read_b64_tr_b16 v[208:209], v42 offset:32768
    ds_read_b64_tr_b16 v[210:211], v42 offset:34816
    v_lshlrev_b32 v122, 16, v177
    v_and_b32 v123, 0xffff0000, v177
    v_fma_f32 v122, v122, v8, -v9
    v_fma_f32 v123, v123, v8, -v9
    s_waitcnt lgkmcnt(8)
    v_mfma_f32_32x32x16_bf16 v[80:95], v[188:191], v[180:183], v[80:95]
    ds_read_b64_tr_b16 v[212:213], v43 offset:32768
    ds_read_b64_tr_b16 v[214:215], v43 offset:34816
    ds_read_b128 v[216:219], v39 offset:27648
    v_lshlrev_b32 v124, 16, v178
    v_and_b32 v125, 0xffff0000, v178
    v_fma_f32 v124, v124, v8, -v9
    v_fma_f32 v125, v125, v8, -v9
    s_waitcnt lgkmcnt(8)
    v_mfma_f32_32x32x16_bf16 v[64:79], v[196:199], v[192:195], v[64:79]
    ds_read_b64_tr_b16 v[220:221], v42 offset:36864
    ds_read_b64_tr_b16 v[222:223], v42 offset:38912
    ds_read_b64_tr_b16 v[224:225], v43 offset:36864
    v_lshlrev_b32 v126, 16, v179
    v_and_b32 v127, 0xffff0000, v179
    v_fma_f32 v126, v126, v8, -v9
    v_fma_f32 v127, v127, v8, -v9
    s_waitcnt lgkmcnt(9)
    v_mfma_f32_32x32x16_bf16 v[80:95], v[200:203], v[192:195], v[80:95]
    ds_read_b64_tr_b16 v[226:227], v43 offset:38912
    s_add_u32 m0, s72, 98304
    s_mov_b32 s71, 1376256
    buffer_load_dwordx4 v46, s[16:19], s71 offen lds
    s_waitcnt lgkmcnt(7)
    v_mfma_f32_32x32x16_bf16 v[64:79], v[208:211], v[204:207], v[64:79]
    buffer_load_dwordx4 v47, s[16:19], s71 offen offset:1024 lds
    s_waitcnt lgkmcnt(5)
    v_mfma_f32_32x32x16_bf16 v[80:95], v[212:215], v[204:207], v[80:95]
    s_add_u32 m0, s72, 106496
    s_mov_b32 s71, 1605632
    buffer_load_dwordx4 v46, s[16:19], s71 offen lds
    s_waitcnt lgkmcnt(2)
    v_mfma_f32_32x32x16_bf16 v[64:79], v[220:223], v[216:219], v[64:79]
    buffer_load_dwordx4 v47, s[16:19], s71 offen offset:1024 lds
    s_waitcnt lgkmcnt(0)
    v_mfma_f32_32x32x16_bf16 v[80:95], v[224:227], v[216:219], v[80:95]
    s_mov_b32 s70, 2097152
    s_nop 7
    v_pk_add_f32 v[64:65], v[96:97], v[64:65]
    v_pk_add_f32 v[66:67], v[98:99], v[66:67]
    v_pk_add_f32 v[68:69], v[100:101], v[68:69]
    v_pk_add_f32 v[70:71], v[102:103], v[70:71]
    v_cvt_pk_bf16_f32 v152, v64, v65
    v_cvt_pk_bf16_f32 v153, v66, v67
    v_cvt_pk_bf16_f32 v154, v68, v69
    v_cvt_pk_bf16_f32 v155, v70, v71
    buffer_store_dwordx4 v[152:155], v33, s[36:39], s70 offen sc1
    v_pk_add_f32 v[72:73], v[104:105], v[72:73]
    v_pk_add_f32 v[74:75], v[106:107], v[74:75]
    v_pk_add_f32 v[76:77], v[108:109], v[76:77]
    v_pk_add_f32 v[78:79], v[110:111], v[78:79]
    v_cvt_pk_bf16_f32 v156, v72, v73
    v_cvt_pk_bf16_f32 v157, v74, v75
    v_cvt_pk_bf16_f32 v158, v76, v77
    v_cvt_pk_bf16_f32 v159, v78, v79
    buffer_store_dwordx4 v[156:159], v33, s[36:39], s70 offen offset:1024 sc1
    v_pk_add_f32 v[80:81], v[112:113], v[80:81]
    v_pk_add_f32 v[82:83], v[114:115], v[82:83]
    v_pk_add_f32 v[84:85], v[116:117], v[84:85]
    v_pk_add_f32 v[86:87], v[118:119], v[86:87]
    v_cvt_pk_bf16_f32 v24, v80, v81
    v_cvt_pk_bf16_f32 v25, v82, v83
    v_cvt_pk_bf16_f32 v26, v84, v85
    v_cvt_pk_bf16_f32 v27, v86, v87
    buffer_store_dwordx4 v[24:27], v33, s[36:39], s70 offen offset:2048 sc1
    v_pk_add_f32 v[88:89], v[120:121], v[88:89]
    v_pk_add_f32 v[90:91], v[122:123], v[90:91]
    v_pk_add_f32 v[92:93], v[124:125], v[92:93]
    v_pk_add_f32 v[94:95], v[126:127], v[94:95]
    v_cvt_pk_bf16_f32 v128, v88, v89
    v_cvt_pk_bf16_f32 v129, v90, v91
    v_cvt_pk_bf16_f32 v130, v92, v93
    v_cvt_pk_bf16_f32 v131, v94, v95
    buffer_store_dwordx4 v[128:131], v33, s[36:39], s70 offen offset:3072 sc1
    v_pk_mul_f32 v[22:23], v[64:65], v[64:65]
    v_pk_add_f32 v[20:21], v[64:65], v[66:67]
    v_pk_fma_f32 v[22:23], v[66:67], v[66:67], v[22:23]
    v_pk_add_f32 v[20:21], v[20:21], v[68:69]
    v_pk_fma_f32 v[22:23], v[68:69], v[68:69], v[22:23]
    v_pk_add_f32 v[20:21], v[20:21], v[70:71]
    v_pk_fma_f32 v[22:23], v[70:71], v[70:71], v[22:23]
    v_pk_add_f32 v[20:21], v[20:21], v[72:73]
    v_pk_fma_f32 v[22:23], v[72:73], v[72:73], v[22:23]
    v_pk_add_f32 v[20:21], v[20:21], v[74:75]
    v_pk_fma_f32 v[22:23], v[74:75], v[74:75], v[22:23]
    v_pk_add_f32 v[20:21], v[20:21], v[76:77]
    v_pk_fma_f32 v[22:23], v[76:77], v[76:77], v[22:23]
    v_pk_add_f32 v[20:21], v[20:21], v[78:79]
    v_pk_fma_f32 v[22:23], v[78:79], v[78:79], v[22:23]
    v_pk_add_f32 v[20:21], v[20:21], v[80:81]
    v_pk_fma_f32 v[22:23], v[80:81], v[80:81], v[22:23]
    v_pk_add_f32 v[20:21], v[20:21], v[82:83]
    v_pk_fma_f32 v[22:23], v[82:83], v[82:83], v[22:23]
    v_pk_add_f32 v[20:21], v[20:21], v[84:85]
    v_pk_fma_f32 v[22:23], v[84:85], v[84:85], v[22:23]
    v_pk_add_f32 v[20:21], v[20:21], v[86:87]
    v_pk_fma_f32 v[22:23], v[86:87], v[86:87], v[22:23]
    v_pk_add_f32 v[20:21], v[20:21], v[88:89]
    v_pk_fma_f32 v[22:23], v[88:89], v[88:89], v[22:23]
    v_pk_add_f32 v[20:21], v[20:21], v[90:91]
    v_pk_fma_f32 v[22:23], v[90:91], v[90:91], v[22:23]
    v_pk_add_f32 v[20:21], v[20:21], v[92:93]
    v_pk_fma_f32 v[22:23], v[92:93], v[92:93], v[22:23]
    v_pk_add_f32 v[20:21], v[20:21], v[94:95]
    v_pk_fma_f32 v[22:23], v[94:95], v[94:95], v[22:23]
    v_add_f32 v20, v20, v21
    v_add_f32 v22, v22, v23
    v_lshrrev_b32 v3, 4, v1
    v_bfe_u32 v4, v1, 1, 1
    v_lshl_add_u32 v3, v3, 1, v4
    v_cmp_eq_u32 vcc, s62, v3
    s_nop 1
    v_cndmask_b32_e64 v58, 0, 3, vcc
    v_permlane32_swap_b32 v20, v22
    v_add_f32 v20, v20, v22
    buffer_store_dword v20, v41, s[36:39], 0 offen sc1
    s_lshr_b32 s68, s62, 1
    s_lshr_b32 s67, s65, 5
    s_add_u32 s67, s67, s62
    s_lshl_b32 s67, s67, 15
    s_add_u32 s67, s67, 0x200000
    s_lshl_b32 s69, s68, 10
    s_add_u32 s100, s67, s69
    v_add_u32 v7, s100, v2
    s_sub_u32 s100, s67, s69
    s_add_u32 s100, s100, 1024
    v_add_u32 v32, s100, v2
    s_lshl_b32 s67, s62, 5
    s_add_u32 s67, s67, s65
    s_lshl_b32 s67, s67, 2
    v_and_b32 v3, 31, v1
    v_lshl_add_u32 v17, v3, 2, s67
    v_lshrrev_b32 v3, 5, v1
    v_lshl_add_u32 v17, v3, 16, v17
    v_bfe_u32 v3, v1, 2, 2
    v_lshrrev_b32 v4, 5, v1
    v_mul_u32_u24 v4, 4, v4
    v_add_u32 v3, v3, v4
    v_mul_u32_u24 v3, 128, v3
    v_bfe_u32 v4, v1, 4, 1
    v_lshl_add_u32 v3, v4, 5, v3
    v_and_b32 v4, 3, v1
    v_lshl_add_u32 v3, v4, 3, v3
    v_bfe_u32 v4, v1, 3, 1
    s_and_b32 s67, s62, 1
    v_xor_b32 v4, s67, v4
    v_lshl_add_u32 v3, v4, 6, v3
    s_lshl_b32 s69, s68, 11
    s_sub_u32 s100, 2048, s69
    v_add_u32 v18, s69, v3
    v_add_u32 v34, s100, v3
    v_xor_b32 v19, 64, v18
    v_xor_b32 v35, 64, v34
    v_add_u32 v18, 0xc000, v18
    v_add_u32 v19, 0xc000, v19
    v_add_u32 v34, 0xc000, v34
    v_add_u32 v35, 0xc000, v35
    s_add_u32 s67, s101, 3
    v_mov_b32 v59, s67
    s_add_u32 s67, s66, 3
    v_mov_b32 v61, s67
    s_waitcnt vmcnt(0)
    buffer_store_dword v59, v55, s[36:39], 0 offen
    buffer_load_dword v57, v56, s[36:39], 0 offen sc1
    v_and_b32 v3, 31, v1
    s_and_b32 s68, s62, 1
    s_lshl_b32 s67, s68, 7
    s_add_u32 s67, s67, 147456
    v_lshl_add_u32 v6, v3, 2, s67
    v_xor_b32 v33, 128, v6
    s_lshr_b32 s68, s62, 1
    s_lshl_b32 s68, s68, 9
    v_add_u32 v36, s68, v6
    s_lshl_b32 s68, s92, 1
    s_and_b32 s67, s62, 1
    s_add_u32 s68, s68, s67
    v_and_b32 v3, 3, v1
    v_cmp_eq_u32 vcc, s68, v3
    s_lshl_b32 s67, s92, 1
    s_add_u32 s67, s67, 32
    v_cndmask_b32_e64 v11, 0, 5, vcc
    v_cndmask_b32_e64 v12, 0, 6, vcc
    v_and_b32 v3, 34, v1
    v_cmp_eq_u32 vcc, s67, v3
    s_nop 1
    v_cndmask_b32_e64 v12, v12, 6, vcc
    s_lshr_b32 s67, s65, 5
    s_add_u32 s67, s67, s68
    s_lshl_b32 s0, s67, 15
    s_lshl_b32 s69, s93, 12
    s_add_u32 s0, s0, s69
    s_lshr_b32 s69, s62, 1
    s_lshl_b32 s69, s69, 11
    s_add_u32 s0, s0, s69
    s_add_u32 s0, s0, 0x200000
    s_mul_i32 s67, s67, 147456
    s_lshl_b32 s69, s69, 1
    s_add_u32 s67, s67, s69
    s_add_u32 s67, s67, 0x400000
    v_add_u32 v8, s67, v2
    s_lshl_b32 s67, s92, 2
    s_add_u32 s67, s67, s62
    s_lshl_b32 s67, s67, 4
    s_add_u32 s67, s67, s65
    s_lshl_b32 s67, s67, 10
    s_lshl_b32 s69, s93, 7
    s_add_u32 s67, s67, s69
    v_lshrrev_b32 v3, 3, v1
    v_and_b32 v4, 7, v1
    v_lshlrev_b32 v4, 4, v4
    v_lshl_add_u32 v3, v3, 10, v4
    v_add_u32 v9, s67, v3
    v_add_u32 v10, 8192, v9
    s_waitcnt vmcnt(0)
    v_subrev_u32 v57, s101, v57
    v_cmp_gt_u32 vcc, 8, v57
    s_nop 1
    v_cndmask_b32 v57, 0, v57, vcc
    s_cmp_eq_u64 vcc, -1
    s_cselect_b32 s1, 1, s1
    v_cmp_lt_u32 vcc, v57, v58
    s_nop 1
    s_cbranch_vccnz L_slow_9
L_back_10:
    s_mov_b32 s70, 0x0
    buffer_load_dwordx4 a[0:3], v7, s[36:39], s70 offen sc1
    buffer_load_dwordx4 a[4:7], v32, s[36:39], s70 offen sc1
    buffer_load_dwordx4 a[8:11], v7, s[36:39], s70 offen offset:2048 sc1
    buffer_load_dwordx4 a[12:15], v32, s[36:39], s70 offen offset:2048 sc1
    s_mov_b32 s70, 0x1000
    buffer_load_dwordx4 a[16:19], v7, s[36:39], s70 offen sc1
    buffer_load_dwordx4 a[20:23], v32, s[36:39], s70 offen sc1
    buffer_load_dwordx4 a[24:27], v7, s[36:39], s70 offen offset:2048 sc1
    buffer_load_dwordx4 a[28:31], v32, s[36:39], s70 offen offset:2048 sc1
    s_cmp_eq_u32 s1, 0
    s_cbranch_scc1 L_fq_12
L_fqb_13:
    s_barrier
    ds_read_b64_tr_b16 v[96:97], v18
    ds_read_b64_tr_b16 v[98:99], v18 offset:1024
    ds_read_b64_tr_b16 v[100:101], v19
    ds_read_b64_tr_b16 v[102:103], v19 offset:1024
    ds_read_b64_tr_b16 v[104:105], v34
    ds_read_b64_tr_b16 v[106:107], v34 offset:1024
    ds_read_b64_tr_b16 v[108:109], v35
    ds_read_b64_tr_b16 v[110:111], v35 offset:1024
    s_waitcnt vmcnt(4) lgkmcnt(6)
    v_mfma_f32_32x32x16_bf16 v[64:79], v[96:99], a[0:3], 0
    ds_read_b64_tr_b16 v[112:113], v18 offset:4096
    ds_read_b64_tr_b16 v[114:115], v18 offset:5120
    ds_read_b64_tr_b16 v[116:117], v19 offset:4096
    s_mov_b32 s70, 0x2000
    buffer_load_dwordx4 a[32:35], v7, s[36:39], s70 offen sc1
    v_mfma_f32_16x16x32_bf16 v[40:43], v[28:31], v[96:99], 0
    s_waitcnt lgkmcnt(7)
    v_mfma_f32_32x32x16_bf16 v[80:95], v[100:103], a[0:3], 0
    ds_read_b64_tr_b16 v[118:119], v19 offset:5120
    ds_read_b64_tr_b16 v[120:121], v34 offset:4096
    ds_read_b64_tr_b16 v[122:123], v34 offset:5120
    buffer_load_dwordx4 a[36:39], v32, s[36:39], s70 offen sc1
    s_waitcnt lgkmcnt(8)
    v_mfma_f32_32x32x16_bf16 v[64:79], v[104:107], a[4:7], v[64:79]
    ds_read_b64_tr_b16 v[124:125], v35 offset:4096
    ds_read_b64_tr_b16 v[126:127], v35 offset:5120
    buffer_load_dwordx4 a[40:43], v7, s[36:39], s70 offen offset:2048 sc1
    s_waitcnt lgkmcnt(8)
    v_mfma_f32_32x32x16_bf16 v[80:95], v[108:111], a[4:7], v[80:95]
    buffer_load_dwordx4 a[44:47], v32, s[36:39], s70 offen offset:2048 sc1
    s_barrier
    s_waitcnt lgkmcnt(6)
    v_mfma_f32_32x32x16_bf16 v[64:79], v[112:115], a[8:11], v[64:79]
    ds_read_b64_tr_b16 v[96:97], v18 offset:8192
    ds_read_b64_tr_b16 v[98:99], v18 offset:9216
    ds_read_b64_tr_b16 v[100:101], v19 offset:8192
    s_mov_b32 s70, 0x3000
    buffer_load_dwordx4 a[48:51], v7, s[36:39], s70 offen sc1
    v_mfma_f32_16x16x32_bf16 v[40:43], v[28:31], v[112:115], v[40:43]
    s_waitcnt lgkmcnt(7)
    v_mfma_f32_32x32x16_bf16 v[80:95], v[116:119], a[8:11], v[80:95]
    ds_read_b64_tr_b16 v[102:103], v19 offset:9216
    ds_read_b64_tr_b16 v[104:105], v34 offset:8192
    ds_read_b64_tr_b16 v[106:107], v34 offset:9216
    buffer_load_dwordx4 a[52:55], v32, s[36:39], s70 offen sc1
    s_waitcnt lgkmcnt(8)
    v_mfma_f32_32x32x16_bf16 v[64:79], v[120:123], a[12:15], v[64:79]
    ds_read_b64_tr_b16 v[108:109], v35 offset:8192
    ds_read_b64_tr_b16 v[110:111], v35 offset:9216
    buffer_load_dwordx4 a[56:59], v7, s[36:39], s70 offen offset:2048 sc1
    s_waitcnt lgkmcnt(8)
    v_mfma_f32_32x32x16_bf16 v[80:95], v[124:127], a[12:15], v[80:95]
    buffer_load_dwordx4 a[60:63], v32, s[36:39], s70 offen offset:2048 sc1
    s_barrier
    s_waitcnt vmcnt(8) lgkmcnt(6)
    v_mfma_f32_32x32x16_bf16 v[64:79], v[96:99], a[16:19], v[64:79]
    ds_read_b64_tr_b16 v[112:113], v18 offset:12288
    ds_read_b64_tr_b16 v[114:115], v18 offset:13312
    ds_read_b64_tr_b16 v[116:117], v19 offset:12288
    s_mov_b32 s70, 0x4000
    buffer_load_dwordx4 a[64:67], v7, s[36:39], s70 offen sc1
    v_mfma_f32_16x16x32_bf16 v[40:43], v[28:31], v[96:99], v[40:43]
    s_waitcnt lgkmcnt(7)
    v_mfma_f32_32x32x16_bf16 v[80:95], v[100:103], a[16:19], v[80:95]
    ds_read_b64_tr_b16 v[118:119], v19 offset:13312
    ds_read_b64_tr_b16 v[120:121], v34 offset:12288
    ds_read_b64_tr_b16 v[122:123], v34 offset:13312
    buffer_load_dwordx4 a[68:71], v32, s[36:39], s70 offen sc1
    s_waitcnt lgkmcnt(8)
    v_mfma_f32_32x32x16_bf16 v[64:79], v[104:107], a[20:23], v[64:79]
    ds_read_b64_tr_b16 v[124:125], v35 offset:12288
    ds_read_b64_tr_b16 v[126:127], v35 offset:13312
    buffer_load_dwordx4 a[72:75], v7, s[36:39], s70 offen offset:2048 sc1
    s_waitcnt lgkmcnt(8)
    v_mfma_f32_32x32x16_bf16 v[80:95], v[108:111], a[20:23], v[80:95]
    buffer_load_dwordx4 a[76:79], v32, s[36:39], s70 offen offset:2048 sc1
    s_waitcnt lgkmcnt(6)
    v_mfma_f32_32x32x16_bf16 v[64:79], v[112:115], a[24:27], v[64:79]
    ds_read_b64_tr_b16 v[96:97], v18 offset:16384
    ds_read_b64_tr_b16 v[98:99], v18 offset:17408
    ds_read_b64_tr_b16 v[100:101], v19 offset:16384
    s_mov_b32 s70, 0x5000
    buffer_load_dwordx4 a[80:83], v7, s[36:39], s70 offen sc1
    v_mfma_f32_16x16x32_bf16 v[40:43], v[28:31], v[112:115], v[40:43]
    s_waitcnt lgkmcnt(7)
    v_mfma_f32_32x32x16_bf16 v[80:95], v[116:119], a[24:27], v[80:95]
    ds_read_b64_tr_b16 v[102:103], v19 offset:17408
    ds_read_b64_tr_b16 v[104:105], v34 offset:16384
    ds_read_b64_tr_b16 v[106:107], v34 offset:17408
    buffer_load_dwordx4 a[84:87], v32, s[36:39], s70 offen sc1
    s_waitcnt lgkmcnt(8)
    v_mfma_f32_32x32x16_bf16 v[64:79], v[120:123], a[28:31], v[64:79]
    ds_read_b64_tr_b16 v[108:109], v35 offset:16384
    ds_read_b64_tr_b16 v[110:111], v35 offset:17408
    buffer_load_dwordx4 a[88:91], v7, s[36:39], s70 offen offset:2048 sc1
    s_waitcnt lgkmcnt(8)
    v_mfma_f32_32x32x16_bf16 v[80:95], v[124:127], a[28:31], v[80:95]
    buffer_load_dwordx4 a[92:95], v32, s[36:39], s70 offen offset:2048 sc1
    s_barrier
    s_waitcnt vmcnt(12) lgkmcnt(6)
    v_mfma_f32_32x32x16_bf16 v[64:79], v[96:99], a[32:35], v[64:79]
    ds_read_b64_tr_b16 v[112:113], v18 offset:20480
    ds_read_b64_tr_b16 v[114:115], v18 offset:21504
    ds_read_b64_tr_b16 v[116:117], v19 offset:20480
    s_mov_b32 s70, 0x6000
    buffer_load_dwordx4 a[96:99], v7, s[36:39], s70 offen sc1
    v_mfma_f32_16x16x32_bf16 v[40:43], v[28:31], v[96:99], v[40:43]
    s_waitcnt lgkmcnt(7)
    v_mfma_f32_32x32x16_bf16 v[80:95], v[100:103], a[32:35], v[80:95]
    ds_read_b64_tr_b16 v[118:119], v19 offset:21504
    ds_read_b64_tr_b16 v[120:121], v34 offset:20480
    ds_read_b64_tr_b16 v[122:123], v34 offset:21504
    buffer_load_dwordx4 a[100:103], v32, s[36:39], s70 offen sc1
    s_waitcnt lgkmcnt(8)
    v_mfma_f32_32x32x16_bf16 v[64:79], v[104:107], a[36:39], v[64:79]
    ds_read_b64_tr_b16 v[124:125], v35 offset:20480
    ds_read_b64_tr_b16 v[126:127], v35 offset:21504
    buffer_load_dwordx4 a[104:107], v7, s[36:39], s70 offen offset:2048 sc1
    s_waitcnt lgkmcnt(8)
    v_mfma_f32_32x32x16_bf16 v[80:95], v[108:111], a[36:39], v[80:95]
    buffer_load_dwordx4 a[108:111], v32, s[36:39], s70 offen offset:2048 sc1
    s_waitcnt lgkmcnt(6)
    v_mfma_f32_32x32x16_bf16 v[64:79], v[112:115], a[40:43], v[64:79]
    ds_read_b64_tr_b16 v[96:97], v18 offset:24576
    ds_read_b64_tr_b16 v[98:99], v18 offset:25600
    ds_read_b64_tr_b16 v[100:101], v19 offset:24576
    v_mfma_f32_16x16x32_bf16 v[40:43], v[28:31], v[112:115], v[40:43]
    s_waitcnt lgkmcnt(7)
    v_mfma_f32_32x32x16_bf16 v[80:95], v[116:119], a[40:43], v[80:95]
    ds_read_b64_tr_b16 v[102:103], v19 offset:25600
    ds_read_b64_tr_b16 v[104:105], v34 offset:24576
    ds_read_b64_tr_b16 v[106:107], v34 offset:25600
    s_waitcnt lgkmcnt(8)
    v_mfma_f32_32x32x16_bf16 v[64:79], v[120:123], a[44:47], v[64:79]
    ds_read_b64_tr_b16 v[108:109], v35 offset:24576
    ds_read_b64_tr_b16 v[110:111], v35 offset:25600
    s_waitcnt lgkmcnt(8)
    v_mfma_f32_32x32x16_bf16 v[80:95], v[124:127], a[44:47], v[80:95]
    s_barrier
    s_waitcnt vmcnt(12) lgkmcnt(6)
    v_mfma_f32_32x32x16_bf16 v[64:79], v[96:99], a[48:51], v[64:79]
    ds_read_b64_tr_b16 v[112:113], v18 offset:28672
    ds_read_b64_tr_b16 v[114:115], v18 offset:29696
    ds_read_b64_tr_b16 v[116:117], v19 offset:28672
    s_mov_b32 s70, 0x7000
    buffer_load_dwordx4 a[112:115], v7, s[36:39], s70 offen sc1
    v_mfma_f32_16x16x32_bf16 v[40:43], v[28:31], v[96:99], v[40:43]
    s_waitcnt lgkmcnt(7)
    v_mfma_f32_32x32x16_bf16 v[80:95], v[100:103], a[48:51], v[80:95]
    ds_read_b64_tr_b16 v[118:119], v19 offset:29696
    ds_read_b64_tr_b16 v[120:121], v34 offset:28672
    ds_read_b64_tr_b16 v[122:123], v34 offset:29696
    buffer_load_dwordx4 a[116:119], v32, s[36:39], s70 offen sc1
    s_waitcnt lgkmcnt(8)
    v_mfma_f32_32x32x16_bf16 v[64:79], v[104:107], a[52:55], v[64:79]
    ds_read_b64_tr_b16 v[124:125], v35 offset:28672
    ds_read_b64_tr_b16 v[126:127], v35 offset:29696
    buffer_load_dwordx4 a[120:123], v7, s[36:39], s70 offen offset:2048 sc1
    s_waitcnt lgkmcnt(8)
    v_mfma_f32_32x32x16_bf16 v[80:95], v[108:111], a[52:55], v[80:95]
    buffer_load_dwordx4 a[124:127], v32, s[36:39], s70 offen offset:2048 sc1
    s_waitcnt lgkmcnt(6)
    v_mfma_f32_32x32x16_bf16 v[64:79], v[112:115], a[56:59], v[64:79]
    ds_read_b64_tr_b16 v[96:97], v18 offset:32768
    ds_read_b64_tr_b16 v[98:99], v18 offset:33792
    ds_read_b64_tr_b16 v[100:101], v19 offset:32768
    v_mfma_f32_16x16x32_bf16 v[40:43], v[28:31], v[112:115], v[40:43]
    s_waitcnt lgkmcnt(7)
    v_mfma_f32_32x32x16_bf16 v[80:95], v[116:119], a[56:59], v[80:95]
    ds_read_b64_tr_b16 v[102:103], v19 offset:33792
    ds_read_b64_tr_b16 v[104:105], v34 offset:32768
    ds_read_b64_tr_b16 v[106:107], v34 offset:33792
    s_waitcnt lgkmcnt(8)
    v_mfma_f32_32x32x16_bf16 v[64:79], v[120:123], a[60:63], v[64:79]
    ds_read_b64_tr_b16 v[108:109], v35 offset:32768
    ds_read_b64_tr_b16 v[110:111], v35 offset:33792
    s_waitcnt lgkmcnt(8)
    v_mfma_f32_32x32x16_bf16 v[80:95], v[124:127], a[60:63], v[80:95]
    s_barrier
    s_waitcnt vmcnt(12) lgkmcnt(6)
    v_mfma_f32_32x32x16_bf16 v[64:79], v[96:99], a[64:67], v[64:79]
    ds_read_b64_tr_b16 v[112:113], v18 offset:36864
    ds_read_b64_tr_b16 v[114:115], v18 offset:37888
    ds_read_b64_tr_b16 v[116:117], v19 offset:36864
    s_mov_b32 s70, 15859712
    buffer_load_dword v144, v17, s[36:39], s70 offen sc1
    v_mfma_f32_16x16x32_bf16 v[40:43], v[28:31], v[96:99], v[40:43]
    s_waitcnt lgkmcnt(7)
    v_mfma_f32_32x32x16_bf16 v[80:95], v[100:103], a[64:67], v[80:95]
    ds_read_b64_tr_b16 v[118:119], v19 offset:37888
    ds_read_b64_tr_b16 v[120:121], v34 offset:36864
    ds_read_b64_tr_b16 v[122:123], v34 offset:37888
    s_mov_b32 s70, 15867904
    buffer_load_dword v145, v17, s[36:39], s70 offen sc1
    s_waitcnt lgkmcnt(8)
    v_mfma_f32_32x32x16_bf16 v[64:79], v[104:107], a[68:71], v[64:79]
    ds_read_b64_tr_b16 v[124:125], v35 offset:36864
    ds_read_b64_tr_b16 v[126:127], v35 offset:37888
    s_mov_b32 s70, 15876096
    buffer_load_dword v146, v17, s[36:39], s70 offen sc1
    s_waitcnt lgkmcnt(8)
    v_mfma_f32_32x32x16_bf16 v[80:95], v[108:111], a[68:71], v[80:95]
    s_mov_b32 s70, 15884288
    buffer_load_dword v147, v17, s[36:39], s70 offen sc1
    s_waitcnt lgkmcnt(6)
    v_mfma_f32_32x32x16_bf16 v[64:79], v[112:115], a[72:75], v[64:79]
    ds_read_b64_tr_b16 v[96:97], v18 offset:40960
    ds_read_b64_tr_b16 v[98:99], v18 offset:41984
    ds_read_b64_tr_b16 v[100:101], v19 offset:40960
    s_mov_b32 s70, 15892480
    buffer_load_dword v148, v17, s[36:39], s70 offen sc1
    v_mfma_f32_16x16x32_bf16 v[40:43], v[28:31], v[112:115], v[40:43]
    s_waitcnt lgkmcnt(7)
    v_mfma_f32_32x32x16_bf16 v[80:95], v[116:119], a[72:75], v[80:95]
    ds_read_b64_tr_b16 v[102:103], v19 offset:41984
    ds_read_b64_tr_b16 v[104:105], v34 offset:40960
    ds_read_b64_tr_b16 v[106:107], v34 offset:41984
    s_mov_b32 s70, 15900672
    buffer_load_dword v149, v17, s[36:39], s70 offen sc1
    s_waitcnt lgkmcnt(8)
    v_mfma_f32_32x32x16_bf16 v[64:79], v[120:123], a[76:79], v[64:79]
    ds_read_b64_tr_b16 v[108:109], v35 offset:40960
    ds_read_b64_tr_b16 v[110:111], v35 offset:41984
    s_mov_b32 s70, 15908864
    buffer_load_dword v150, v17, s[36:39], s70 offen sc1
    s_waitcnt lgkmcnt(8)
    v_mfma_f32_32x32x16_bf16 v[80:95], v[124:127], a[76:79], v[80:95]
    s_mov_b32 s70, 15917056
    buffer_load_dword v151, v17, s[36:39], s70 offen sc1
    s_barrier
    s_waitcnt vmcnt(16) lgkmcnt(6)
    v_mfma_f32_32x32x16_bf16 v[64:79], v[96:99], a[80:83], v[64:79]
    ds_read_b64_tr_b16 v[112:113], v18 offset:45056
    ds_read_b64_tr_b16 v[114:115], v18 offset:46080
    ds_read_b64_tr_b16 v[116:117], v19 offset:45056
    s_add_u32 m0, s72, 114688
    s_mov_b32 s71, 128
    buffer_load_dwordx4 v46, s[16:19], s71 offen lds
    v_mfma_f32_16x16x32_bf16 v[40:43], v[28:31], v[96:99], v[40:43]
    s_waitcnt lgkmcnt(7)
    v_mfma_f32_32x32x16_bf16 v[80:95], v[100:103], a[80:83], v[80:95]
    ds_read_b64_tr_b16 v[118:119], v19 offset:46080
    ds_read_b64_tr_b16 v[120:121], v34 offset:45056
    ds_read_b64_tr_b16 v[122:123], v34 offset:46080
    buffer_load_dwordx4 v47, s[16:19], s71 offen offset:1024 lds
    s_waitcnt lgkmcnt(8)
    v_mfma_f32_32x32x16_bf16 v[64:79], v[104:107], a[84:87], v[64:79]
    ds_read_b64_tr_b16 v[124:125], v35 offset:45056
    ds_read_b64_tr_b16 v[126:127], v35 offset:46080
    s_add_u32 m0, s72, 122880
    s_mov_b32 s71, 229504
    buffer_load_dwordx4 v46, s[16:19], s71 offen lds
    s_waitcnt lgkmcnt(8)
    v_mfma_f32_32x32x16_bf16 v[80:95], v[108:111], a[84:87], v[80:95]
    buffer_load_dwordx4 v47, s[16:19], s71 offen offset:1024 lds
    s_waitcnt lgkmcnt(6)
    v_mfma_f32_32x32x16_bf16 v[64:79], v[112:115], a[88:91], v[64:79]
    ds_read_b64_tr_b16 v[96:97], v18 offset:49152
    ds_read_b64_tr_b16 v[98:99], v18 offset:50176
    ds_read_b64_tr_b16 v[100:101], v19 offset:49152
    s_add_u32 m0, s72, 131072
    s_mov_b32 s71, 458880
    buffer_load_dwordx4 v46, s[16:19], s71 offen lds
    v_mfma_f32_16x16x32_bf16 v[40:43], v[28:31], v[112:115], v[40:43]
    s_waitcnt lgkmcnt(7)
    v_mfma_f32_32x32x16_bf16 v[80:95], v[116:119], a[88:91], v[80:95]
    ds_read_b64_tr_b16 v[102:103], v19 offset:50176
    ds_read_b64_tr_b16 v[104:105], v34 offset:49152
    ds_read_b64_tr_b16 v[106:107], v34 offset:50176
    buffer_load_dwordx4 v47, s[16:19], s71 offen offset:1024 lds
    s_waitcnt lgkmcnt(8)
    v_mfma_f32_32x32x16_bf16 v[64:79], v[120:123], a[92:95], v[64:79]
    ds_read_b64_tr_b16 v[108:109], v35 offset:49152
    ds_read_b64_tr_b16 v[110:111], v35 offset:50176
    s_add_u32 m0, s72, 139264
    s_mov_b32 s71, 688256
    buffer_load_dwordx4 v46, s[16:19], s71 offen lds
    s_waitcnt lgkmcnt(8)
    v_mfma_f32_32x32x16_bf16 v[80:95], v[124:127], a[92:95], v[80:95]
    buffer_load_dwordx4 v47, s[16:19], s71 offen offset:1024 lds
    s_barrier
    s_waitcnt vmcnt(20) lgkmcnt(6)
    v_mfma_f32_32x32x16_bf16 v[64:79], v[96:99], a[96:99], v[64:79]
    ds_read_b64_tr_b16 v[112:113], v18 offset:53248
    ds_read_b64_tr_b16 v[114:115], v18 offset:54272
    ds_read_b64_tr_b16 v[116:117], v19 offset:53248
    s_waitcnt vmcnt(8)
    s_add_u32 m0, s72, 0
    s_mov_b32 s71, 917632
    buffer_load_dwordx4 v46, s[16:19], s71 offen lds
    v_add_f32 v144, v144, v148
    v_mfma_f32_16x16x32_bf16 v[40:43], v[28:31], v[96:99], v[40:43]
    s_waitcnt lgkmcnt(7)
    v_mfma_f32_32x32x16_bf16 v[80:95], v[100:103], a[96:99], v[80:95]
    ds_read_b64_tr_b16 v[118:119], v19 offset:54272
    ds_read_b64_tr_b16 v[120:121], v34 offset:53248
    ds_read_b64_tr_b16 v[122:123], v34 offset:54272
    buffer_load_dwordx4 v47, s[16:19], s71 offen offset:1024 lds
    v_add_f32 v145, v145, v149
    v_add_f32 v146, v146, v150
    v_add_f32 v147, v147, v151
    v_add_f32 v144, v144, v146
    s_waitcnt lgkmcnt(8)
    v_mfma_f32_32x32x16_bf16 v[64:79], v[104:107], a[100:103], v[64:79]
    ds_read_b64_tr_b16 v[124:125], v35 offset:53248
    ds_read_b64_tr_b16 v[126:127], v35 offset:54272
    s_add_u32 m0, s72, 8192
    s_mov_b32 s71, 1147008
    buffer_load_dwordx4 v46, s[16:19], s71 offen lds
    v_add_f32 v145, v145, v147
    v_add_f32 v144, v144, v145
    v_mov_b32 v145, v144
    s_waitcnt lgkmcnt(8)
    v_mfma_f32_32x32x16_bf16 v[80:95], v[108:111], a[100:103], v[80:95]
    buffer_load_dwordx4 v47, s[16:19], s71 offen offset:1024 lds
    v_permlane32_swap_b32 v144, v145
    v_mul_f32 v146, 0x3b000000, v144
    v_mul_f32 v147, 0x3b000000, v145
    v_fma_f32 v147, -v146, v146, v147
    v_max_f32 v147, 0, v147
    v_add_f32 v148, 0x3727c5ac, v147
    v_rsq_f32 v148, v148
    s_waitcnt lgkmcnt(6)
    v_mfma_f32_32x32x16_bf16 v[64:79], v[112:115], a[104:107], v[64:79]
    ds_read_b64_tr_b16 v[96:97], v18 offset:57344
    ds_read_b64_tr_b16 v[98:99], v18 offset:58368
    ds_read_b64_tr_b16 v[100:101], v19 offset:57344
    v_mul_f32 v156, 0xc0135761, v148
    v_mul_f32 v149, v148, v148
    v_mul_f32 v149, v149, v148
    v_mul_f32 v157, 0xbdd2d3e8, v149
    v_sub_f32 v158, 0, v146
    v_mfma_f32_16x16x32_bf16 v[40:43], v[28:31], v[112:115], v[40:43]
    s_waitcnt lgkmcnt(7)
    v_mfma_f32_32x32x16_bf16 v[80:95], v[116:119], a[104:107], v[80:95]
    ds_read_b64_tr_b16 v[102:103], v19 offset:58368
    ds_read_b64_tr_b16 v[104:105], v34 offset:57344
    ds_read_b64_tr_b16 v[106:107], v34 offset:58368
    v_rcp_f32 v159, v148
    v_and_b32 v149, 0xffff0000, v158
    v_cvt_pk_bf16_f32 v128, v149, v149
    v_sub_f32 v149, v158, v149
    s_waitcnt lgkmcnt(8)
    v_mfma_f32_32x32x16_bf16 v[64:79], v[120:123], a[108:111], v[64:79]
    ds_read_b64_tr_b16 v[108:109], v35 offset:57344
    ds_read_b64_tr_b16 v[110:111], v35 offset:58368
    v_cvt_pk_bf16_f32 v129, v149, 0
    v_mov_b32 v130, 0
    v_mov_b32 v131, 0
    v_mov_b32 v134, 0
    v_mov_b32 v135, 0
    v_mov_b32 v138, 0
    s_waitcnt lgkmcnt(8)
    v_mfma_f32_32x32x16_bf16 v[80:95], v[124:127], a[108:111], v[80:95]
    v_mov_b32 v139, 0
    s_waitcnt vmcnt(10)
    s_barrier
    s_waitcnt lgkmcnt(6)
    v_mfma_f32_32x32x16_bf16 v[64:79], v[96:99], a[112:115], v[64:79]
    ds_read_b64_tr_b16 v[112:113], v18 offset:61440
    ds_read_b64_tr_b16 v[114:115], v18 offset:62464
    ds_read_b64_tr_b16 v[116:117], v19 offset:61440
    s_add_u32 m0, s3, 32768
    s_add_u32 s71, s79, 0x0
    buffer_load_dwordx4 v48, s[20:23], s71 offen lds
    v_mfma_f32_16x16x32_bf16 v[40:43], v[28:31], v[96:99], v[40:43]
    s_waitcnt lgkmcnt(7)
    v_mfma_f32_32x32x16_bf16 v[80:95], v[100:103], a[112:115], v[80:95]
    ds_read_b64_tr_b16 v[118:119], v19 offset:62464
    ds_read_b64_tr_b16 v[120:121], v34 offset:61440
    ds_read_b64_tr_b16 v[122:123], v34 offset:62464
    buffer_load_dwordx4 v49, s[20:23], s71 offen offset:1024 lds
    s_waitcnt lgkmcnt(8)
    v_mfma_f32_32x32x16_bf16 v[64:79], v[104:107], a[116:119], v[64:79]
    ds_read_b64_tr_b16 v[124:125], v35 offset:61440
    ds_read_b64_tr_b16 v[126:127], v35 offset:62464
    buffer_load_dwordx4 v50, s[20:23], s71 offen offset:2048 lds
    s_waitcnt lgkmcnt(8)
    v_mfma_f32_32x32x16_bf16 v[80:95], v[108:111], a[116:119], v[80:95]
    buffer_load_dwordx4 v51, s[20:23], s71 offen offset:3072 lds
    s_waitcnt lgkmcnt(6)
    v_mfma_f32_32x32x16_bf16 v[64:79], v[112:115], a[120:123], v[64:79]
    s_add_u32 m0, s72, 16384
    s_mov_b32 s71, 1376384
    buffer_load_dwordx4 v46, s[16:19], s71 offen lds
    v_mfma_f32_16x16x32_bf16 v[40:43], v[28:31], v[112:115], v[40:43]
    s_waitcnt lgkmcnt(4)
    v_mfma_f32_32x32x16_bf16 v[80:95], v[116:119], a[120:123], v[80:95]
    buffer_load_dwordx4 v47, s[16:19], s71 offen offset:1024 lds
    s_waitcnt lgkmcnt(2)
    v_mfma_f32_32x32x16_bf16 v[64:79], v[120:123], a[124:127], v[64:79]
    s_add_u32 m0, s72, 24576
    s_mov_b32 s71, 1605760
    buffer_load_dwordx4 v46, s[16:19], s71 offen lds
    s_waitcnt lgkmcnt(0)
    v_mfma_f32_32x32x16_bf16 v[80:95], v[124:127], a[124:127], v[80:95]
    buffer_load_dwordx4 v47, s[16:19], s71 offen offset:1024 lds
    ds_write_b32 v36, v40
    v_add_u32 v18, 0x4000, v18
    v_add_u32 v19, 0x4000, v19
    v_add_u32 v34, 0x4000, v34
    v_add_u32 v35, 0x4000, v35
    s_waitcnt lgkmcnt(0)
    s_barrier
    ds_read_b64_tr_b16 v[96:97], v18 offset:49152
    ds_read_b64_tr_b16 v[98:99], v18 offset:50176
    ds_read_b64_tr_b16 v[100:101], v19 offset:49152
    ds_read_b64_tr_b16 v[102:103], v19 offset:50176
    ds_read_b64_tr_b16 v[104:105], v34 offset:49152
    ds_read_b64_tr_b16 v[106:107], v34 offset:50176
    ds_read_b64_tr_b16 v[108:109], v35 offset:49152
    ds_read_b64_tr_b16 v[110:111], v35 offset:50176
    s_waitcnt lgkmcnt(6)
    v_mfma_f32_32x32x16_bf16 v[176:191], v[96:99], a[0:3], 0
    ds_read_b64_tr_b16 v[112:113], v18 offset:53248
    ds_read_b64_tr_b16 v[114:115], v18 offset:54272
    ds_read2st64_b32 v[164:165], v6 offset0:0 offset1:2
    ds_read2st64_b32 v[166:167], v33 offset0:0 offset1:2
    s_waitcnt lgkmcnt(0)
    v_add_f32 v164, v164, v165
    v_cndmask_b32_e64 v164, v164, 0, s[86:87]
    v_and_b32 v165, 0xffff0000, v164
    v_mfma_f32_16x16x32_bf16 v[152:155], v[28:31], v[96:99], 0
    v_mfma_f32_32x32x16_bf16 v[192:207], v[100:103], a[0:3], 0
    ds_read_b64_tr_b16 v[116:117], v19 offset:53248
    ds_read_b64_tr_b16 v[118:119], v19 offset:54272
    s_add_u32 m0, s3, 49152
    s_add_u32 s71, s79, 0x40000
    buffer_load_dwordx4 v48, s[20:23], s71 offen lds
    v_sub_f32 v164, v164, v165
    v_lshrrev_b32 v133, 16, v165
    v_cvt_pk_bf16_f32 v132, v165, v164
    v_mfma_f32_32x32x16_bf16 v[176:191], v[104:107], a[4:7], v[176:191]
    ds_read_b64_tr_b16 v[120:121], v34 offset:53248
    ds_read_b64_tr_b16 v[122:123], v34 offset:54272
    v_add_f32 v166, v166, v167
    v_cndmask_b32_e64 v166, v166, 0, s[86:87]
    v_and_b32 v167, 0xffff0000, v166
    v_sub_f32 v166, v166, v167
    v_lshrrev_b32 v137, 16, v167
    v_cvt_pk_bf16_f32 v136, v167, v166
    v_mfma_f32_32x32x16_bf16 v[192:207], v[108:111], a[4:7], v[192:207]
    ds_read_b64_tr_b16 v[124:125], v35 offset:53248
    ds_read_b64_tr_b16 v[126:127], v35 offset:54272
    buffer_load_dwordx4 v49, s[20:23], s71 offen offset:1024 lds
    v_mfma_f32_32x32x16_bf16 v[64:79], v[132:135], v[128:131], v[64:79]
    v_mfma_f32_32x32x16_bf16 v[80:95], v[136:139], v[128:131], v[80:95]
    s_nop 10
    v_mul_f32 v20, v64, v64
    v_mul_f32 v21, v65, v65
    v_mul_f32 v22, v66, v66
    s_waitcnt vmcnt(18)
    s_barrier
    v_mfma_f32_32x32x16_bf16 v[176:191], v[112:115], a[8:11], v[176:191]
    ds_read_b64_tr_b16 v[96:97], v18 offset:57344
    ds_read_b64_tr_b16 v[98:99], v18 offset:58368
    v_mul_f32 v23, v67, v67
    v_mul_f32 v24, v68, v68
    v_mul_f32 v25, v69, v69
    v_mul_f32 v26, v70, v70
    v_mul_f32 v27, v71, v71
    v_fma_f32 v20, v20, v157, v156
    v_mfma_f32_16x16x32_bf16 v[152:155], v[28:31], v[112:115], v[152:155]
    s_waitcnt lgkmcnt(6)
    v_mfma_f32_32x32x16_bf16 v[192:207], v[116:119], a[8:11], v[192:207]
    ds_read_b64_tr_b16 v[100:101], v19 offset:57344
    ds_read_b64_tr_b16 v[102:103], v19 offset:58368
    buffer_load_dwordx4 v50, s[20:23], s71 offen offset:2048 lds
    v_fma_f32 v21, v21, v157, v156
    v_fma_f32 v22, v22, v157, v156
    v_fma_f32 v23, v23, v157, v156
    v_fma_f32 v24, v24, v157, v156
    v_fma_f32 v25, v25, v157, v156
    s_waitcnt lgkmcnt(6)
    v_mfma_f32_32x32x16_bf16 v[176:191], v[120:123], a[12:15], v[176:191]
    ds_read_b64_tr_b16 v[104:105], v34 offset:57344
    ds_read_b64_tr_b16 v[106:107], v34 offset:58368
    v_fma_f32 v26, v26, v157, v156
    v_fma_f32 v27, v27, v157, v156
    v_mul_f32 v20, v20, v64
    v_mul_f32 v21, v21, v65
    v_mul_f32 v22, v22, v66
    v_mul_f32 v23, v23, v67
    s_waitcnt lgkmcnt(6)
    v_mfma_f32_32x32x16_bf16 v[192:207], v[124:127], a[12:15], v[192:207]
    ds_read_b64_tr_b16 v[108:109], v35 offset:57344
    ds_read_b64_tr_b16 v[110:111], v35 offset:58368
    buffer_load_dwordx4 v51, s[20:23], s71 offen offset:3072 lds
    v_mul_f32 v24, v24, v68
    v_mul_f32 v25, v25, v69
    v_mul_f32 v26, v26, v70
    v_mul_f32 v27, v27, v71
    v_exp_f32 v20, v20
    s_waitcnt vmcnt(18)
    s_barrier
    s_waitcnt lgkmcnt(6)
    v_mfma_f32_32x32x16_bf16 v[176:191], v[96:99], a[16:19], v[176:191]
    ds_read_b64_tr_b16 v[112:113], v18 offset:61440
    ds_read_b64_tr_b16 v[114:115], v18 offset:62464
    v_exp_f32 v21, v21
    v_exp_f32 v22, v22
    v_exp_f32 v23, v23
    v_mfma_f32_16x16x32_bf16 v[152:155], v[28:31], v[96:99], v[152:155]
    s_waitcnt lgkmcnt(6)
    v_mfma_f32_32x32x16_bf16 v[192:207], v[100:103], a[16:19], v[192:207]
    ds_read_b64_tr_b16 v[116:117], v19 offset:61440
    ds_read_b64_tr_b16 v[118:119], v19 offset:62464
    s_add_u32 m0, s3, 65536
    s_add_u32 s71, s79, 0x80000
    buffer_load_dwordx4 v48, s[20:23], s71 offen lds
    v_exp_f32 v24, v24
    s_waitcnt lgkmcnt(6)
    v_mfma_f32_32x32x16_bf16 v[176:191], v[104:107], a[20:23], v[176:191]
    ds_read_b64_tr_b16 v[120:121], v34 offset:61440
    ds_read_b64_tr_b16 v[122:123], v34 offset:62464
    v_exp_f32 v25, v25
    v_exp_f32 v26, v26
    v_exp_f32 v27, v27
    s_waitcnt lgkmcnt(6)
    v_mfma_f32_32x32x16_bf16 v[192:207], v[108:111], a[20:23], v[192:207]
    ds_read_b64_tr_b16 v[124:125], v35 offset:61440
    ds_read_b64_tr_b16 v[126:127], v35 offset:62464
    buffer_load_dwordx4 v49, s[20:23], s71 offen offset:1024 lds
    v_fma_f32 v20, v20, v159, v159
    v_fma_f32 v21, v21, v159, v159
    v_fma_f32 v22, v22, v159, v159
    v_fma_f32 v23, v23, v159, v159
    v_fma_f32 v24, v24, v159, v159
    v_add_u32 v18, 0x10000, v18
    v_add_u32 v19, 0x10000, v19
    v_add_u32 v34, 0x10000, v34
    v_add_u32 v35, 0x10000, v35
    s_waitcnt lgkmcnt(6)
    v_mfma_f32_32x32x16_bf16 v[176:191], v[112:115], a[24:27], v[176:191]
    ds_read_b64_tr_b16 v[96:97], v18
    ds_read_b64_tr_b16 v[98:99], v18 offset:1024
    v_fma_f32 v25, v25, v159, v159
    v_fma_f32 v26, v26, v159, v159
    v_fma_f32 v27, v27, v159, v159
    v_rcp_f32 v20, v20
    v_rcp_f32 v21, v21
    v_mfma_f32_16x16x32_bf16 v[152:155], v[28:31], v[112:115], v[152:155]
    s_waitcnt lgkmcnt(6)
    v_mfma_f32_32x32x16_bf16 v[192:207], v[116:119], a[24:27], v[192:207]
    ds_read_b64_tr_b16 v[100:101], v19
    ds_read_b64_tr_b16 v[102:103], v19 offset:1024
    buffer_load_dwordx4 v50, s[20:23], s71 offen offset:2048 lds
    v_rcp_f32 v22, v22
    v_rcp_f32 v23, v23
    s_waitcnt lgkmcnt(6)
    v_mfma_f32_32x32x16_bf16 v[176:191], v[120:123], a[28:31], v[176:191]
    ds_read_b64_tr_b16 v[104:105], v34
    ds_read_b64_tr_b16 v[106:107], v34 offset:1024
    v_rcp_f32 v24, v24
    v_rcp_f32 v25, v25
    v_rcp_f32 v26, v26
    s_waitcnt lgkmcnt(6)
    v_mfma_f32_32x32x16_bf16 v[192:207], v[124:127], a[28:31], v[192:207]
    ds_read_b64_tr_b16 v[108:109], v35
    ds_read_b64_tr_b16 v[110:111], v35 offset:1024
    buffer_load_dwordx4 v51, s[20:23], s71 offen offset:3072 lds
    v_rcp_f32 v27, v27
    v_mul_f32 v20, v20, v64
    v_mul_f32 v21, v21, v65
    v_mul_f32 v22, v22, v66
    s_waitcnt vmcnt(20)
    s_barrier
    s_waitcnt lgkmcnt(6)
    v_mfma_f32_32x32x16_bf16 v[176:191], v[96:99], a[32:35], v[176:191]
    ds_read_b64_tr_b16 v[112:113], v18 offset:4096
    ds_read_b64_tr_b16 v[114:115], v18 offset:5120
    v_mul_f32 v23, v23, v67
    v_mul_f32 v24, v24, v68
    v_mul_f32 v25, v25, v69
    v_mul_f32 v26, v26, v70
    v_mul_f32 v27, v27, v71
    v_cvt_pk_bf16_f32 v168, v20, v21
    v_mfma_f32_16x16x32_bf16 v[152:155], v[28:31], v[96:99], v[152:155]
    s_waitcnt lgkmcnt(6)
    v_mfma_f32_32x32x16_bf16 v[192:207], v[100:103], a[32:35], v[192:207]
    ds_read_b64_tr_b16 v[116:117], v19 offset:4096
    ds_read_b64_tr_b16 v[118:119], v19 offset:5120
    s_add_u32 m0, s3, 81920
    s_add_u32 s71, s79, 0xc0000
    buffer_load_dwordx4 v48, s[20:23], s71 offen lds
    v_cvt_pk_bf16_f32 v169, v22, v23
    v_cvt_pk_bf16_f32 v170, v24, v25
    v_cvt_pk_bf16_f32 v171, v26, v27
    s_waitcnt lgkmcnt(6)
    v_mfma_f32_32x32x16_bf16 v[176:191], v[104:107], a[36:39], v[176:191]
    ds_read_b64_tr_b16 v[120:121], v34 offset:4096
    ds_read_b64_tr_b16 v[122:123], v34 offset:5120
    buffer_store_dwordx4 v[168:171], v52, s[36:39], 0 offen sc1
    v_mul_f32 v20, v72, v72
    v_mul_f32 v21, v73, v73
    v_mul_f32 v22, v74, v74
    v_mul_f32 v23, v75, v75
    v_mul_f32 v24, v76, v76
    s_waitcnt lgkmcnt(6)
    v_mfma_f32_32x32x16_bf16 v[192:207], v[108:111], a[36:39], v[192:207]
    ds_read_b64_tr_b16 v[124:125], v35 offset:4096
    ds_read_b64_tr_b16 v[126:127], v35 offset:5120
    buffer_load_dwordx4 v49, s[20:23], s71 offen offset:1024 lds
    v_mul_f32 v25, v77, v77
    v_mul_f32 v26, v78, v78
    v_mul_f32 v27, v79, v79
    v_fma_f32 v20, v20, v157, v156
    v_fma_f32 v21, v21, v157, v156
    s_waitcnt lgkmcnt(6)
    v_mfma_f32_32x32x16_bf16 v[176:191], v[112:115], a[40:43], v[176:191]
    ds_read_b64_tr_b16 v[96:97], v18 offset:8192
    ds_read_b64_tr_b16 v[98:99], v18 offset:9216
    v_fma_f32 v22, v22, v157, v156
    v_fma_f32 v23, v23, v157, v156
    v_fma_f32 v24, v24, v157, v156
    v_fma_f32 v25, v25, v157, v156
    v_fma_f32 v26, v26, v157, v156
    v_fma_f32 v27, v27, v157, v156
    v_mfma_f32_16x16x32_bf16 v[152:155], v[28:31], v[112:115], v[152:155]
    s_waitcnt lgkmcnt(6)
    v_mfma_f32_32x32x16_bf16 v[192:207], v[116:119], a[40:43], v[192:207]
    ds_read_b64_tr_b16 v[100:101], v19 offset:8192
    ds_read_b64_tr_b16 v[102:103], v19 offset:9216
    buffer_load_dwordx4 v50, s[20:23], s71 offen offset:2048 lds
    v_mul_f32 v20, v20, v72
    v_mul_f32 v21, v21, v73
    v_mul_f32 v22, v22, v74
    v_mul_f32 v23, v23, v75
    v_mul_f32 v24, v24, v76
    s_waitcnt lgkmcnt(6)
    v_mfma_f32_32x32x16_bf16 v[176:191], v[120:123], a[44:47], v[176:191]
    ds_read_b64_tr_b16 v[104:105], v34 offset:8192
    ds_read_b64_tr_b16 v[106:107], v34 offset:9216
    v_mul_f32 v25, v25, v77
    v_mul_f32 v26, v26, v78
    v_mul_f32 v27, v27, v79
    v_exp_f32 v20, v20
    v_exp_f32 v21, v21
    s_waitcnt lgkmcnt(6)
    v_mfma_f32_32x32x16_bf16 v[192:207], v[124:127], a[44:47], v[192:207]
    ds_read_b64_tr_b16 v[108:109], v35 offset:8192
    ds_read_b64_tr_b16 v[110:111], v35 offset:9216
    buffer_load_dwordx4 v51, s[20:23], s71 offen offset:3072 lds
    v_exp_f32 v22, v22
    v_exp_f32 v23, v23
    s_waitcnt vmcnt(23)
    s_barrier
    s_waitcnt lgkmcnt(6)
    v_mfma_f32_32x32x16_bf16 v[176:191], v[96:99], a[48:51], v[176:191]
    ds_read_b64_tr_b16 v[112:113], v18 offset:12288
    ds_read_b64_tr_b16 v[114:115], v18 offset:13312
    v_exp_f32 v24, v24
    v_exp_f32 v25, v25
    v_exp_f32 v26, v26
    v_mfma_f32_16x16x32_bf16 v[152:155], v[28:31], v[96:99], v[152:155]
    s_waitcnt lgkmcnt(6)
    v_mfma_f32_32x32x16_bf16 v[192:207], v[100:103], a[48:51], v[192:207]
    ds_read_b64_tr_b16 v[116:117], v19 offset:12288
    ds_read_b64_tr_b16 v[118:119], v19 offset:13312
    s_add_u32 m0, s3, 98304
    s_add_u32 s71, s61, 0x100000
    buffer_load_dwordx4 v48, s[20:23], s71 offen lds
    v_exp_f32 v27, v27
    v_fma_f32 v20, v20, v159, v159
    s_waitcnt lgkmcnt(6)
    v_mfma_f32_32x32x16_bf16 v[176:191], v[104:107], a[52:55], v[176:191]
    ds_read_b64_tr_b16 v[120:121], v34 offset:12288
    ds_read_b64_tr_b16 v[122:123], v34 offset:13312
    v_fma_f32 v21, v21, v159, v159
    v_fma_f32 v22, v22, v159, v159
    v_fma_f32 v23, v23, v159, v159
    v_fma_f32 v24, v24, v159, v159
    v_fma_f32 v25, v25, v159, v159
    v_fma_f32 v26, v26, v159, v159
    s_waitcnt lgkmcnt(6)
    v_mfma_f32_32x32x16_bf16 v[192:207], v[108:111], a[52:55], v[192:207]
    ds_read_b64_tr_b16 v[124:125], v35 offset:12288
    ds_read_b64_tr_b16 v[126:127], v35 offset:13312
    buffer_load_dwordx4 v49, s[20:23], s71 offen offset:1024 lds
    v_fma_f32 v27, v27, v159, v159
    v_rcp_f32 v20, v20
    v_rcp_f32 v21, v21
    v_add_u32 v18, 0xfffe0000, v18
    v_add_u32 v19, 0xfffe0000, v19
    v_add_u32 v34, 0xfffe0000, v34
    v_add_u32 v35, 0xfffe0000, v35
    s_waitcnt lgkmcnt(6)
    v_mfma_f32_32x32x16_bf16 v[176:191], v[112:115], a[56:59], v[176:191]
    ds_read_b64_tr_b16 v[96:97], v18
    ds_read_b64_tr_b16 v[98:99], v18 offset:1024
    v_rcp_f32 v22, v22
    v_rcp_f32 v23, v23
    v_rcp_f32 v24, v24
    v_mfma_f32_16x16x32_bf16 v[152:155], v[28:31], v[112:115], v[152:155]
    s_waitcnt lgkmcnt(6)
    v_mfma_f32_32x32x16_bf16 v[192:207], v[116:119], a[56:59], v[192:207]
    ds_read_b64_tr_b16 v[100:101], v19
    ds_read_b64_tr_b16 v[102:103], v19 offset:1024
    buffer_load_dwordx4 v50, s[20:23], s71 offen offset:2048 lds
    v_rcp_f32 v25, v25
    v_rcp_f32 v26, v26
    v_rcp_f32 v27, v27
    s_waitcnt lgkmcnt(6)
    v_mfma_f32_32x32x16_bf16 v[176:191], v[120:123], a[60:63], v[176:191]
    ds_read_b64_tr_b16 v[104:105], v34
    ds_read_b64_tr_b16 v[106:107], v34 offset:1024
    v_mul_f32 v20, v20, v72
    v_mul_f32 v21, v21, v73
    v_mul_f32 v22, v22, v74
    v_mul_f32 v23, v23, v75
    v_mul_f32 v24, v24, v76
    s_waitcnt lgkmcnt(6)
    v_mfma_f32_32x32x16_bf16 v[192:207], v[124:127], a[60:63], v[192:207]
    ds_read_b64_tr_b16 v[108:109], v35
    ds_read_b64_tr_b16 v[110:111], v35 offset:1024
    buffer_load_dwordx4 v51, s[20:23], s71 offen offset:3072 lds
    v_mul_f32 v25, v25, v77
    v_mul_f32 v26, v26, v78
    v_mul_f32 v27, v27, v79
    v_cvt_pk_bf16_f32 v172, v20, v21
    v_cvt_pk_bf16_f32 v173, v22, v23
    s_waitcnt vmcnt(25)
    s_barrier
    s_waitcnt lgkmcnt(6)
    v_mfma_f32_32x32x16_bf16 v[176:191], v[96:99], a[64:67], v[176:191]
    ds_read_b64_tr_b16 v[112:113], v18 offset:4096
    ds_read_b64_tr_b16 v[114:115], v18 offset:5120
    v_cvt_pk_bf16_f32 v174, v24, v25
    v_cvt_pk_bf16_f32 v175, v26, v27
    buffer_store_dwordx4 v[172:175], v52, s[36:39], 0 offen offset:1024 sc1
    v_mul_f32 v20, v80, v80
    v_mul_f32 v21, v81, v81
    v_mul_f32 v22, v82, v82
    v_mfma_f32_16x16x32_bf16 v[152:155], v[28:31], v[96:99], v[152:155]
    s_waitcnt lgkmcnt(6)
    v_mfma_f32_32x32x16_bf16 v[192:207], v[100:103], a[64:67], v[192:207]
    ds_read_b64_tr_b16 v[116:117], v19 offset:4096
    ds_read_b64_tr_b16 v[118:119], v19 offset:5120
    s_add_u32 m0, s3, 114688
    s_add_u32 s71, s61, 0x130000
    buffer_load_dwordx4 v48, s[20:23], s71 offen lds
    v_mul_f32 v23, v83, v83
    v_mul_f32 v24, v84, v84
    v_mul_f32 v25, v85, v85
    s_waitcnt lgkmcnt(6)
    v_mfma_f32_32x32x16_bf16 v[176:191], v[104:107], a[68:71], v[176:191]
    ds_read_b64_tr_b16 v[120:121], v34 offset:4096
    ds_read_b64_tr_b16 v[122:123], v34 offset:5120
    v_mul_f32 v26, v86, v86
    v_mul_f32 v27, v87, v87
    v_fma_f32 v20, v20, v157, v156
    v_fma_f32 v21, v21, v157, v156
    v_fma_f32 v22, v22, v157, v156
    v_fma_f32 v23, v23, v157, v156
    s_waitcnt lgkmcnt(6)
    v_mfma_f32_32x32x16_bf16 v[192:207], v[108:111], a[68:71], v[192:207]
    ds_read_b64_tr_b16 v[124:125], v35 offset:4096
    ds_read_b64_tr_b16 v[126:127], v35 offset:5120
    buffer_load_dwordx4 v49, s[20:23], s71 offen offset:1024 lds
    v_fma_f32 v24, v24, v157, v156
    v_fma_f32 v25, v25, v157, v156
    v_fma_f32 v26, v26, v157, v156
    v_fma_f32 v27, v27, v157, v156
    v_mul_f32 v20, v20, v80
    s_waitcnt lgkmcnt(6)
    v_mfma_f32_32x32x16_bf16 v[176:191], v[112:115], a[72:75], v[176:191]
    ds_read_b64_tr_b16 v[96:97], v18 offset:8192
    ds_read_b64_tr_b16 v[98:99], v18 offset:9216
    v_mul_f32 v21, v21, v81
    v_mul_f32 v22, v22, v82
    v_mul_f32 v23, v23, v83
    v_mul_f32 v24, v24, v84
    v_mul_f32 v25, v25, v85
    v_mul_f32 v26, v26, v86
    v_mfma_f32_16x16x32_bf16 v[152:155], v[28:31], v[112:115], v[152:155]
    s_waitcnt lgkmcnt(6)
    v_mfma_f32_32x32x16_bf16 v[192:207], v[116:119], a[72:75], v[192:207]
    ds_read_b64_tr_b16 v[100:101], v19 offset:8192
    ds_read_b64_tr_b16 v[102:103], v19 offset:9216
    buffer_load_dwordx4 v50, s[20:23], s71 offen offset:2048 lds
    v_mul_f32 v27, v27, v87
    v_exp_f32 v20, v20
    v_exp_f32 v21, v21
    s_waitcnt lgkmcnt(6)
    v_mfma_f32_32x32x16_bf16 v[176:191], v[120:123], a[76:79], v[176:191]
    ds_read_b64_tr_b16 v[104:105], v34 offset:8192
    ds_read_b64_tr_b16 v[106:107], v34 offset:9216
    v_exp_f32 v22, v22
    v_exp_f32 v23, v23
    v_exp_f32 v24, v24
    s_waitcnt lgkmcnt(6)
    v_mfma_f32_32x32x16_bf16 v[192:207], v[124:127], a[76:79], v[192:207]
    ds_read_b64_tr_b16 v[108:109], v35 offset:8192
    ds_read_b64_tr_b16 v[110:111], v35 offset:9216
    buffer_load_dwordx4 v51, s[20:23], s71 offen offset:3072 lds
    v_exp_f32 v25, v25
    v_exp_f32 v26, v26
    v_exp_f32 v27, v27
    s_waitcnt vmcnt(24)
    s_barrier
    s_waitcnt lgkmcnt(6)
    v_mfma_f32_32x32x16_bf16 v[176:191], v[96:99], a[80:83], v[176:191]
    ds_read_b64_tr_b16 v[112:113], v18 offset:12288
    ds_read_b64_tr_b16 v[114:115], v18 offset:13312
    v_fma_f32 v20, v20, v159, v159
    v_fma_f32 v21, v21, v159, v159
    v_fma_f32 v22, v22, v159, v159
    v_fma_f32 v23, v23, v159, v159
    v_fma_f32 v24, v24, v159, v159
    v_mfma_f32_16x16x32_bf16 v[152:155], v[28:31], v[96:99], v[152:155]
    s_waitcnt lgkmcnt(6)
    v_mfma_f32_32x32x16_bf16 v[192:207], v[100:103], a[80:83], v[192:207]
    ds_read_b64_tr_b16 v[116:117], v19 offset:12288
    ds_read_b64_tr_b16 v[118:119], v19 offset:13312
    buffer_load_dwordx4 v[208:211], v2, s[36:39], s0 offen sc1
    v_fma_f32 v25, v25, v159, v159
    v_fma_f32 v26, v26, v159, v159
    v_fma_f32 v27, v27, v159, v159
    v_rcp_f32 v20, v20
    s_waitcnt lgkmcnt(6)
    v_mfma_f32_32x32x16_bf16 v[176:191], v[104:107], a[84:87], v[176:191]
    ds_read_b64_tr_b16 v[120:121], v34 offset:12288
    ds_read_b64_tr_b16 v[122:123], v34 offset:13312
    v_rcp_f32 v21, v21
    v_rcp_f32 v22, v22
    v_rcp_f32 v23, v23
    s_waitcnt lgkmcnt(6)
    v_mfma_f32_32x32x16_bf16 v[192:207], v[108:111], a[84:87], v[192:207]
    ds_read_b64_tr_b16 v[124:125], v35 offset:12288
    ds_read_b64_tr_b16 v[126:127], v35 offset:13312
    buffer_load_dwordx4 v[212:215], v2, s[36:39], s0 offen offset:1024 sc1
    v_rcp_f32 v24, v24
    v_rcp_f32 v25, v25
    v_rcp_f32 v26, v26
    s_waitcnt lgkmcnt(6)
    v_mfma_f32_32x32x16_bf16 v[176:191], v[112:115], a[88:91], v[176:191]
    ds_read_b64_tr_b16 v[96:97], v18 offset:16384
    ds_read_b64_tr_b16 v[98:99], v18 offset:17408
    v_rcp_f32 v27, v27
    v_mul_f32 v20, v20, v80
    v_mul_f32 v21, v21, v81
    v_mul_f32 v22, v22, v82
    v_mfma_f32_16x16x32_bf16 v[152:155], v[28:31], v[112:115], v[152:155]
    s_waitcnt lgkmcnt(6)
    v_mfma_f32_32x32x16_bf16 v[192:207], v[116:119], a[88:91], v[192:207]
    ds_read_b64_tr_b16 v[100:101], v19 offset:16384
    ds_read_b64_tr_b16 v[102:103], v19 offset:17408
    buffer_load_dwordx4 v[216:219], v9, s[4:7], 0 offen
    v_mul_f32 v23, v23, v83
    v_mul_f32 v24, v24, v84
    v_mul_f32 v25, v25, v85
    v_mul_f32 v26, v26, v86
    v_mul_f32 v27, v27, v87
    s_waitcnt lgkmcnt(6)
    v_mfma_f32_32x32x16_bf16 v[176:191], v[120:123], a[92:95], v[176:191]
    ds_read_b64_tr_b16 v[104:105], v34 offset:16384
    ds_read_b64_tr_b16 v[106:107], v34 offset:17408
    v_cvt_pk_bf16_f32 v168, v20, v21
    v_cvt_pk_bf16_f32 v169, v22, v23
    v_cvt_pk_bf16_f32 v170, v24, v25
    v_cvt_pk_bf16_f32 v171, v26, v27
    buffer_store_dwordx4 v[168:171], v53, s[36:39], 0 offen sc1
    v_mul_f32 v20, v88, v88
    s_waitcnt lgkmcnt(6)
    v_mfma_f32_32x32x16_bf16 v[192:207], v[124:127], a[92:95], v[192:207]
    ds_read_b64_tr_b16 v[108:109], v35 offset:16384
    ds_read_b64_tr_b16 v[110:111], v35 offset:17408
    buffer_load_dwordx4 v[220:223], v10, s[4:7], 0 offen
    v_mul_f32 v21, v89, v89
    v_mul_f32 v22, v90, v90
    v_mul_f32 v23, v91, v91
    v_mul_f32 v24, v92, v92
    v_mul_f32 v25, v93, v93
    s_waitcnt vmcnt(27)
    s_barrier
    s_waitcnt lgkmcnt(6)
    v_mfma_f32_32x32x16_bf16 v[176:191], v[96:99], a[96:99], v[176:191]
    ds_read_b64_tr_b16 v[112:113], v18 offset:20480
    ds_read_b64_tr_b16 v[114:115], v18 offset:21504
    v_mul_f32 v26, v94, v94
    v_mul_f32 v27, v95, v95
    v_fma_f32 v20, v20, v157, v156
    v_fma_f32 v21, v21, v157, v156
    v_fma_f32 v22, v22, v157, v156
    v_fma_f32 v23, v23, v157, v156
    v_mfma_f32_16x16x32_bf16 v[152:155], v[28:31], v[96:99], v[152:155]
    s_waitcnt lgkmcnt(6)
    v_mfma_f32_32x32x16_bf16 v[192:207], v[100:103], a[96:99], v[192:207]
    ds_read_b64_tr_b16 v[116:117], v19 offset:20480
    ds_read_b64_tr_b16 v[118:119], v19 offset:21504
    s_add_u32 m0, s3, 131072
    s_add_u32 s71, s61, 0x160000
    buffer_load_dwordx4 v48, s[20:23], s71 offen lds
    v_fma_f32 v24, v24, v157, v156
    v_fma_f32 v25, v25, v157, v156
    v_fma_f32 v26, v26, v157, v156
    s_waitcnt lgkmcnt(6)
    v_mfma_f32_32x32x16_bf16 v[176:191], v[104:107], a[100:103], v[176:191]
    ds_read_b64_tr_b16 v[120:121], v34 offset:20480
    ds_read_b64_tr_b16 v[122:123], v34 offset:21504
    v_fma_f32 v27, v27, v157, v156
    v_mul_f32 v20, v20, v88
    v_mul_f32 v21, v21, v89
    v_mul_f32 v22, v22, v90
    v_mul_f32 v23, v23, v91
    v_mul_f32 v24, v24, v92
    s_waitcnt lgkmcnt(6)
    v_mfma_f32_32x32x16_bf16 v[192:207], v[108:111], a[100:103], v[192:207]
    ds_read_b64_tr_b16 v[124:125], v35 offset:20480
    ds_read_b64_tr_b16 v[126:127], v35 offset:21504
    buffer_load_dwordx4 v49, s[20:23], s71 offen offset:1024 lds
    v_mul_f32 v25, v25, v93
    v_mul_f32 v26, v26, v94
    v_mul_f32 v27, v27, v95
    v_exp_f32 v20, v20
    s_waitcnt lgkmcnt(6)
    v_mfma_f32_32x32x16_bf16 v[176:191], v[112:115], a[104:107], v[176:191]
    ds_read_b64_tr_b16 v[96:97], v18 offset:24576
    ds_read_b64_tr_b16 v[98:99], v18 offset:25600
    v_exp_f32 v21, v21
    v_exp_f32 v22, v22
    v_exp_f32 v23, v23
    v_mfma_f32_16x16x32_bf16 v[152:155], v[28:31], v[112:115], v[152:155]
    s_waitcnt lgkmcnt(6)
    v_mfma_f32_32x32x16_bf16 v[192:207], v[116:119], a[104:107], v[192:207]
    ds_read_b64_tr_b16 v[100:101], v19 offset:24576
    ds_read_b64_tr_b16 v[102:103], v19 offset:25600
    buffer_load_dwordx4 v50, s[20:23], s71 offen offset:2048 lds
    v_exp_f32 v24, v24
    v_exp_f32 v25, v25
    v_exp_f32 v26, v26
    s_waitcnt lgkmcnt(6)
    v_mfma_f32_32x32x16_bf16 v[176:191], v[120:123], a[108:111], v[176:191]
    ds_read_b64_tr_b16 v[104:105], v34 offset:24576
    ds_read_b64_tr_b16 v[106:107], v34 offset:25600
    v_exp_f32 v27, v27
    v_fma_f32 v20, v20, v159, v159
    v_fma_f32 v21, v21, v159, v159
    v_fma_f32 v22, v22, v159, v159
    s_waitcnt lgkmcnt(6)
    v_mfma_f32_32x32x16_bf16 v[192:207], v[124:127], a[108:111], v[192:207]
    ds_read_b64_tr_b16 v[108:109], v35 offset:24576
    ds_read_b64_tr_b16 v[110:111], v35 offset:25600
    buffer_load_dwordx4 v51, s[20:23], s71 offen offset:3072 lds
    v_fma_f32 v23, v23, v159, v159
    v_fma_f32 v24, v24, v159, v159
    v_fma_f32 v25, v25, v159, v159
    v_fma_f32 v26, v26, v159, v159
    v_fma_f32 v27, v27, v159, v159
    s_waitcnt lgkmcnt(6)
    v_mfma_f32_32x32x16_bf16 v[176:191], v[96:99], a[112:115], v[176:191]
    ds_read_b64_tr_b16 v[112:113], v18 offset:28672
    ds_read_b64_tr_b16 v[114:115], v18 offset:29696
    v_rcp_f32 v20, v20
    v_rcp_f32 v21, v21
    v_rcp_f32 v22, v22
    v_mfma_f32_16x16x32_bf16 v[152:155], v[28:31], v[96:99], v[152:155]
    s_waitcnt lgkmcnt(6)
    v_mfma_f32_32x32x16_bf16 v[192:207], v[100:103], a[112:115], v[192:207]
    ds_read_b64_tr_b16 v[116:117], v19 offset:28672
    ds_read_b64_tr_b16 v[118:119], v19 offset:29696
    s_add_u32 m0, s3, 0
    s_add_u32 s71, s61, 0x190000
    buffer_load_dwordx4 v48, s[20:23], s71 offen lds
    v_rcp_f32 v23, v23
    v_rcp_f32 v24, v24
    s_waitcnt lgkmcnt(6)
    v_mfma_f32_32x32x16_bf16 v[176:191], v[104:107], a[116:119], v[176:191]
    ds_read_b64_tr_b16 v[120:121], v34 offset:28672
    ds_read_b64_tr_b16 v[122:123], v34 offset:29696
    v_rcp_f32 v25, v25
    v_rcp_f32 v26, v26
    v_rcp_f32 v27, v27
    s_waitcnt lgkmcnt(6)
    v_mfma_f32_32x32x16_bf16 v[192:207], v[108:111], a[116:119], v[192:207]
    ds_read_b64_tr_b16 v[124:125], v35 offset:28672
    ds_read_b64_tr_b16 v[126:127], v35 offset:29696
    buffer_load_dwordx4 v49, s[20:23], s71 offen offset:1024 lds
    v_mul_f32 v20, v20, v88
    v_mul_f32 v21, v21, v89
    v_mul_f32 v22, v22, v90
    v_mul_f32 v23, v23, v91
    s_waitcnt lgkmcnt(6)
    v_mfma_f32_32x32x16_bf16 v[176:191], v[112:115], a[120:123], v[176:191]
    v_mul_f32 v24, v24, v92
    v_mul_f32 v25, v25, v93
    v_mul_f32 v26, v26, v94
    v_mul_f32 v27, v27, v95
    v_cvt_pk_bf16_f32 v172, v20, v21
    v_cvt_pk_bf16_f32 v173, v22, v23
    v_cvt_pk_bf16_f32 v174, v24, v25
    v_cvt_pk_bf16_f32 v175, v26, v27
    v_mfma_f32_16x16x32_bf16 v[152:155], v[28:31], v[112:115], v[152:155]
    s_waitcnt lgkmcnt(4)
    v_mfma_f32_32x32x16_bf16 v[192:207], v[116:119], a[120:123], v[192:207]
    buffer_load_dwordx4 v50, s[20:23], s71 offen offset:2048 lds
    buffer_store_dwordx4 v[172:175], v53, s[36:39], 0 offen offset:1024 sc1
    s_waitcnt lgkmcnt(2)
    v_mfma_f32_32x32x16_bf16 v[176:191], v[120:123], a[124:127], v[176:191]
    s_waitcnt lgkmcnt(0)
    v_mfma_f32_32x32x16_bf16 v[192:207], v[124:127], a[124:127], v[192:207]
    buffer_load_dwordx4 v51, s[20:23], s71 offen offset:3072 lds
    ds_write_b32 v36, v152 offset:256
    s_waitcnt lgkmcnt(0)
    s_barrier
    ds_read2st64_b32 v[164:165], v6 offset0:1 offset1:3
    ds_read2st64_b32 v[166:167], v33 offset0:1 offset1:3
    s_add_u32 s67, s101, 5
    v_mov_b32 v59, s67
    s_add_u32 s67, s66, 5
    v_mov_b32 v61, s67
    s_waitcnt vmcnt(1)
    buffer_store_dword v59, v55, s[36:39], 0 offen
    s_cmp_eq_u32 s1, 0
    s_cbranch_scc1 L_fq_14
L_fqb_15:
    s_waitcnt lgkmcnt(0)
    v_add_f32 v164, v164, v165
    v_cndmask_b32_e64 v164, v164, 0, s[86:87]
    v_and_b32 v165, 0xffff0000, v164
    v_sub_f32 v164, v164, v165
    v_lshrrev_b32 v133, 16, v165
    v_cvt_pk_bf16_f32 v132, v165, v164
    v_add_f32 v166, v166, v167
    v_cndmask_b32_e64 v166, v166, 0, s[86:87]
    v_and_b32 v167, 0xffff0000, v166
    v_sub_f32 v166, v166, v167
    v_lshrrev_b32 v137, 16, v167
    v_cvt_pk_bf16_f32 v136, v167, v166
    v_mfma_f32_32x32x16_bf16 v[176:191], v[132:135], v[128:131], v[176:191]
    s_nop 0
    v_mfma_f32_32x32x16_bf16 v[192:207], v[136:139], v[128:131], v[192:207]
    s_mov_b32 s45, 32768
    v_bfe_u32 v3, v1, 2, 2
    v_lshrrev_b32 v4, 5, v1
    v_mul_u32_u24 v4, 4, v4
    v_add_u32 v3, v3, v4
    v_mul_u32_u24 v3, 128, v3
    v_bfe_u32 v4, v1, 4, 1
    v_lshl_add_u32 v3, v4, 5, v3
    v_and_b32 v4, 3, v1
    v_lshl_add_u32 v3, v4, 3, v3
    s_lshr_b32 s67, s62, 1
    v_bfe_u32 v4, v1, 3, 1
    v_xor_b32 v4, s67, v4
    v_lshl_add_u32 v3, v4, 6, v3
    s_lshl_b32 s67, s67, 13
    s_add_u32 s67, s67, 0
    v_add_u32 v7, s67, v3
    v_xor_b32 v13, 64, v7
    v_lshlrev_b32 v224, 16, v208
    v_and_b32 v225, 0xffff0000, v208
    v_lshlrev_b32 v226, 16, v209
    v_and_b32 v227, 0xffff0000, v209
    v_lshlrev_b32 v228, 16, v210
    v_and_b32 v229, 0xffff0000, v210
    v_lshlrev_b32 v230, 16, v211
    v_and_b32 v231, 0xffff0000, v211
    v_lshlrev_b32 v232, 16, v212
    v_and_b32 v233, 0xffff0000, v212
    v_lshlrev_b32 v234, 16, v213
    v_and_b32 v235, 0xffff0000, v213
    v_lshlrev_b32 v236, 16, v214
    v_and_b32 v237, 0xffff0000, v214
    v_lshlrev_b32 v238, 16, v215
    v_and_b32 v239, 0xffff0000, v215
    v_pk_mul_f32 v[20:21], v[176:177], v[176:177]
    v_pk_mul_f32 v[22:23], v[178:179], v[178:179]
    v_pk_mul_f32 v[24:25], v[180:181], v[180:181]
    v_pk_mul_f32 v[26:27], v[182:183], v[182:183]
    s_add_u32 m0, s3, 16384
    s_add_u32 s71, s79, 0x10000
    buffer_load_dwordx4 v48, s[20:23], s71 offen lds
    v_pk_fma_f32 v[20:21], v[20:21], v[156:157], v[156:157] op_sel:[0,1,0] op_sel_hi:[1,1,0]
    v_pk_fma_f32 v[22:23], v[22:23], v[156:157], v[156:157] op_sel:[0,1,0] op_sel_hi:[1,1,0]
    v_pk_fma_f32 v[24:25], v[24:25], v[156:157], v[156:157] op_sel:[0,1,0] op_sel_hi:[1,1,0]
    v_pk_fma_f32 v[26:27], v[26:27], v[156:157], v[156:157] op_sel:[0,1,0] op_sel_hi:[1,1,0]
    v_pk_mul_f32 v[20:21], v[20:21], v[176:177]
    v_pk_mul_f32 v[22:23], v[22:23], v[178:179]
    v_pk_mul_f32 v[24:25], v[24:25], v[180:181]
    v_pk_mul_f32 v[26:27], v[26:27], v[182:183]
    v_exp_f32 v20, v20
    v_exp_f32 v21, v21
    v_exp_f32 v22, v22
    v_exp_f32 v23, v23
    v_exp_f32 v24, v24
    v_exp_f32 v25, v25
    v_exp_f32 v26, v26
    v_exp_f32 v27, v27
    buffer_load_dwordx4 v49, s[20:23], s71 offen offset:1024 lds
    v_pk_fma_f32 v[20:21], v[20:21], v[158:159], v[158:159] op_sel:[0,1,1] op_sel_hi:[1,1,1]
    v_pk_fma_f32 v[22:23], v[22:23], v[158:159], v[158:159] op_sel:[0,1,1] op_sel_hi:[1,1,1]
    v_pk_fma_f32 v[24:25], v[24:25], v[158:159], v[158:159] op_sel:[0,1,1] op_sel_hi:[1,1,1]
    v_pk_fma_f32 v[26:27], v[26:27], v[158:159], v[158:159] op_sel:[0,1,1] op_sel_hi:[1,1,1]
    v_rcp_f32 v20, v20
    v_rcp_f32 v21, v21
    v_rcp_f32 v22, v22
    v_rcp_f32 v23, v23
    v_rcp_f32 v24, v24
    v_rcp_f32 v25, v25
    v_rcp_f32 v26, v26
    v_rcp_f32 v27, v27
    buffer_load_dwordx4 v50, s[20:23], s71 offen offset:2048 lds
    v_pk_mul_f32 v[20:21], v[20:21], v[176:177]
    v_pk_mul_f32 v[22:23], v[22:23], v[178:179]
    v_pk_mul_f32 v[24:25], v[24:25], v[180:181]
    v_pk_mul_f32 v[26:27], v[26:27], v[182:183]
    v_cvt_pk_bf16_f32 v168, v20, v21
    v_cvt_pk_bf16_f32 v169, v22, v23
    v_cvt_pk_bf16_f32 v170, v24, v25
    v_cvt_pk_bf16_f32 v171, v26, v27
    buffer_store_dwordx4 v[168:171], v52, s[36:39], s45 offen sc1
    buffer_load_dword v57, v56, s[36:39], 0 offen sc1
    v_pk_mul_f32 v[20:21], v[184:185], v[184:185]
    v_pk_mul_f32 v[22:23], v[186:187], v[186:187]
    v_pk_mul_f32 v[24:25], v[188:189], v[188:189]
    v_pk_mul_f32 v[26:27], v[190:191], v[190:191]
    buffer_load_dwordx4 v51, s[20:23], s71 offen offset:3072 lds
    v_pk_fma_f32 v[20:21], v[20:21], v[156:157], v[156:157] op_sel:[0,1,0] op_sel_hi:[1,1,0]
    v_pk_fma_f32 v[22:23], v[22:23], v[156:157], v[156:157] op_sel:[0,1,0] op_sel_hi:[1,1,0]
    v_pk_fma_f32 v[24:25], v[24:25], v[156:157], v[156:157] op_sel:[0,1,0] op_sel_hi:[1,1,0]
    v_pk_fma_f32 v[26:27], v[26:27], v[156:157], v[156:157] op_sel:[0,1,0] op_sel_hi:[1,1,0]
    v_pk_mul_f32 v[20:21], v[20:21], v[184:185]
    v_pk_mul_f32 v[22:23], v[22:23], v[186:187]
    v_pk_mul_f32 v[24:25], v[24:25], v[188:189]
    v_pk_mul_f32 v[26:27], v[26:27], v[190:191]
    v_exp_f32 v20, v20
    v_exp_f32 v21, v21
    v_exp_f32 v22, v22
    v_exp_f32 v23, v23
    v_exp_f32 v24, v24
    v_exp_f32 v25, v25
    v_exp_f32 v26, v26
    v_exp_f32 v27, v27
    v_pk_fma_f32 v[20:21], v[20:21], v[158:159], v[158:159] op_sel:[0,1,1] op_sel_hi:[1,1,1]
    v_pk_fma_f32 v[22:23], v[22:23], v[158:159], v[158:159] op_sel:[0,1,1] op_sel_hi:[1,1,1]
    v_pk_fma_f32 v[24:25], v[24:25], v[158:159], v[158:159] op_sel:[0,1,1] op_sel_hi:[1,1,1]
    v_pk_fma_f32 v[26:27], v[26:27], v[158:159], v[158:159] op_sel:[0,1,1] op_sel_hi:[1,1,1]
    v_rcp_f32 v20, v20
    v_rcp_f32 v21, v21
    v_rcp_f32 v22, v22
    v_rcp_f32 v23, v23
    v_rcp_f32 v24, v24
    v_rcp_f32 v25, v25
    v_rcp_f32 v26, v26
    v_rcp_f32 v27, v27
    v_pk_mul_f32 v[20:21], v[20:21], v[184:185]
    v_pk_mul_f32 v[22:23], v[22:23], v[186:187]
    v_pk_mul_f32 v[24:25], v[24:25], v[188:189]
    v_pk_mul_f32 v[26:27], v[26:27], v[190:191]
    v_cvt_pk_bf16_f32 v172, v20, v21
    v_cvt_pk_bf16_f32 v173, v22, v23
    v_cvt_pk_bf16_f32 v174, v24, v25
    v_cvt_pk_bf16_f32 v175, v26, v27
    buffer_store_dwordx4 v[172:175], v52, s[36:39], s45 offen offset:1024 sc1
    s_waitcnt vmcnt(2)
    v_subrev_u32 v57, s101, v57
    v_cmp_gt_u32 vcc, 8, v57
    s_nop 1
    v_cndmask_b32 v57, 0, v57, vcc
    v_cmp_lt_u32 vcc, v57, v11
    s_nop 1
    s_cbranch_vccnz L_slow_16
L_back_17:
    v_pk_mul_f32 v[20:21], v[192:193], v[192:193]
    v_pk_mul_f32 v[22:23], v[194:195], v[194:195]
    v_pk_mul_f32 v[24:25], v[196:197], v[196:197]
    v_pk_mul_f32 v[26:27], v[198:199], v[198:199]
    s_mov_b32 s70, 0xc000
    buffer_load_dwordx4 a[128:131], v8, s[36:39], s70 offen sc1
    v_pk_fma_f32 v[20:21], v[20:21], v[156:157], v[156:157] op_sel:[0,1,0] op_sel_hi:[1,1,0]
    v_pk_fma_f32 v[22:23], v[22:23], v[156:157], v[156:157] op_sel:[0,1,0] op_sel_hi:[1,1,0]
    v_pk_fma_f32 v[24:25], v[24:25], v[156:157], v[156:157] op_sel:[0,1,0] op_sel_hi:[1,1,0]
    v_pk_fma_f32 v[26:27], v[26:27], v[156:157], v[156:157] op_sel:[0,1,0] op_sel_hi:[1,1,0]
    v_pk_mul_f32 v[20:21], v[20:21], v[192:193]
    v_pk_mul_f32 v[22:23], v[22:23], v[194:195]
    v_pk_mul_f32 v[24:25], v[24:25], v[196:197]
    v_pk_mul_f32 v[26:27], v[26:27], v[198:199]
    v_exp_f32 v20, v20
    v_exp_f32 v21, v21
    v_exp_f32 v22, v22
    v_exp_f32 v23, v23
    v_exp_f32 v24, v24
    v_exp_f32 v25, v25
    v_exp_f32 v26, v26
    v_exp_f32 v27, v27
    buffer_load_dwordx4 a[132:135], v8, s[36:39], s70 offen offset:1024 sc1
    v_pk_fma_f32 v[20:21], v[20:21], v[158:159], v[158:159] op_sel:[0,1,1] op_sel_hi:[1,1,1]
    v_pk_fma_f32 v[22:23], v[22:23], v[158:159], v[158:159] op_sel:[0,1,1] op_sel_hi:[1,1,1]
    v_pk_fma_f32 v[24:25], v[24:25], v[158:159], v[158:159] op_sel:[0,1,1] op_sel_hi:[1,1,1]
    v_pk_fma_f32 v[26:27], v[26:27], v[158:159], v[158:159] op_sel:[0,1,1] op_sel_hi:[1,1,1]
    v_rcp_f32 v20, v20
    v_rcp_f32 v21, v21
    v_rcp_f32 v22, v22
    v_rcp_f32 v23, v23
    v_rcp_f32 v24, v24
    v_rcp_f32 v25, v25
    v_rcp_f32 v26, v26
    v_rcp_f32 v27, v27
    buffer_load_dwordx4 a[136:139], v8, s[36:39], s70 offen offset:2048 sc1
    v_pk_mul_f32 v[20:21], v[20:21], v[192:193]
    v_pk_mul_f32 v[22:23], v[22:23], v[194:195]
    v_pk_mul_f32 v[24:25], v[24:25], v[196:197]
    v_pk_mul_f32 v[26:27], v[26:27], v[198:199]
    v_cvt_pk_bf16_f32 v168, v20, v21
    v_cvt_pk_bf16_f32 v169, v22, v23
    v_cvt_pk_bf16_f32 v170, v24, v25
    v_cvt_pk_bf16_f32 v171, v26, v27
    buffer_store_dwordx4 v[168:171], v53, s[36:39], s45 offen sc1
    v_pk_mul_f32 v[20:21], v[200:201], v[200:201]
    v_pk_mul_f32 v[22:23], v[202:203], v[202:203]
    v_pk_mul_f32 v[24:25], v[204:205], v[204:205]
    v_pk_mul_f32 v[26:27], v[206:207], v[206:207]
    buffer_load_dwordx4 a[140:143], v8, s[36:39], s70 offen offset:3072 sc1
    v_pk_fma_f32 v[20:21], v[20:21], v[156:157], v[156:157] op_sel:[0,1,0] op_sel_hi:[1,1,0]
    v_pk_fma_f32 v[22:23], v[22:23], v[156:157], v[156:157] op_sel:[0,1,0] op_sel_hi:[1,1,0]
    v_pk_fma_f32 v[24:25], v[24:25], v[156:157], v[156:157] op_sel:[0,1,0] op_sel_hi:[1,1,0]
    v_pk_fma_f32 v[26:27], v[26:27], v[156:157], v[156:157] op_sel:[0,1,0] op_sel_hi:[1,1,0]
    v_pk_mul_f32 v[20:21], v[20:21], v[200:201]
    v_pk_mul_f32 v[22:23], v[22:23], v[202:203]
    v_pk_mul_f32 v[24:25], v[24:25], v[204:205]
    v_pk_mul_f32 v[26:27], v[26:27], v[206:207]
    v_exp_f32 v20, v20
    v_exp_f32 v21, v21
    v_exp_f32 v22, v22
    v_exp_f32 v23, v23
    v_exp_f32 v24, v24
    v_exp_f32 v25, v25
    v_exp_f32 v26, v26
    v_exp_f32 v27, v27
    s_mov_b32 s70, 0xe000
    buffer_load_dwordx4 a[144:147], v8, s[36:39], s70 offen sc1
    v_pk_fma_f32 v[20:21], v[20:21], v[158:159], v[158:159] op_sel:[0,1,1] op_sel_hi:[1,1,1]
    v_pk_fma_f32 v[22:23], v[22:23], v[158:159], v[158:159] op_sel:[0,1,1] op_sel_hi:[1,1,1]
    v_pk_fma_f32 v[24:25], v[24:25], v[158:159], v[158:159] op_sel:[0,1,1] op_sel_hi:[1,1,1]
    v_pk_fma_f32 v[26:27], v[26:27], v[158:159], v[158:159] op_sel:[0,1,1] op_sel_hi:[1,1,1]
    v_rcp_f32 v20, v20
    v_rcp_f32 v21, v21
    v_rcp_f32 v22, v22
    v_rcp_f32 v23, v23
    v_rcp_f32 v24, v24
    v_rcp_f32 v25, v25
    v_rcp_f32 v26, v26
    v_rcp_f32 v27, v27
    buffer_load_dwordx4 a[148:151], v8, s[36:39], s70 offen offset:1024 sc1
    v_pk_mul_f32 v[20:21], v[20:21], v[200:201]
    v_pk_mul_f32 v[22:23], v[22:23], v[202:203]
    v_pk_mul_f32 v[24:25], v[24:25], v[204:205]
    v_pk_mul_f32 v[26:27], v[26:27], v[206:207]
    v_cvt_pk_bf16_f32 v172, v20, v21
    v_cvt_pk_bf16_f32 v173, v22, v23
    v_cvt_pk_bf16_f32 v174, v24, v25
    v_cvt_pk_bf16_f32 v175, v26, v27
    buffer_store_dwordx4 v[172:175], v53, s[36:39], s45 offen offset:1024 sc1
    buffer_load_dwordx4 a[152:155], v8, s[36:39], s70 offen offset:2048 sc1
    buffer_load_dwordx4 a[156:159], v8, s[36:39], s70 offen offset:3072 sc1
    s_mov_b32 s70, 0x10000
    buffer_load_dwordx4 a[160:163], v8, s[36:39], s70 offen sc1
    buffer_load_dwordx4 a[164:167], v8, s[36:39], s70 offen offset:1024 sc1
    buffer_load_dwordx4 a[168:171], v8, s[36:39], s70 offen offset:2048 sc1
    buffer_load_dwordx4 a[172:175], v8, s[36:39], s70 offen offset:3072 sc1
    s_barrier
    ds_read_b64_tr_b16 v[40:41], v7 offset:32768
    ds_read_b64_tr_b16 v[42:43], v7 offset:33792
    ds_read_b64_tr_b16 v[44:45], v13 offset:32768
    ds_read_b64_tr_b16 v[46:47], v13 offset:33792
    ds_read_b64_tr_b16 v[240:241], v7 offset:34816
    ds_read_b64_tr_b16 v[242:243], v7 offset:35840
    ds_read_b64_tr_b16 v[244:245], v13 offset:34816
    ds_read_b64_tr_b16 v[246:247], v13 offset:35840
    s_waitcnt vmcnt(9) lgkmcnt(6)
    v_mfma_f32_32x32x16_bf16 v[224:239], v[40:43], a[128:131], v[224:239]
    ds_read_b64_tr_b16 v[20:21], v7 offset:36864
    ds_read_b64_tr_b16 v[22:23], v7 offset:37888
    ds_read_b64_tr_b16 v[24:25], v13 offset:36864
    s_mov_b32 s70, 0x12000
    buffer_load_dwordx4 a[176:179], v8, s[36:39], s70 offen sc1
    s_waitcnt lgkmcnt(7)
    v_mfma_f32_32x32x16_bf16 v[144:159], v[44:47], a[128:131], 0
    ds_read_b64_tr_b16 v[26:27], v13 offset:37888
    ds_read_b64_tr_b16 v[28:29], v7 offset:38912
    ds_read_b64_tr_b16 v[30:31], v7 offset:39936
    buffer_load_dwordx4 a[180:183], v8, s[36:39], s70 offen offset:1024 sc1
    s_waitcnt lgkmcnt(8)
    v_mfma_f32_32x32x16_bf16 v[224:239], v[240:243], a[132:135], v[224:239]
    ds_read_b64_tr_b16 v[32:33], v13 offset:38912
    ds_read_b64_tr_b16 v[34:35], v13 offset:39936
    buffer_load_dwordx4 a[184:187], v8, s[36:39], s70 offen offset:2048 sc1
    s_waitcnt lgkmcnt(8)
    v_mfma_f32_32x32x16_bf16 v[144:159], v[244:247], a[132:135], v[144:159]
    buffer_load_dwordx4 a[188:191], v8, s[36:39], s70 offen offset:3072 sc1
    s_barrier
    s_waitcnt lgkmcnt(6)
    v_mfma_f32_32x32x16_bf16 v[224:239], v[20:23], a[136:139], v[224:239]
    ds_read_b64_tr_b16 v[40:41], v7 offset:49152
    ds_read_b64_tr_b16 v[42:43], v7 offset:50176
    ds_read_b64_tr_b16 v[44:45], v13 offset:49152
    s_waitcnt lgkmcnt(7)
    v_mfma_f32_32x32x16_bf16 v[144:159], v[24:27], a[136:139], v[144:159]
    ds_read_b64_tr_b16 v[46:47], v13 offset:50176
    ds_read_b64_tr_b16 v[240:241], v7 offset:51200
    ds_read_b64_tr_b16 v[242:243], v7 offset:52224
    s_waitcnt lgkmcnt(8)
    v_mfma_f32_32x32x16_bf16 v[224:239], v[28:31], a[140:143], v[224:239]
    ds_read_b64_tr_b16 v[244:245], v13 offset:51200
    ds_read_b64_tr_b16 v[246:247], v13 offset:52224
    s_waitcnt lgkmcnt(8)
    v_mfma_f32_32x32x16_bf16 v[144:159], v[32:35], a[140:143], v[144:159]
    s_barrier
    s_waitcnt vmcnt(8) lgkmcnt(6)
    v_mfma_f32_32x32x16_bf16 v[224:239], v[40:43], a[144:147], v[224:239]
    ds_read_b64_tr_b16 v[20:21], v7 offset:53248
    ds_read_b64_tr_b16 v[22:23], v7 offset:54272
    ds_read_b64_tr_b16 v[24:25], v13 offset:53248
    s_add_u32 m0, s3, 32768
    s_add_u32 s71, s79, 0x50000
    buffer_load_dwordx4 v48, s[20:23], s71 offen lds
    s_waitcnt lgkmcnt(7)
    v_mfma_f32_32x32x16_bf16 v[144:159], v[44:47], a[144:147], v[144:159]
    ds_read_b64_tr_b16 v[26:27], v13 offset:54272
    ds_read_b64_tr_b16 v[28:29], v7 offset:55296
    ds_read_b64_tr_b16 v[30:31], v7 offset:56320
    buffer_load_dwordx4 v49, s[20:23], s71 offen offset:1024 lds
    s_waitcnt lgkmcnt(8)
    v_mfma_f32_32x32x16_bf16 v[224:239], v[240:243], a[148:151], v[224:239]
    ds_read_b64_tr_b16 v[32:33], v13 offset:55296
    ds_read_b64_tr_b16 v[34:35], v13 offset:56320
    v_add_u32 v7, 0x10000, v7
    v_add_u32 v13, 0x10000, v13
    buffer_load_dwordx4 v50, s[20:23], s71 offen offset:2048 lds
    s_waitcnt lgkmcnt(8)
    v_mfma_f32_32x32x16_bf16 v[144:159], v[244:247], a[148:151], v[144:159]
    buffer_load_dwordx4 v51, s[20:23], s71 offen offset:3072 lds
    s_add_u32 s67, s101, 6
    v_mov_b32 v59, s67
    s_add_u32 s67, s66, 6
    v_mov_b32 v61, s67
    buffer_store_dword v59, v55, s[36:39], 0 offen
    s_cmp_eq_u32 s1, 0
    s_cbranch_scc1 L_fq_19
L_fqb_20:
    s_waitcnt lgkmcnt(6)
    v_mfma_f32_32x32x16_bf16 v[224:239], v[20:23], a[152:155], v[224:239]
    ds_read_b64_tr_b16 v[40:41], v7
    ds_read_b64_tr_b16 v[42:43], v7 offset:1024
    ds_read_b64_tr_b16 v[44:45], v13
    s_mov_b32 s70, 0x0
    buffer_load_dwordx4 a[192:195], v8, s[36:39], s70 offen sc1
    s_waitcnt lgkmcnt(7)
    v_mfma_f32_32x32x16_bf16 v[144:159], v[24:27], a[152:155], v[144:159]
    ds_read_b64_tr_b16 v[46:47], v13 offset:1024
    ds_read_b64_tr_b16 v[240:241], v7 offset:2048
    ds_read_b64_tr_b16 v[242:243], v7 offset:3072
    buffer_load_dwordx4 a[196:199], v8, s[36:39], s70 offen offset:1024 sc1
    s_waitcnt lgkmcnt(8)
    v_mfma_f32_32x32x16_bf16 v[224:239], v[28:31], a[156:159], v[224:239]
    ds_read_b64_tr_b16 v[244:245], v13 offset:2048
    ds_read_b64_tr_b16 v[246:247], v13 offset:3072
    buffer_load_dwordx4 a[200:203], v8, s[36:39], s70 offen offset:2048 sc1
    s_waitcnt lgkmcnt(8)
    v_mfma_f32_32x32x16_bf16 v[144:159], v[32:35], a[156:159], v[144:159]
    buffer_load_dwordx4 a[204:207], v8, s[36:39], s70 offen offset:3072 sc1
    s_barrier
    s_waitcnt vmcnt(13) lgkmcnt(6)
    v_mfma_f32_32x32x16_bf16 v[224:239], v[40:43], a[160:163], v[224:239]
    ds_read_b64_tr_b16 v[20:21], v7 offset:4096
    ds_read_b64_tr_b16 v[22:23], v7 offset:5120
    ds_read_b64_tr_b16 v[24:25], v13 offset:4096
    s_add_u32 m0, s3, 49152
    s_add_u32 s71, s79, 0x90000
    buffer_load_dwordx4 v48, s[20:23], s71 offen lds
    s_waitcnt lgkmcnt(7)
    v_mfma_f32_32x32x16_bf16 v[144:159], v[44:47], a[160:163], v[144:159]
    ds_read_b64_tr_b16 v[26:27], v13 offset:5120
    ds_read_b64_tr_b16 v[28:29], v7 offset:6144
    ds_read_b64_tr_b16 v[30:31], v7 offset:7168
    buffer_load_dwordx4 v49, s[20:23], s71 offen offset:1024 lds
    s_waitcnt lgkmcnt(8)
    v_mfma_f32_32x32x16_bf16 v[224:239], v[240:243], a[164:167], v[224:239]
    ds_read_b64_tr_b16 v[32:33], v13 offset:6144
    ds_read_b64_tr_b16 v[34:35], v13 offset:7168
    buffer_load_dwordx4 v50, s[20:23], s71 offen offset:2048 lds
    s_waitcnt lgkmcnt(8)
    v_mfma_f32_32x32x16_bf16 v[144:159], v[244:247], a[164:167], v[144:159]
    buffer_load_dwordx4 v51, s[20:23], s71 offen offset:3072 lds
    s_waitcnt lgkmcnt(6)
    v_mfma_f32_32x32x16_bf16 v[224:239], v[20:23], a[168:171], v[224:239]
    ds_read_b64_tr_b16 v[40:41], v7 offset:16384
    ds_read_b64_tr_b16 v[42:43], v7 offset:17408
    ds_read_b64_tr_b16 v[44:45], v13 offset:16384
    s_mov_b32 s70, 0x2000
    buffer_load_dwordx4 a[208:211], v8, s[36:39], s70 offen sc1
    s_waitcnt lgkmcnt(7)
    v_mfma_f32_32x32x16_bf16 v[144:159], v[24:27], a[168:171], v[144:159]
    ds_read_b64_tr_b16 v[46:47], v13 offset:17408
    ds_read_b64_tr_b16 v[240:241], v7 offset:18432
    ds_read_b64_tr_b16 v[242:243], v7 offset:19456
    buffer_load_dwordx4 a[212:215], v8, s[36:39], s70 offen offset:1024 sc1
    s_waitcnt lgkmcnt(8)
    v_mfma_f32_32x32x16_bf16 v[224:239], v[28:31], a[172:175], v[224:239]
    ds_read_b64_tr_b16 v[244:245], v13 offset:18432
    ds_read_b64_tr_b16 v[246:247], v13 offset:19456
    buffer_load_dwordx4 a[216:219], v8, s[36:39], s70 offen offset:2048 sc1
    s_waitcnt lgkmcnt(8)
    v_mfma_f32_32x32x16_bf16 v[144:159], v[32:35], a[172:175], v[144:159]
    buffer_load_dwordx4 a[220:223], v8, s[36:39], s70 offen offset:3072 sc1
    s_barrier
    s_waitcnt vmcnt(17) lgkmcnt(6)
    v_mfma_f32_32x32x16_bf16 v[224:239], v[40:43], a[176:179], v[224:239]
    ds_read_b64_tr_b16 v[20:21], v7 offset:20480
    ds_read_b64_tr_b16 v[22:23], v7 offset:21504
    ds_read_b64_tr_b16 v[24:25], v13 offset:20480
    s_add_u32 m0, s3, 65536
    s_add_u32 s71, s79, 0xd0000
    buffer_load_dwordx4 v48, s[20:23], s71 offen lds
    s_waitcnt lgkmcnt(7)
    v_mfma_f32_32x32x16_bf16 v[144:159], v[44:47], a[176:179], v[144:159]
    ds_read_b64_tr_b16 v[26:27], v13 offset:21504
    ds_read_b64_tr_b16 v[28:29], v7 offset:22528
    ds_read_b64_tr_b16 v[30:31], v7 offset:23552
    buffer_load_dwordx4 v49, s[20:23], s71 offen offset:1024 lds
    s_waitcnt lgkmcnt(8)
    v_mfma_f32_32x32x16_bf16 v[224:239], v[240:243], a[180:183], v[224:239]
    ds_read_b64_tr_b16 v[32:33], v13 offset:22528
    ds_read_b64_tr_b16 v[34:35], v13 offset:23552
    buffer_load_dwordx4 v50, s[20:23], s71 offen offset:2048 lds
    s_waitcnt lgkmcnt(8)
    v_mfma_f32_32x32x16_bf16 v[144:159], v[244:247], a[180:183], v[144:159]
    buffer_load_dwordx4 v51, s[20:23], s71 offen offset:3072 lds
    buffer_load_dword v57, v56, s[36:39], 0 offen sc1
    s_waitcnt lgkmcnt(6)
    v_mfma_f32_32x32x16_bf16 v[224:239], v[20:23], a[184:187], v[224:239]
    ds_read_b64_tr_b16 v[40:41], v7 offset:32768
    ds_read_b64_tr_b16 v[42:43], v7 offset:33792
    ds_read_b64_tr_b16 v[44:45], v13 offset:32768
    s_mov_b32 s70, 0x4000
    buffer_load_dwordx4 a[224:227], v8, s[36:39], s70 offen sc1
    s_waitcnt lgkmcnt(7)
    v_mfma_f32_32x32x16_bf16 v[144:159], v[24:27], a[184:187], v[144:159]
    ds_read_b64_tr_b16 v[46:47], v13 offset:33792
    ds_read_b64_tr_b16 v[240:241], v7 offset:34816
    ds_read_b64_tr_b16 v[242:243], v7 offset:35840
    buffer_load_dwordx4 a[228:231], v8, s[36:39], s70 offen offset:1024 sc1
    s_waitcnt lgkmcnt(8)
    v_mfma_f32_32x32x16_bf16 v[224:239], v[28:31], a[188:191], v[224:239]
    ds_read_b64_tr_b16 v[244:245], v13 offset:34816
    ds_read_b64_tr_b16 v[246:247], v13 offset:35840
    buffer_load_dwordx4 a[232:235], v8, s[36:39], s70 offen offset:2048 sc1
    s_waitcnt lgkmcnt(8)
    v_mfma_f32_32x32x16_bf16 v[144:159], v[32:35], a[188:191], v[144:159]
    buffer_load_dwordx4 a[236:239], v8, s[36:39], s70 offen offset:3072 sc1
    s_barrier
    s_waitcnt vmcnt(17) lgkmcnt(6)
    v_mfma_f32_32x32x16_bf16 v[224:239], v[40:43], a[192:195], v[224:239]
    ds_read_b64_tr_b16 v[20:21], v7 offset:36864
    ds_read_b64_tr_b16 v[22:23], v7 offset:37888
    ds_read_b64_tr_b16 v[24:25], v13 offset:36864
    s_add_u32 m0, s3, 81920
    s_add_u32 s71, s47, 0x110000
    buffer_load_dwordx4 v48, s[20:23], s71 offen lds
    s_waitcnt lgkmcnt(7)
    v_mfma_f32_32x32x16_bf16 v[144:159], v[44:47], a[192:195], v[144:159]
    ds_read_b64_tr_b16 v[26:27], v13 offset:37888
    ds_read_b64_tr_b16 v[28:29], v7 offset:38912
    ds_read_b64_tr_b16 v[30:31], v7 offset:39936
    buffer_load_dwordx4 v49, s[20:23], s71 offen offset:1024 lds
    s_waitcnt lgkmcnt(8)
    v_mfma_f32_32x32x16_bf16 v[224:239], v[240:243], a[196:199], v[224:239]
    ds_read_b64_tr_b16 v[32:33], v13 offset:38912
    ds_read_b64_tr_b16 v[34:35], v13 offset:39936
    buffer_load_dwordx4 v50, s[20:23], s71 offen offset:2048 lds
    s_waitcnt lgkmcnt(8)
    v_mfma_f32_32x32x16_bf16 v[144:159], v[244:247], a[196:199], v[144:159]
    buffer_load_dwordx4 v51, s[20:23], s71 offen offset:3072 lds
    s_waitcnt lgkmcnt(6)
    v_mfma_f32_32x32x16_bf16 v[224:239], v[20:23], a[200:203], v[224:239]
    ds_read_b64_tr_b16 v[40:41], v7 offset:49152
    ds_read_b64_tr_b16 v[42:43], v7 offset:50176
    ds_read_b64_tr_b16 v[44:45], v13 offset:49152
    s_mov_b32 s70, 0x6000
    buffer_load_dwordx4 a[240:243], v8, s[36:39], s70 offen sc1
    s_waitcnt lgkmcnt(7)
    v_mfma_f32_32x32x16_bf16 v[144:159], v[24:27], a[200:203], v[144:159]
    ds_read_b64_tr_b16 v[46:47], v13 offset:50176
    ds_read_b64_tr_b16 v[240:241], v7 offset:51200
    ds_read_b64_tr_b16 v[242:243], v7 offset:52224
    buffer_load_dwordx4 a[244:247], v8, s[36:39], s70 offen offset:1024 sc1
    s_waitcnt lgkmcnt(8)
    v_mfma_f32_32x32x16_bf16 v[224:239], v[28:31], a[204:207], v[224:239]
    ds_read_b64_tr_b16 v[244:245], v13 offset:51200
    ds_read_b64_tr_b16 v[246:247], v13 offset:52224
    buffer_load_dwordx4 a[248:251], v8, s[36:39], s70 offen offset:2048 sc1
    s_waitcnt lgkmcnt(8)
    v_mfma_f32_32x32x16_bf16 v[144:159], v[32:35], a[204:207], v[144:159]
    buffer_load_dwordx4 a[252:255], v8, s[36:39], s70 offen offset:3072 sc1
    s_barrier
    s_waitcnt vmcnt(17) lgkmcnt(6)
    v_mfma_f32_32x32x16_bf16 v[224:239], v[40:43], a[208:211], v[224:239]
    ds_read_b64_tr_b16 v[20:21], v7 offset:53248
    ds_read_b64_tr_b16 v[22:23], v7 offset:54272
    ds_read_b64_tr_b16 v[24:25], v13 offset:53248
    s_add_u32 m0, s3, 98304
    s_add_u32 s71, s47, 0x170000
    buffer_load_dwordx4 v48, s[20:23], s71 offen lds
    s_waitcnt lgkmcnt(7)
    v_mfma_f32_32x32x16_bf16 v[144:159], v[44:47], a[208:211], v[144:159]
    ds_read_b64_tr_b16 v[26:27], v13 offset:54272
    ds_read_b64_tr_b16 v[28:29], v7 offset:55296
    ds_read_b64_tr_b16 v[30:31], v7 offset:56320
    buffer_load_dwordx4 v49, s[20:23], s71 offen offset:1024 lds
    s_waitcnt lgkmcnt(8)
    v_mfma_f32_32x32x16_bf16 v[224:239], v[240:243], a[212:215], v[224:239]
    ds_read_b64_tr_b16 v[32:33], v13 offset:55296
    ds_read_b64_tr_b16 v[34:35], v13 offset:56320
    v_add_u32 v7, 0x10000, v7
    v_add_u32 v13, 0x10000, v13
    buffer_load_dwordx4 v50, s[20:23], s71 offen offset:2048 lds
    s_waitcnt lgkmcnt(8)
    v_mfma_f32_32x32x16_bf16 v[144:159], v[244:247], a[212:215], v[144:159]
    buffer_load_dwordx4 v51, s[20:23], s71 offen offset:3072 lds
    s_waitcnt vmcnt(16)
    v_subrev_u32 v57, s101, v57
    v_cmp_gt_u32 vcc, 8, v57
    s_nop 1
    v_cndmask_b32 v57, 0, v57, vcc
    v_cmp_lt_u32 vcc, v57, v12
    s_nop 1
    s_cbranch_vccnz L_slow_21
L_back_22:
    s_waitcnt lgkmcnt(6)
    v_mfma_f32_32x32x16_bf16 v[224:239], v[20:23], a[216:219], v[224:239]
    ds_read_b64_tr_b16 v[40:41], v7
    ds_read_b64_tr_b16 v[42:43], v7 offset:1024
    ds_read_b64_tr_b16 v[44:45], v13
    s_mov_b32 s70, 0x14000
    buffer_load_dwordx4 a[128:131], v8, s[36:39], s70 offen sc1
    s_waitcnt lgkmcnt(7)
    v_mfma_f32_32x32x16_bf16 v[144:159], v[24:27], a[216:219], v[144:159]
    ds_read_b64_tr_b16 v[46:47], v13 offset:1024
    ds_read_b64_tr_b16 v[240:241], v7 offset:2048
    ds_read_b64_tr_b16 v[242:243], v7 offset:3072
    buffer_load_dwordx4 a[132:135], v8, s[36:39], s70 offen offset:1024 sc1
    s_waitcnt lgkmcnt(8)
    v_mfma_f32_32x32x16_bf16 v[224:239], v[28:31], a[220:223], v[224:239]
    ds_read_b64_tr_b16 v[244:245], v13 offset:2048
    ds_read_b64_tr_b16 v[246:247], v13 offset:3072
    buffer_load_dwordx4 a[136:139], v8, s[36:39], s70 offen offset:2048 sc1
    s_waitcnt lgkmcnt(8)
    v_mfma_f32_32x32x16_bf16 v[144:159], v[32:35], a[220:223], v[144:159]
    buffer_load_dwordx4 a[140:143], v8, s[36:39], s70 offen offset:3072 sc1
    s_barrier
    s_waitcnt vmcnt(16) lgkmcnt(6)
    v_mfma_f32_32x32x16_bf16 v[224:239], v[40:43], a[224:227], v[224:239]
    ds_read_b64_tr_b16 v[20:21], v7 offset:4096
    ds_read_b64_tr_b16 v[22:23], v7 offset:5120
    ds_read_b64_tr_b16 v[24:25], v13 offset:4096
    s_add_u32 m0, s3, 114688
    s_mov_b32 s71, 0x0
    buffer_load_dwordx4 v48, s[24:27], s71 offen lds
    s_waitcnt lgkmcnt(7)
    v_mfma_f32_32x32x16_bf16 v[144:159], v[44:47], a[224:227], v[144:159]
    ds_read_b64_tr_b16 v[26:27], v13 offset:5120
    ds_read_b64_tr_b16 v[28:29], v7 offset:6144
    ds_read_b64_tr_b16 v[30:31], v7 offset:7168
    buffer_load_dwordx4 v49, s[24:27], s71 offen offset:1024 lds
    s_waitcnt lgkmcnt(8)
    v_mfma_f32_32x32x16_bf16 v[224:239], v[240:243], a[228:231], v[224:239]
    ds_read_b64_tr_b16 v[32:33], v13 offset:6144
    ds_read_b64_tr_b16 v[34:35], v13 offset:7168
    v_add_u32 v7, 0xfffe0000, v7
    v_add_u32 v13, 0xfffe0000, v13
    buffer_load_dwordx4 v50, s[24:27], s71 offen offset:2048 lds
    s_waitcnt lgkmcnt(8)
    v_mfma_f32_32x32x16_bf16 v[144:159], v[244:247], a[228:231], v[144:159]
    buffer_load_dwordx4 v51, s[24:27], s71 offen offset:3072 lds
    s_waitcnt lgkmcnt(6)
    v_mfma_f32_32x32x16_bf16 v[224:239], v[20:23], a[232:235], v[224:239]
    ds_read_b64_tr_b16 v[40:41], v7
    ds_read_b64_tr_b16 v[42:43], v7 offset:1024
    ds_read_b64_tr_b16 v[44:45], v13
    s_mov_b32 s70, 0x16000
    buffer_load_dwordx4 a[144:147], v8, s[36:39], s70 offen sc1
    s_waitcnt lgkmcnt(7)
    v_mfma_f32_32x32x16_bf16 v[144:159], v[24:27], a[232:235], v[144:159]
    ds_read_b64_tr_b16 v[46:47], v13 offset:1024
    ds_read_b64_tr_b16 v[240:241], v7 offset:2048
    ds_read_b64_tr_b16 v[242:243], v7 offset:3072
    buffer_load_dwordx4 a[148:151], v8, s[36:39], s70 offen offset:1024 sc1
    s_waitcnt lgkmcnt(8)
    v_mfma_f32_32x32x16_bf16 v[224:239], v[28:31], a[236:239], v[224:239]
    ds_read_b64_tr_b16 v[244:245], v13 offset:2048
    ds_read_b64_tr_b16 v[246:247], v13 offset:3072
    buffer_load_dwordx4 a[152:155], v8, s[36:39], s70 offen offset:2048 sc1
    s_waitcnt lgkmcnt(8)
    v_mfma_f32_32x32x16_bf16 v[144:159], v[32:35], a[236:239], v[144:159]
    buffer_load_dwordx4 a[156:159], v8, s[36:39], s70 offen offset:3072 sc1
    s_barrier
    s_waitcnt vmcnt(16) lgkmcnt(6)
    v_mfma_f32_32x32x16_bf16 v[224:239], v[40:43], a[240:243], v[224:239]
    ds_read_b64_tr_b16 v[20:21], v7 offset:4096
    ds_read_b64_tr_b16 v[22:23], v7 offset:5120
    ds_read_b64_tr_b16 v[24:25], v13 offset:4096
    s_add_u32 m0, s3, 131072
    s_mov_b32 s71, 0x20000
    buffer_load_dwordx4 v48, s[24:27], s71 offen lds
    s_waitcnt lgkmcnt(7)
    v_mfma_f32_32x32x16_bf16 v[144:159], v[44:47], a[240:243], v[144:159]
    ds_read_b64_tr_b16 v[26:27], v13 offset:5120
    ds_read_b64_tr_b16 v[28:29], v7 offset:6144
    ds_read_b64_tr_b16 v[30:31], v7 offset:7168
    buffer_load_dwordx4 v49, s[24:27], s71 offen offset:1024 lds
    s_waitcnt lgkmcnt(8)
    v_mfma_f32_32x32x16_bf16 v[224:239], v[240:243], a[244:247], v[224:239]
    ds_read_b64_tr_b16 v[32:33], v13 offset:6144
    ds_read_b64_tr_b16 v[34:35], v13 offset:7168
    buffer_load_dwordx4 v50, s[24:27], s71 offen offset:2048 lds
    s_waitcnt lgkmcnt(8)
    v_mfma_f32_32x32x16_bf16 v[144:159], v[244:247], a[244:247], v[144:159]
    buffer_load_dwordx4 v51, s[24:27], s71 offen offset:3072 lds
    s_waitcnt lgkmcnt(6)
    v_mfma_f32_32x32x16_bf16 v[224:239], v[20:23], a[248:251], v[224:239]
    ds_read_b64_tr_b16 v[40:41], v7 offset:16384
    ds_read_b64_tr_b16 v[42:43], v7 offset:17408
    ds_read_b64_tr_b16 v[44:45], v13 offset:16384
    s_mov_b32 s70, 0x18000
    buffer_load_dwordx4 a[160:163], v8, s[36:39], s70 offen sc1
    s_waitcnt lgkmcnt(7)
    v_mfma_f32_32x32x16_bf16 v[144:159], v[24:27], a[248:251], v[144:159]
    ds_read_b64_tr_b16 v[46:47], v13 offset:17408
    ds_read_b64_tr_b16 v[240:241], v7 offset:18432
    ds_read_b64_tr_b16 v[242:243], v7 offset:19456
    buffer_load_dwordx4 a[164:167], v8, s[36:39], s70 offen offset:1024 sc1
    s_waitcnt lgkmcnt(8)
    v_mfma_f32_32x32x16_bf16 v[224:239], v[28:31], a[252:255], v[224:239]
    ds_read_b64_tr_b16 v[244:245], v13 offset:18432
    ds_read_b64_tr_b16 v[246:247], v13 offset:19456
    buffer_load_dwordx4 a[168:171], v8, s[36:39], s70 offen offset:2048 sc1
    s_waitcnt lgkmcnt(8)
    v_mfma_f32_32x32x16_bf16 v[144:159], v[32:35], a[252:255], v[144:159]
    buffer_load_dwordx4 a[172:175], v8, s[36:39], s70 offen offset:3072 sc1
    s_barrier
    s_waitcnt vmcnt(16) lgkmcnt(6)
    v_mfma_f32_32x32x16_bf16 v[224:239], v[40:43], a[128:131], v[224:239]
    ds_read_b64_tr_b16 v[20:21], v7 offset:20480
    ds_read_b64_tr_b16 v[22:23], v7 offset:21504
    ds_read_b64_tr_b16 v[24:25], v13 offset:20480
    s_add_u32 m0, s3, 0
    s_mov_b32 s71, 0x40000
    buffer_load_dwordx4 v48, s[24:27], s71 offen lds
    s_waitcnt lgkmcnt(7)
    v_mfma_f32_32x32x16_bf16 v[144:159], v[44:47], a[128:131], v[144:159]
    ds_read_b64_tr_b16 v[26:27], v13 offset:21504
    ds_read_b64_tr_b16 v[28:29], v7 offset:22528
    ds_read_b64_tr_b16 v[30:31], v7 offset:23552
    buffer_load_dwordx4 v49, s[24:27], s71 offen offset:1024 lds
    s_waitcnt lgkmcnt(8)
    v_mfma_f32_32x32x16_bf16 v[224:239], v[240:243], a[132:135], v[224:239]
    ds_read_b64_tr_b16 v[32:33], v13 offset:22528
    ds_read_b64_tr_b16 v[34:35], v13 offset:23552
    buffer_load_dwordx4 v50, s[24:27], s71 offen offset:2048 lds
    s_waitcnt lgkmcnt(8)
    v_mfma_f32_32x32x16_bf16 v[144:159], v[244:247], a[132:135], v[144:159]
    buffer_load_dwordx4 v51, s[24:27], s71 offen offset:3072 lds
    s_waitcnt lgkmcnt(6)
    v_mfma_f32_32x32x16_bf16 v[224:239], v[20:23], a[136:139], v[224:239]
    ds_read_b64_tr_b16 v[40:41], v7 offset:32768
    ds_read_b64_tr_b16 v[42:43], v7 offset:33792
    ds_read_b64_tr_b16 v[44:45], v13 offset:32768
    s_mov_b32 s70, 0x1a000
    buffer_load_dwordx4 a[176:179], v8, s[36:39], s70 offen sc1
    s_waitcnt lgkmcnt(7)
    v_mfma_f32_32x32x16_bf16 v[144:159], v[24:27], a[136:139], v[144:159]
    ds_read_b64_tr_b16 v[46:47], v13 offset:33792
    ds_read_b64_tr_b16 v[240:241], v7 offset:34816
    ds_read_b64_tr_b16 v[242:243], v7 offset:35840
    buffer_load_dwordx4 a[180:183], v8, s[36:39], s70 offen offset:1024 sc1
    s_waitcnt lgkmcnt(8)
    v_mfma_f32_32x32x16_bf16 v[224:239], v[28:31], a[140:143], v[224:239]
    ds_read_b64_tr_b16 v[244:245], v13 offset:34816
    ds_read_b64_tr_b16 v[246:247], v13 offset:35840
    buffer_load_dwordx4 a[184:187], v8, s[36:39], s70 offen offset:2048 sc1
    s_waitcnt lgkmcnt(8)
    v_mfma_f32_32x32x16_bf16 v[144:159], v[32:35], a[140:143], v[144:159]
    buffer_load_dwordx4 a[188:191], v8, s[36:39], s70 offen offset:3072 sc1
    s_barrier
    s_waitcnt vmcnt(16) lgkmcnt(6)
    v_mfma_f32_32x32x16_bf16 v[224:239], v[40:43], a[144:147], v[224:239]
    ds_read_b64_tr_b16 v[20:21], v7 offset:36864
    ds_read_b64_tr_b16 v[22:23], v7 offset:37888
    ds_read_b64_tr_b16 v[24:25], v13 offset:36864
    s_add_u32 m0, s3, 16384
    s_mov_b32 s71, 0x60000
    buffer_load_dwordx4 v48, s[24:27], s71 offen lds
    s_waitcnt lgkmcnt(7)
    v_mfma_f32_32x32x16_bf16 v[144:159], v[44:47], a[144:147], v[144:159]
    ds_read_b64_tr_b16 v[26:27], v13 offset:37888
    ds_read_b64_tr_b16 v[28:29], v7 offset:38912
    ds_read_b64_tr_b16 v[30:31], v7 offset:39936
    buffer_load_dwordx4 v49, s[24:27], s71 offen offset:1024 lds
    s_waitcnt lgkmcnt(8)
    v_mfma_f32_32x32x16_bf16 v[224:239], v[240:243], a[148:151], v[224:239]
    ds_read_b64_tr_b16 v[32:33], v13 offset:38912
    ds_read_b64_tr_b16 v[34:35], v13 offset:39936
    buffer_load_dwordx4 v50, s[24:27], s71 offen offset:2048 lds
    s_waitcnt lgkmcnt(8)
    v_mfma_f32_32x32x16_bf16 v[144:159], v[244:247], a[148:151], v[144:159]
    buffer_load_dwordx4 v51, s[24:27], s71 offen offset:3072 lds
    s_waitcnt lgkmcnt(6)
    v_mfma_f32_32x32x16_bf16 v[224:239], v[20:23], a[152:155], v[224:239]
    ds_read_b64_tr_b16 v[40:41], v7 offset:49152
    ds_read_b64_tr_b16 v[42:43], v7 offset:50176
    ds_read_b64_tr_b16 v[44:45], v13 offset:49152
    s_mov_b32 s70, 0x8000
    buffer_load_dwordx4 a[192:195], v8, s[36:39], s70 offen sc1
    s_waitcnt lgkmcnt(7)
    v_mfma_f32_32x32x16_bf16 v[144:159], v[24:27], a[152:155], v[144:159]
    ds_read_b64_tr_b16 v[46:47], v13 offset:50176
    ds_read_b64_tr_b16 v[240:241], v7 offset:51200
    ds_read_b64_tr_b16 v[242:243], v7 offset:52224
    buffer_load_dwordx4 a[196:199], v8, s[36:39], s70 offen offset:1024 sc1
    s_waitcnt lgkmcnt(8)
    v_mfma_f32_32x32x16_bf16 v[224:239], v[28:31], a[156:159], v[224:239]
    ds_read_b64_tr_b16 v[244:245], v13 offset:51200
    ds_read_b64_tr_b16 v[246:247], v13 offset:52224
    buffer_load_dwordx4 a[200:203], v8, s[36:39], s70 offen offset:2048 sc1
    s_waitcnt lgkmcnt(8)
    v_mfma_f32_32x32x16_bf16 v[144:159], v[32:35], a[156:159], v[144:159]
    buffer_load_dwordx4 a[204:207], v8, s[36:39], s70 offen offset:3072 sc1
    s_barrier
    s_waitcnt vmcnt(16) lgkmcnt(6)
    v_mfma_f32_32x32x16_bf16 v[224:239], v[40:43], a[160:163], v[224:239]
    ds_read_b64_tr_b16 v[20:21], v7 offset:53248
    ds_read_b64_tr_b16 v[22:23], v7 offset:54272
    ds_read_b64_tr_b16 v[24:25], v13 offset:53248
    s_mov_b32 s70, 0xa000
    buffer_load_dwordx4 a[208:211], v8, s[36:39], s70 offen sc1
    s_waitcnt lgkmcnt(7)
    v_mfma_f32_32x32x16_bf16 v[144:159], v[44:47], a[160:163], v[144:159]
    ds_read_b64_tr_b16 v[26:27], v13 offset:54272
    ds_read_b64_tr_b16 v[28:29], v7 offset:55296
    ds_read_b64_tr_b16 v[30:31], v7 offset:56320
    buffer_load_dwordx4 a[212:215], v8, s[36:39], s70 offen offset:1024 sc1
    s_waitcnt lgkmcnt(8)
    v_mfma_f32_32x32x16_bf16 v[224:239], v[240:243], a[164:167], v[224:239]
    ds_read_b64_tr_b16 v[32:33], v13 offset:55296
    ds_read_b64_tr_b16 v[34:35], v13 offset:56320
    v_add_u32 v7, 0x10000, v7
    v_add_u32 v13, 0x10000, v13
    buffer_load_dwordx4 a[216:219], v8, s[36:39], s70 offen offset:2048 sc1
    s_waitcnt lgkmcnt(8)
    v_mfma_f32_32x32x16_bf16 v[144:159], v[244:247], a[164:167], v[144:159]
    buffer_load_dwordx4 a[220:223], v8, s[36:39], s70 offen offset:3072 sc1
    s_waitcnt lgkmcnt(6)
    v_mfma_f32_32x32x16_bf16 v[224:239], v[20:23], a[168:171], v[224:239]
    ds_read_b64_tr_b16 v[40:41], v7
    ds_read_b64_tr_b16 v[42:43], v7 offset:1024
    ds_read_b64_tr_b16 v[44:45], v13
    s_and_b32 s67, s62, 1
    s_lshl_b32 s67, s67, 13
    s_lshr_b32 s68, s62, 1
    s_mul_i32 s68, s68, 16512
    s_waitcnt lgkmcnt(7)
    v_mfma_f32_32x32x16_bf16 v[144:159], v[24:27], a[168:171], v[144:159]
    ds_read_b64_tr_b16 v[46:47], v13 offset:1024
    ds_read_b64_tr_b16 v[240:241], v7 offset:2048
    ds_read_b64_tr_b16 v[242:243], v7 offset:3072
    s_add_u32 s67, s67, s68
    s_add_u32 s67, s67, 32768
    v_and_b32 v3, 31, v1
    v_lshl_add_u32 v3, v3, 8, s67
    s_waitcnt lgkmcnt(8)
    v_mfma_f32_32x32x16_bf16 v[224:239], v[28:31], a[172:175], v[224:239]
    ds_read_b64_tr_b16 v[244:245], v13 offset:2048
    ds_read_b64_tr_b16 v[246:247], v13 offset:3072
    v_lshrrev_b32 v4, 5, v1
    v_xor_b32 v4, v4, v1
    v_and_b32 v4, 7, v4
    v_xor_b32 v5, 0, v4
    v_lshl_add_u32 v180, v5, 4, v3
    s_waitcnt lgkmcnt(8)
    v_mfma_f32_32x32x16_bf16 v[144:159], v[32:35], a[172:175], v[144:159]
    v_xor_b32 v184, 128, v180
    v_xor_b32 v5, 2, v4
    v_lshl_add_u32 v181, v5, 4, v3
    v_xor_b32 v185, 128, v181
    v_xor_b32 v5, 4, v4
    v_lshl_add_u32 v182, v5, 4, v3
    v_xor_b32 v186, 128, v182
    s_barrier
    s_waitcnt vmcnt(12) lgkmcnt(6)
    v_mfma_f32_32x32x16_bf16 v[224:239], v[40:43], a[176:179], v[224:239]
    ds_read_b64_tr_b16 v[20:21], v7 offset:4096
    ds_read_b64_tr_b16 v[22:23], v7 offset:5120
    ds_read_b64_tr_b16 v[24:25], v13 offset:4096
    s_mov_b32 s70, 0x1c000
    buffer_load_dwordx4 a[224:227], v8, s[36:39], s70 offen sc1
    v_xor_b32 v5, 6, v4
    v_lshl_add_u32 v183, v5, 4, v3
    s_waitcnt lgkmcnt(7)
    v_mfma_f32_32x32x16_bf16 v[144:159], v[44:47], a[176:179], v[144:159]
    ds_read_b64_tr_b16 v[26:27], v13 offset:5120
    ds_read_b64_tr_b16 v[28:29], v7 offset:6144
    ds_read_b64_tr_b16 v[30:31], v7 offset:7168
    buffer_load_dwordx4 a[228:231], v8, s[36:39], s70 offen offset:1024 sc1
    v_xor_b32 v187, 128, v183
    v_lshrrev_b32 v3, 3, v1
    v_and_b32 v4, 7, v1
    s_waitcnt lgkmcnt(8)
    v_mfma_f32_32x32x16_bf16 v[224:239], v[240:243], a[180:183], v[224:239]
    ds_read_b64_tr_b16 v[32:33], v13 offset:6144
    ds_read_b64_tr_b16 v[34:35], v13 offset:7168
    buffer_load_dwordx4 a[232:235], v8, s[36:39], s70 offen offset:2048 sc1
    v_lshlrev_b32 v4, 1, v4
    v_xor_b32 v4, v4, v3
    s_lshl_b32 s67, s62, 12
    s_add_u32 s67, s67, 32768
    s_waitcnt lgkmcnt(8)
    v_mfma_f32_32x32x16_bf16 v[144:159], v[244:247], a[180:183], v[144:159]
    buffer_load_dwordx4 a[236:239], v8, s[36:39], s70 offen offset:3072 sc1
    v_lshl_add_u32 v3, v3, 8, s67
    v_lshl_add_u32 v188, v4, 4, v3
    v_xor_b32 v189, 16, v188
    s_waitcnt lgkmcnt(6)
    v_mfma_f32_32x32x16_bf16 v[224:239], v[20:23], a[184:187], v[224:239]
    ds_read_b64_tr_b16 v[40:41], v7 offset:16384
    ds_read_b64_tr_b16 v[42:43], v7 offset:17408
    ds_read_b64_tr_b16 v[44:45], v13 offset:16384
    s_waitcnt lgkmcnt(7)
    v_mfma_f32_32x32x16_bf16 v[144:159], v[24:27], a[184:187], v[144:159]
    ds_read_b64_tr_b16 v[46:47], v13 offset:17408
    ds_read_b64_tr_b16 v[240:241], v7 offset:18432
    ds_read_b64_tr_b16 v[242:243], v7 offset:19456
    s_waitcnt lgkmcnt(8)
    v_mfma_f32_32x32x16_bf16 v[224:239], v[28:31], a[188:191], v[224:239]
    ds_read_b64_tr_b16 v[244:245], v13 offset:18432
    ds_read_b64_tr_b16 v[246:247], v13 offset:19456
    s_waitcnt lgkmcnt(8)
    v_mfma_f32_32x32x16_bf16 v[144:159], v[32:35], a[188:191], v[144:159]
    s_barrier
    s_waitcnt vmcnt(8) lgkmcnt(6)
    v_mfma_f32_32x32x16_bf16 v[224:239], v[40:43], a[192:195], v[224:239]
    ds_read_b64_tr_b16 v[20:21], v7 offset:20480
    ds_read_b64_tr_b16 v[22:23], v7 offset:21504
    ds_read_b64_tr_b16 v[24:25], v13 offset:20480
    s_mov_b32 s70, 0x1e000
    buffer_load_dwordx4 a[240:243], v8, s[36:39], s70 offen sc1
    s_waitcnt lgkmcnt(7)
    v_mfma_f32_32x32x16_bf16 v[144:159], v[44:47], a[192:195], v[144:159]
    ds_read_b64_tr_b16 v[26:27], v13 offset:21504
    ds_read_b64_tr_b16 v[28:29], v7 offset:22528
    ds_read_b64_tr_b16 v[30:31], v7 offset:23552
    buffer_load_dwordx4 a[244:247], v8, s[36:39], s70 offen offset:1024 sc1
    s_waitcnt lgkmcnt(8)
    v_mfma_f32_32x32x16_bf16 v[224:239], v[240:243], a[196:199], v[224:239]
    ds_read_b64_tr_b16 v[32:33], v13 offset:22528
    ds_read_b64_tr_b16 v[34:35], v13 offset:23552
    buffer_load_dwordx4 a[248:251], v8, s[36:39], s70 offen offset:2048 sc1
    s_waitcnt lgkmcnt(8)
    v_mfma_f32_32x32x16_bf16 v[144:159], v[244:247], a[196:199], v[144:159]
    buffer_load_dwordx4 a[252:255], v8, s[36:39], s70 offen offset:3072 sc1
    s_waitcnt lgkmcnt(6)
    v_mfma_f32_32x32x16_bf16 v[224:239], v[20:23], a[200:203], v[224:239]
    ds_read_b64_tr_b16 v[40:41], v7 offset:32768
    ds_read_b64_tr_b16 v[42:43], v7 offset:33792
    ds_read_b64_tr_b16 v[44:45], v13 offset:32768
    s_waitcnt lgkmcnt(7)
    v_mfma_f32_32x32x16_bf16 v[144:159], v[24:27], a[200:203], v[144:159]
    ds_read_b64_tr_b16 v[46:47], v13 offset:33792
    ds_read_b64_tr_b16 v[240:241], v7 offset:34816
    ds_read_b64_tr_b16 v[242:243], v7 offset:35840
    s_waitcnt lgkmcnt(8)
    v_mfma_f32_32x32x16_bf16 v[224:239], v[28:31], a[204:207], v[224:239]
    ds_read_b64_tr_b16 v[244:245], v13 offset:34816
    ds_read_b64_tr_b16 v[246:247], v13 offset:35840
    s_waitcnt lgkmcnt(8)
    v_mfma_f32_32x32x16_bf16 v[144:159], v[32:35], a[204:207], v[144:159]
    s_barrier
    s_waitcnt vmcnt(8) lgkmcnt(6)
    v_mfma_f32_32x32x16_bf16 v[224:239], v[40:43], a[208:211], v[224:239]
    ds_read_b64_tr_b16 v[20:21], v7 offset:36864
    ds_read_b64_tr_b16 v[22:23], v7 offset:37888
    ds_read_b64_tr_b16 v[24:25], v13 offset:36864
    s_mov_b32 s70, 0x20000
    buffer_load_dwordx4 a[128:131], v8, s[36:39], s70 offen sc1
    s_waitcnt lgkmcnt(7)
    v_mfma_f32_32x32x16_bf16 v[144:159], v[44:47], a[208:211], v[144:159]
    ds_read_b64_tr_b16 v[26:27], v13 offset:37888
    ds_read_b64_tr_b16 v[28:29], v7 offset:38912
    ds_read_b64_tr_b16 v[30:31], v7 offset:39936
    buffer_load_dwordx4 a[132:135], v8, s[36:39], s70 offen offset:1024 sc1
    s_waitcnt lgkmcnt(8)
    v_mfma_f32_32x32x16_bf16 v[224:239], v[240:243], a[212:215], v[224:239]
    ds_read_b64_tr_b16 v[32:33], v13 offset:38912
    ds_read_b64_tr_b16 v[34:35], v13 offset:39936
    buffer_load_dwordx4 a[136:139], v8, s[36:39], s70 offen offset:2048 sc1
    s_waitcnt lgkmcnt(8)
    v_mfma_f32_32x32x16_bf16 v[144:159], v[244:247], a[212:215], v[144:159]
    buffer_load_dwordx4 a[140:143], v8, s[36:39], s70 offen offset:3072 sc1
    s_waitcnt lgkmcnt(6)
    v_mfma_f32_32x32x16_bf16 v[224:239], v[20:23], a[216:219], v[224:239]
    ds_read_b64_tr_b16 v[40:41], v7 offset:49152
    ds_read_b64_tr_b16 v[42:43], v7 offset:50176
    ds_read_b64_tr_b16 v[44:45], v13 offset:49152
    s_waitcnt lgkmcnt(7)
    v_mfma_f32_32x32x16_bf16 v[144:159], v[24:27], a[216:219], v[144:159]
    ds_read_b64_tr_b16 v[46:47], v13 offset:50176
    ds_read_b64_tr_b16 v[240:241], v7 offset:51200
    ds_read_b64_tr_b16 v[242:243], v7 offset:52224
    s_waitcnt lgkmcnt(8)
    v_mfma_f32_32x32x16_bf16 v[224:239], v[28:31], a[220:223], v[224:239]
    ds_read_b64_tr_b16 v[244:245], v13 offset:51200
    ds_read_b64_tr_b16 v[246:247], v13 offset:52224
    s_waitcnt lgkmcnt(8)
    v_mfma_f32_32x32x16_bf16 v[144:159], v[32:35], a[220:223], v[144:159]
    s_barrier
    s_waitcnt vmcnt(8) lgkmcnt(6)
    v_mfma_f32_32x32x16_bf16 v[224:239], v[40:43], a[224:227], v[224:239]
    ds_read_b64_tr_b16 v[20:21], v7 offset:53248
    ds_read_b64_tr_b16 v[22:23], v7 offset:54272
    ds_read_b64_tr_b16 v[24:25], v13 offset:53248
    s_mov_b32 s70, 0x22000
    buffer_load_dwordx4 a[144:147], v8, s[36:39], s70 offen sc1
    s_waitcnt lgkmcnt(7)
    v_mfma_f32_32x32x16_bf16 v[144:159], v[44:47], a[224:227], v[144:159]
    ds_read_b64_tr_b16 v[26:27], v13 offset:54272
    ds_read_b64_tr_b16 v[28:29], v7 offset:55296
    ds_read_b64_tr_b16 v[30:31], v7 offset:56320
    buffer_load_dwordx4 a[148:151], v8, s[36:39], s70 offen offset:1024 sc1
    s_waitcnt lgkmcnt(8)
    v_mfma_f32_32x32x16_bf16 v[224:239], v[240:243], a[228:231], v[224:239]
    ds_read_b64_tr_b16 v[32:33], v13 offset:55296
    ds_read_b64_tr_b16 v[34:35], v13 offset:56320
    v_add_u32 v7, 0x10000, v7
    v_add_u32 v13, 0x10000, v13
    buffer_load_dwordx4 a[152:155], v8, s[36:39], s70 offen offset:2048 sc1
    s_waitcnt lgkmcnt(8)
    v_mfma_f32_32x32x16_bf16 v[144:159], v[244:247], a[228:231], v[144:159]
    buffer_load_dwordx4 a[156:159], v8, s[36:39], s70 offen offset:3072 sc1
    s_waitcnt lgkmcnt(6)
    v_mfma_f32_32x32x16_bf16 v[224:239], v[20:23], a[232:235], v[224:239]
    ds_read_b64_tr_b16 v[40:41], v7
    ds_read_b64_tr_b16 v[42:43], v7 offset:1024
    ds_read_b64_tr_b16 v[44:45], v13
    v_lshlrev_b32 v164, 16, v216
    v_and_b32 v165, 0xffff0000, v216
    v_lshlrev_b32 v166, 16, v217
    v_and_b32 v167, 0xffff0000, v217
    s_waitcnt lgkmcnt(7)
    v_mfma_f32_32x32x16_bf16 v[144:159], v[24:27], a[232:235], v[144:159]
    ds_read_b64_tr_b16 v[46:47], v13 offset:1024
    ds_read_b64_tr_b16 v[240:241], v7 offset:2048
    ds_read_b64_tr_b16 v[242:243], v7 offset:3072
    v_lshlrev_b32 v168, 16, v218
    v_and_b32 v169, 0xffff0000, v218
    v_lshlrev_b32 v170, 16, v219
    v_and_b32 v171, 0xffff0000, v219
    s_waitcnt lgkmcnt(8)
    v_mfma_f32_32x32x16_bf16 v[224:239], v[28:31], a[236:239], v[224:239]
    ds_read_b64_tr_b16 v[244:245], v13 offset:2048
    ds_read_b64_tr_b16 v[246:247], v13 offset:3072
    v_lshlrev_b32 v172, 16, v220
    v_and_b32 v173, 0xffff0000, v220
    v_lshlrev_b32 v174, 16, v221
    v_and_b32 v175, 0xffff0000, v221
    v_lshlrev_b32 v176, 16, v222
    s_waitcnt lgkmcnt(8)
    v_mfma_f32_32x32x16_bf16 v[144:159], v[32:35], a[236:239], v[144:159]
    v_and_b32 v177, 0xffff0000, v222
    v_lshlrev_b32 v178, 16, v223
    v_and_b32 v179, 0xffff0000, v223
    s_barrier
    s_waitcnt vmcnt(8) lgkmcnt(6)
    v_mfma_f32_32x32x16_bf16 v[224:239], v[40:43], a[240:243], v[224:239]
    ds_read_b64_tr_b16 v[20:21], v7 offset:4096
    ds_read_b64_tr_b16 v[22:23], v7 offset:5120
    ds_read_b64_tr_b16 v[24:25], v13 offset:4096
    s_waitcnt lgkmcnt(7)
    v_mfma_f32_32x32x16_bf16 v[144:159], v[44:47], a[240:243], v[144:159]
    ds_read_b64_tr_b16 v[26:27], v13 offset:5120
    ds_read_b64_tr_b16 v[28:29], v7 offset:6144
    ds_read_b64_tr_b16 v[30:31], v7 offset:7168
    s_waitcnt lgkmcnt(8)
    v_mfma_f32_32x32x16_bf16 v[224:239], v[240:243], a[244:247], v[224:239]
    ds_read_b64_tr_b16 v[32:33], v13 offset:6144
    ds_read_b64_tr_b16 v[34:35], v13 offset:7168
    v_add_u32 v7, 0xfffe0000, v7
    v_add_u32 v13, 0xfffe0000, v13
    s_waitcnt lgkmcnt(8)
    v_mfma_f32_32x32x16_bf16 v[144:159], v[244:247], a[244:247], v[144:159]
    s_waitcnt lgkmcnt(6)
    v_mfma_f32_32x32x16_bf16 v[224:239], v[20:23], a[248:251], v[224:239]
    ds_read_b64_tr_b16 v[40:41], v7
    ds_read_b64_tr_b16 v[42:43], v7 offset:1024
    ds_read_b64_tr_b16 v[44:45], v13
    s_waitcnt lgkmcnt(7)
    v_mfma_f32_32x32x16_bf16 v[144:159], v[24:27], a[248:251], v[144:159]
    ds_read_b64_tr_b16 v[46:47], v13 offset:1024
    ds_read_b64_tr_b16 v[240:241], v7 offset:2048
    ds_read_b64_tr_b16 v[242:243], v7 offset:3072
    s_waitcnt lgkmcnt(8)
    v_mfma_f32_32x32x16_bf16 v[224:239], v[28:31], a[252:255], v[224:239]
    ds_read_b64_tr_b16 v[244:245], v13 offset:2048
    ds_read_b64_tr_b16 v[246:247], v13 offset:3072
    s_waitcnt lgkmcnt(8)
    v_mfma_f32_32x32x16_bf16 v[144:159], v[32:35], a[252:255], v[144:159]
    s_barrier
    s_waitcnt vmcnt(4) lgkmcnt(6)
    v_mfma_f32_32x32x16_bf16 v[224:239], v[40:43], a[128:131], v[224:239]
    ds_read_b64_tr_b16 v[20:21], v7 offset:4096
    ds_read_b64_tr_b16 v[22:23], v7 offset:5120
    ds_read_b64_tr_b16 v[24:25], v13 offset:4096
    s_waitcnt lgkmcnt(7)
    v_mfma_f32_32x32x16_bf16 v[144:159], v[44:47], a[128:131], v[144:159]
    ds_read_b64_tr_b16 v[26:27], v13 offset:5120
    ds_read_b64_tr_b16 v[28:29], v7 offset:6144
    ds_read_b64_tr_b16 v[30:31], v7 offset:7168
    s_waitcnt lgkmcnt(8)
    v_mfma_f32_32x32x16_bf16 v[224:239], v[240:243], a[132:135], v[224:239]
    ds_read_b64_tr_b16 v[32:33], v13 offset:6144
    ds_read_b64_tr_b16 v[34:35], v13 offset:7168
    s_waitcnt lgkmcnt(8)
    v_mfma_f32_32x32x16_bf16 v[144:159], v[244:247], a[132:135], v[144:159]
    s_waitcnt lgkmcnt(6)
    v_mfma_f32_32x32x16_bf16 v[224:239], v[20:23], a[136:139], v[224:239]
    ds_read_b64_tr_b16 v[40:41], v7 offset:16384
    ds_read_b64_tr_b16 v[42:43], v7 offset:17408
    ds_read_b64_tr_b16 v[44:45], v13 offset:16384
    s_waitcnt lgkmcnt(7)
    v_mfma_f32_32x32x16_bf16 v[144:159], v[24:27], a[136:139], v[144:159]
    ds_read_b64_tr_b16 v[46:47], v13 offset:17408
    ds_read_b64_tr_b16 v[240:241], v7 offset:18432
    ds_read_b64_tr_b16 v[242:243], v7 offset:19456
    s_waitcnt lgkmcnt(8)
    v_mfma_f32_32x32x16_bf16 v[224:239], v[28:31], a[140:143], v[224:239]
    ds_read_b64_tr_b16 v[244:245], v13 offset:18432
    ds_read_b64_tr_b16 v[246:247], v13 offset:19456
    s_waitcnt lgkmcnt(8)
    v_mfma_f32_32x32x16_bf16 v[144:159], v[32:35], a[140:143], v[144:159]
    s_waitcnt vmcnt(0) lgkmcnt(6)
    v_mfma_f32_32x32x16_bf16 v[224:239], v[40:43], a[144:147], v[224:239]
    ds_read_b64_tr_b16 v[20:21], v7 offset:20480
    ds_read_b64_tr_b16 v[22:23], v7 offset:21504
    ds_read_b64_tr_b16 v[24:25], v13 offset:20480
    s_waitcnt lgkmcnt(7)
    v_mfma_f32_32x32x16_bf16 v[144:159], v[44:47], a[144:147], v[144:159]
    ds_read_b64_tr_b16 v[26:27], v13 offset:21504
    ds_read_b64_tr_b16 v[28:29], v7 offset:22528
    ds_read_b64_tr_b16 v[30:31], v7 offset:23552
    s_waitcnt lgkmcnt(8)
    v_mfma_f32_32x32x16_bf16 v[224:239], v[240:243], a[148:151], v[224:239]
    ds_read_b64_tr_b16 v[32:33], v13 offset:22528
    ds_read_b64_tr_b16 v[34:35], v13 offset:23552
    s_waitcnt lgkmcnt(8)
    v_mfma_f32_32x32x16_bf16 v[144:159], v[244:247], a[148:151], v[144:159]
    s_waitcnt lgkmcnt(6)
    v_mfma_f32_32x32x16_bf16 v[224:239], v[20:23], a[152:155], v[224:239]
    s_waitcnt lgkmcnt(4)
    v_mfma_f32_32x32x16_bf16 v[144:159], v[24:27], a[152:155], v[144:159]
    s_waitcnt lgkmcnt(2)
    v_mfma_f32_32x32x16_bf16 v[224:239], v[28:31], a[156:159], v[224:239]
    s_waitcnt lgkmcnt(0)
    v_mfma_f32_32x32x16_bf16 v[144:159], v[32:35], a[156:159], v[144:159]
    s_nop 9
    ds_write_b128 v180, v[224:227]
    ds_write_b128 v181, v[228:231]
    ds_write_b128 v182, v[232:235]
    ds_write_b128 v183, v[236:239]
    ds_write_b128 v184, v[144:147]
    ds_write_b128 v185, v[148:151]
    ds_write_b128 v186, v[152:155]
    ds_write_b128 v187, v[156:159]
    s_waitcnt lgkmcnt(0)
    s_barrier
    ds_read_b128 v[40:43], v188 offset:0
    ds_read_b128 v[20:23], v188 offset:16384
    ds_read_b128 v[44:47], v189 offset:0
    ds_read_b128 v[24:27], v189 offset:16384
    ds_read_b128 v[240:243], v188 offset:2048
    ds_read_b128 v[28:31], v188 offset:18432
    ds_read_b128 v[244:247], v189 offset:2048
    ds_read_b128 v[32:35], v189 offset:18432
    s_waitcnt lgkmcnt(4)
    v_pk_add_f32 v[40:41], v[40:41], v[20:21]
    v_pk_add_f32 v[42:43], v[42:43], v[22:23]
    v_pk_add_f32 v[44:45], v[44:45], v[24:25]
    v_pk_add_f32 v[46:47], v[46:47], v[26:27]
    v_pk_add_f32 v[40:41], v[40:41], v[164:165]
    v_pk_add_f32 v[42:43], v[42:43], v[166:167]
    v_pk_add_f32 v[44:45], v[44:45], v[168:169]
    v_pk_add_f32 v[46:47], v[46:47], v[170:171]
    v_cvt_pk_bf16_f32 v216, v40, v41
    v_cvt_pk_bf16_f32 v217, v42, v43
    v_cvt_pk_bf16_f32 v218, v44, v45
    v_cvt_pk_bf16_f32 v219, v46, v47
    buffer_store_dwordx4 v[216:219], v9, s[28:31], 0 offen sc1
    s_waitcnt lgkmcnt(0)
    v_pk_add_f32 v[240:241], v[240:241], v[28:29]
    v_pk_add_f32 v[242:243], v[242:243], v[30:31]
    v_pk_add_f32 v[244:245], v[244:245], v[32:33]
    v_pk_add_f32 v[246:247], v[246:247], v[34:35]
    v_pk_add_f32 v[240:241], v[240:241], v[172:173]
    v_pk_add_f32 v[242:243], v[242:243], v[174:175]
    v_pk_add_f32 v[244:245], v[244:245], v[176:177]
    v_pk_add_f32 v[246:247], v[246:247], v[178:179]
    v_cvt_pk_bf16_f32 v220, v240, v241
    v_cvt_pk_bf16_f32 v221, v242, v243
    v_cvt_pk_bf16_f32 v222, v244, v245
    v_cvt_pk_bf16_f32 v223, v246, v247
    buffer_store_dwordx4 v[220:223], v10, s[28:31], 0 offen sc1
    s_endpgm
L_roleA:
    s_sub_u32 s91, s64, 8
    s_lshl_b32 s67, s62, 5
    s_add_u32 s68, s65, s67
    v_lshrrev_b32 v3, 3, v1
    v_add_u32 v3, s68, v3
    v_lshrrev_b32 v4, 4, v1
    v_xor_b32 v4, v4, v1
    v_and_b32 v4, 7, v4
    v_lshlrev_b32 v4, 4, v4
    v_add_u32 v5, 0, v3
    v_lshl_add_u32 v6, v5, 10, v4
    v_add_u32 v5, 8, v3
    v_lshl_add_u32 v7, v5, 10, v4
    v_xor_b32 v7, 64, v7
    v_subrev_u32 v7, 1024, v7
    v_add_u32 v5, 16, v3
    v_lshl_add_u32 v8, v5, 10, v4
    v_subrev_u32 v8, 2048, v8
    v_add_u32 v5, 24, v3
    v_lshl_add_u32 v9, v5, 10, v4
    v_xor_b32 v9, 64, v9
    v_subrev_u32 v9, 3072, v9
    v_lshrrev_b32 v3, 3, v1
    s_lshl_b32 s67, s62, 4
    v_add_u32 v3, s67, v3
    v_mul_u32_u24 v3, 0xc00, v3
    v_bfe_u32 v4, v1, 4, 1
    v_lshlrev_b32 v4, 2, v4
    v_xor_b32 v4, v4, v1
    v_and_b32 v4, 7, v4
    v_lshlrev_b32 v4, 4, v4
    s_lshl_b32 s67, s91, 7
    v_add3_u32 v10, v3, v4, s67
    v_add_u32 v11, 24576, v10
    s_lshl_b32 s72, s62, 12
    s_mul_i32 s73, s62, 6144
    s_add_u32 s73, s73, 16384
    s_and_b32 s67, s63, 1
    s_lshl_b32 s67, s67, 3
    s_and_b32 s68, s64, 7
    s_add_u32 s67, s67, s68
    s_lshl_b32 s68, s62, 4
    s_add_u32 s67, s67, s68
    s_mov_b32 s44, s67
    s_lshl_b32 s67, s67, 3
    s_lshr_b32 s68, s63, 1
    s_add_u32 s67, s67, s68
    s_lshl_b32 s67, s67, 13
    v_lshl_add_u32 v12, v1, 7, s67
    s_lshl_b32 s67, s2, 2
    s_add_u32 s67, s67, s62
    s_cmp_eq_u32 s67, 0x20
    s_waitcnt lgkmcnt(0)
    s_load_dwordx2 s[12:13], s[0:1], 40
    s_load_dwordx2 s[32:33], s[0:1], 72
    s_load_dwordx2 s[16:17], s[0:1], 48
    s_load_dwordx2 s[20:21], s[0:1], 56
    s_load_dwordx2 s[24:25], s[0:1], 16
    s_load_dwordx2 s[28:29], s[0:1], 64
    s_cbranch_scc1 L_pick
L_pick_back:
    v_subrev_u32 v13, 0x180000, v12
    buffer_load_dword v14, v13, s[40:43], 0 offen
    v_subrev_u32 v13, 0x200000, v12
    buffer_load_dword v14, v13, s[4:7], 0 offen
    s_add_u32 m0, s72, 0
    s_mov_b32 s70, 0x0
    buffer_load_dwordx4 v6, s[4:7], s70 offen lds
    buffer_load_dwordx4 v7, s[4:7], s70 offen offset:1024 lds
    buffer_load_dwordx4 v8, s[4:7], s70 offen offset:2048 lds
    buffer_load_dwordx4 v9, s[4:7], s70 offen offset:3072 lds
    s_add_u32 m0, s73, 0
    s_mov_b32 s71, 0x0
    buffer_load_dwordx4 v10, s[8:11], s71 offen lds
    buffer_load_dwordx4 v10, s[8:11], s71 offen offset:1024 lds
    buffer_load_dwordx4 v10, s[8:11], s71 offen offset:2048 lds
    s_add_u32 m0, s73, 3072
    s_mov_b32 s71, 0x0
    buffer_load_dwordx4 v11, s[8:11], s71 offen lds
    buffer_load_dwordx4 v11, s[8:11], s71 offen offset:1024 lds
    buffer_load_dwordx4 v11, s[8:11], s71 offen offset:2048 lds
    s_waitcnt lgkmcnt(0)
    v_subrev_u32 v13, 0x0, v12
    buffer_load_dword v14, v13, s[8:11], 0 offen
    s_and_b32 s67, s44, 7
    s_mul_i32 s67, s67, 196608
    s_lshr_b32 s68, s44, 3
    s_lshl_b32 s69, s68, 10
    s_add_u32 s67, s67, s69
    s_add_u32 s67, s67, 384
    s_cmp_lt_u32 s68, 3
    s_cselect_b32 s67, s67, 0x80000000
    v_mul_u32_u24 v13, 0xc00, v1
    v_add_u32 v13, s67, v13
    buffer_load_dword v14, v13, s[8:11], 0 offen
    s_sub_u32 s67, s44, 44
    s_lshl_b32 s67, s67, 16
    s_add_u32 s67, s67, 384
    v_lshl_add_u32 v13, v1, 10, s67
    buffer_load_dword v14, v13, s[40:43], 0 offen
    s_lshl_b32 s67, s63, 8
    s_add_u32 s67, s67, 0xf40000
    v_lshl_add_u32 v22, v1, 2, s67
    s_lshl_b32 s68, s64, 2
    s_add_u32 s68, s68, s62
    s_lshl_b32 s68, s68, 2
    s_add_u32 s67, s67, s68
    v_mov_b32 v29, 0x80000000
    s_add_u32 m0, s72, 40960
    s_mov_b32 s70, 0x80
    buffer_load_dwordx4 v6, s[4:7], s70 offen lds
    v_mov_b32 v21, s67
    v_cmp_eq_u32 vcc, 0, v1
    v_mov_b32 v30, 0
    s_mov_b32 s1, 0
    v_cndmask_b32 v21, v29, v21, vcc
    s_getreg_b32 s101, hwreg(HW_REG_XCC_ID, 0, 4)
    s_lshl_b32 s101, s101, 3
    v_add_u32 v32, 0x1000, v21
    buffer_load_dwordx4 v7, s[4:7], s70 offen offset:1024 lds
    s_mov_b32 s74, 0x3f800008
    s_mov_b32 s75, 0x358637bd
    s_mov_b32 s76, 0x3fb8aa3b
    s_mov_b32 s77, 0xbfb8aa47
    s_mov_b32 s80, 0x22222222
    s_mov_b32 s81, 0x22222222
    s_mov_b32 s82, 0x44444444
    s_mov_b32 s83, 0x44444444
    buffer_load_dwordx4 v8, s[4:7], s70 offen offset:2048 lds
    s_mov_b32 s84, 0x88888888
    s_mov_b32 s85, 0x88888888
    s_mov_b32 s86, 0
    s_mov_b32 s87, -1
    s_lshr_b32 s92, s64, 3
    s_and_b32 s93, s64, 7
    s_lshr_b32 s68, s62, 1
    s_lshl_b32 s67, s68, 13
    buffer_load_dwordx4 v9, s[4:7], s70 offen offset:3072 lds
    v_and_b32 v3, 31, v1
    v_lshl_add_u32 v3, v3, 7, s67
    v_bfe_u32 v4, v1, 1, 3
    v_lshrrev_b32 v5, 5, v1
    v_xor_b32 v4, v4, v5
    s_xor_b32 s67, s68, 0
    s_lshl_b32 s67, s67, 1
    v_xor_b32 v5, s67, v4
    s_add_u32 m0, s73, 40960
    s_mov_b32 s71, 0x30000
    buffer_load_dwordx4 v10, s[8:11], s71 offen lds
    v_lshl_add_u32 v15, v5, 4, v3
    s_xor_b32 s67, s68, 1
    s_lshl_b32 s67, s67, 1
    v_xor_b32 v5, s67, v4
    v_lshl_add_u32 v16, v5, 4, v3
    s_xor_b32 s67, s68, 2
    s_lshl_b32 s67, s67, 1
    v_xor_b32 v5, s67, v4
    buffer_load_dwordx4 v10, s[8:11], s71 offen offset:1024 lds
    v_lshl_add_u32 v17, v5, 4, v3
    s_xor_b32 s67, s68, 3
    s_lshl_b32 s67, s67, 1
    v_xor_b32 v5, s67, v4
    v_lshl_add_u32 v18, v5, 4, v3
    v_bfe_u32 v3, v1, 2, 2
    v_lshrrev_b32 v4, 5, v1
    v_mul_u32_u24 v4, 24, v4
    buffer_load_dwordx4 v10, s[8:11], s71 offen offset:2048 lds
    v_add_u32 v3, v3, v4
    v_mul_u32_u24 v3, 128, v3
    v_bfe_u32 v4, v1, 4, 1
    v_lshl_add_u32 v3, v4, 5, v3
    v_and_b32 v4, 3, v1
    v_lshl_add_u32 v3, v4, 3, v3
    v_bfe_u32 v4, v1, 3, 1
    s_and_b32 s67, s62, 1
    s_add_u32 m0, s73, 44032
    s_mov_b32 s71, 0x30000
    buffer_load_dwordx4 v11, s[8:11], s71 offen lds
    v_xor_b32 v4, s67, v4
    v_lshl_add_u32 v3, v4, 6, v3
    s_mul_i32 s67, s68, 6144
    s_add_u32 s69, s67, 16384
    v_add_u32 v19, s69, v3
    s_sub_u32 s69, 22528, s67
    v_add_u32 v20, s69, v3
    v_lshrrev_b32 v3, 2, v1
    buffer_load_dwordx4 v11, s[8:11], s71 offen offset:1024 lds
    v_lshrrev_b32 v4, 4, v1
    v_xor_b32 v3, v3, v4
    v_and_b32 v3, 1, v3
    v_cmp_eq_u32 vcc, 0, v3
    v_mov_b32 v4, 0x3f803f80
    s_nop 0
    v_cndmask_b32 v24, 0, v4, vcc
    v_mov_b32 v25, v24
    v_mov_b32 v26, v24
    buffer_load_dwordx4 v11, s[8:11], s71 offen offset:2048 lds
    v_mov_b32 v27, v24
    s_getpc_b64 s[68:69]
L_pc_24:
    s_sub_u32 s68, s68, L_pc_24-parallel_sum__linear_attn_block__mixer_s_mlp__prompt_kernel
    s_subb_u32 s69, s69, 0
    s_and_b32 s67, s63, 1
    s_lshl_b32 s67, s67, 3
    s_add_u32 s67, s67, s91
    s_lshl_b32 s67, s67, 2
    s_add_u32 s67, s67, s62
    s_lshl_b32 s67, s67, 10
    s_min_u32 s67, s67, L_code_end-parallel_sum__linear_attn_block__mixer_s_mlp__prompt_kernel-1024
    v_add_u32 v40, s67, v2
    global_load_dwordx4 v[36:39], v40, s[68:69]
    s_waitcnt vmcnt(14)
    s_barrier
    ds_read_b128 v[140:143], v15
    ds_read_b64_tr_b16 v[148:149], v19
    ds_read_b64_tr_b16 v[150:151], v19 offset:512
    ds_read_b128 v[144:147], v15 offset:4096
    ds_read_b64_tr_b16 v[152:153], v19 offset:1024
    ds_read_b64_tr_b16 v[154:155], v19 offset:1536
    ds_read_b64_tr_b16 v[156:157], v19 offset:2048
    ds_read_b64_tr_b16 v[158:159], v19 offset:2560
    s_waitcnt lgkmcnt(5)
    v_mfma_f32_32x32x16_bf16 v[44:59], v[148:151], v[140:143], 0
    ds_read_b128 v[160:163], v16
    ds_read_b64_tr_b16 v[168:169], v20
    s_waitcnt lgkmcnt(6)
    v_mfma_f32_32x32x16_bf16 v[60:75], v[148:151], v[144:147], 0
    ds_read_b64_tr_b16 v[170:171], v20 offset:512
    ds_read_b128 v[164:167], v16 offset:4096
    s_add_u32 m0, s72, 81920
    s_mov_b32 s70, 0x100
    buffer_load_dwordx4 v6, s[4:7], s70 offen lds
    v_mfma_f32_16x16x32_bf16 v[180:183], v[24:27], v[148:151], 0
    s_waitcnt lgkmcnt(6)
    v_mfma_f32_32x32x16_bf16 v[76:91], v[140:143], v[152:155], 0
    ds_read_b64_tr_b16 v[172:173], v20 offset:1024
    ds_read_b64_tr_b16 v[174:175], v20 offset:1536
    v_mfma_f32_32x32x16_bf16 v[92:107], v[144:147], v[152:155], 0
    ds_read_b64_tr_b16 v[176:177], v20 offset:2048
    ds_read_b64_tr_b16 v[178:179], v20 offset:2560
    buffer_load_dwordx4 v7, s[4:7], s70 offen offset:1024 lds
    v_mfma_f32_16x16x32_bf16 v[184:187], v[24:27], v[152:155], 0
    s_waitcnt lgkmcnt(8)
    v_mfma_f32_32x32x16_bf16 v[108:123], v[140:143], v[156:159], 0
    v_mfma_f32_32x32x16_bf16 v[124:139], v[144:147], v[156:159], 0
    buffer_load_dwordx4 v8, s[4:7], s70 offen offset:2048 lds
    v_mfma_f32_16x16x32_bf16 v[188:191], v[24:27], v[156:159], 0
    s_waitcnt lgkmcnt(5)
    v_mfma_f32_32x32x16_bf16 v[44:59], v[168:171], v[160:163], v[44:59]
    ds_read_b128 v[140:143], v17
    ds_read_b64_tr_b16 v[148:149], v19 offset:12288
    s_waitcnt lgkmcnt(6)
    v_mfma_f32_32x32x16_bf16 v[60:75], v[168:171], v[164:167], v[60:75]
    ds_read_b64_tr_b16 v[150:151], v19 offset:12800
    ds_read_b128 v[144:147], v17 offset:4096
    buffer_load_dwordx4 v9, s[4:7], s70 offen offset:3072 lds
    s_waitcnt lgkmcnt(6)
    v_mfma_f32_32x32x16_bf16 v[76:91], v[160:163], v[172:175], v[76:91]
    ds_read_b64_tr_b16 v[152:153], v19 offset:13312
    ds_read_b64_tr_b16 v[154:155], v19 offset:13824
    v_mfma_f32_32x32x16_bf16 v[92:107], v[164:167], v[172:175], v[92:107]
    ds_read_b64_tr_b16 v[156:157], v19 offset:14336
    ds_read_b64_tr_b16 v[158:159], v19 offset:14848
    s_add_u32 m0, s73, 81920
    s_mov_b32 s71, 0x60000
    buffer_load_dwordx4 v10, s[8:11], s71 offen lds
    s_waitcnt lgkmcnt(8)
    v_mfma_f32_32x32x16_bf16 v[108:123], v[160:163], v[176:179], v[108:123]
    v_mfma_f32_32x32x16_bf16 v[124:139], v[164:167], v[176:179], v[124:139]
    buffer_load_dwordx4 v10, s[8:11], s71 offen offset:1024 lds
    s_waitcnt lgkmcnt(5)
    v_mfma_f32_32x32x16_bf16 v[44:59], v[148:151], v[140:143], v[44:59]
    ds_read_b128 v[160:163], v18
    ds_read_b64_tr_b16 v[168:169], v20 offset:12288
    s_waitcnt lgkmcnt(6)
    v_mfma_f32_32x32x16_bf16 v[60:75], v[148:151], v[144:147], v[60:75]
    ds_read_b64_tr_b16 v[170:171], v20 offset:12800
    ds_read_b128 v[164:167], v18 offset:4096
    buffer_load_dwordx4 v10, s[8:11], s71 offen offset:2048 lds
    v_mfma_f32_16x16x32_bf16 v[180:183], v[24:27], v[148:151], v[180:183]
    s_waitcnt lgkmcnt(6)
    v_mfma_f32_32x32x16_bf16 v[76:91], v[140:143], v[152:155], v[76:91]
    ds_read_b64_tr_b16 v[172:173], v20 offset:13312
    ds_read_b64_tr_b16 v[174:175], v20 offset:13824
    v_mfma_f32_32x32x16_bf16 v[92:107], v[144:147], v[152:155], v[92:107]
    ds_read_b64_tr_b16 v[176:177], v20 offset:14336
    ds_read_b64_tr_b16 v[178:179], v20 offset:14848
    s_add_u32 m0, s73, 84992
    s_mov_b32 s71, 0x60000
    buffer_load_dwordx4 v11, s[8:11], s71 offen lds
    v_mfma_f32_16x16x32_bf16 v[184:187], v[24:27], v[152:155], v[184:187]
    s_waitcnt lgkmcnt(8)
    v_mfma_f32_32x32x16_bf16 v[108:123], v[140:143], v[156:159], v[108:123]
    v_add_u32 v15, 0xa000, v15
    v_add_u32 v16, 0xa000, v16
    v_add_u32 v17, 0xa000, v17
    v_add_u32 v18, 0xa000, v18
    v_add_u32 v19, 0xa000, v19
    v_add_u32 v20, 0xa000, v20
    v_mfma_f32_32x32x16_bf16 v[124:139], v[144:147], v[156:159], v[124:139]
    buffer_load_dwordx4 v11, s[8:11], s71 offen offset:1024 lds
    v_mfma_f32_16x16x32_bf16 v[188:191], v[24:27], v[156:159], v[188:191]
    s_waitcnt vmcnt(10) lgkmcnt(0)
    s_barrier
    v_mfma_f32_32x32x16_bf16 v[44:59], v[168:171], v[160:163], v[44:59]
    ds_read_b128 v[140:143], v15
    ds_read_b64_tr_b16 v[148:149], v19
    v_mfma_f32_32x32x16_bf16 v[60:75], v[168:171], v[164:167], v[60:75]
    ds_read_b64_tr_b16 v[150:151], v19 offset:512
    ds_read_b128 v[144:147], v15 offset:4096
    buffer_load_dwordx4 v11, s[8:11], s71 offen offset:2048 lds
    v_mfma_f32_32x32x16_bf16 v[76:91], v[160:163], v[172:175], v[76:91]
    ds_read_b64_tr_b16 v[152:153], v19 offset:1024
    ds_read_b64_tr_b16 v[154:155], v19 offset:1536
    v_mfma_f32_32x32x16_bf16 v[92:107], v[164:167], v[172:175], v[92:107]
    ds_read_b64_tr_b16 v[156:157], v19 offset:2048
    ds_read_b64_tr_b16 v[158:159], v19 offset:2560
    s_add_u32 m0, s72, 122880
    s_mov_b32 s70, 0x180
    buffer_load_dwordx4 v6, s[4:7], s70 offen lds
    v_mfma_f32_32x32x16_bf16 v[108:123], v[160:163], v[176:179], v[108:123]
    v_mfma_f32_32x32x16_bf16 v[124:139], v[164:167], v[176:179], v[124:139]
    buffer_load_dwordx4 v7, s[4:7], s70 offen offset:1024 lds
    s_waitcnt lgkmcnt(5)
    v_mfma_f32_32x32x16_bf16 v[44:59], v[148:151], v[140:143], v[44:59]
    ds_read_b128 v[160:163], v16
    ds_read_b64_tr_b16 v[168:169], v20
    s_waitcnt lgkmcnt(6)
    v_mfma_f32_32x32x16_bf16 v[60:75], v[148:151], v[144:147], v[60:75]
    ds_read_b64_tr_b16 v[170:171], v20 offset:512
    ds_read_b128 v[164:167], v16 offset:4096
    buffer_load_dwordx4 v8, s[4:7], s70 offen offset:2048 lds
    v_mfma_f32_16x16x32_bf16 v[180:183], v[24:27], v[148:151], v[180:183]
    s_waitcnt lgkmcnt(6)
    v_mfma_f32_32x32x16_bf16 v[76:91], v[140:143], v[152:155], v[76:91]
    ds_read_b64_tr_b16 v[172:173], v20 offset:1024
    ds_read_b64_tr_b16 v[174:175], v20 offset:1536
    v_mfma_f32_32x32x16_bf16 v[92:107], v[144:147], v[152:155], v[92:107]
    ds_read_b64_tr_b16 v[176:177], v20 offset:2048
    ds_read_b64_tr_b16 v[178:179], v20 offset:2560
    buffer_load_dwordx4 v9, s[4:7], s70 offen offset:3072 lds
    v_mfma_f32_16x16x32_bf16 v[184:187], v[24:27], v[152:155], v[184:187]
    s_waitcnt lgkmcnt(8)
    v_mfma_f32_32x32x16_bf16 v[108:123], v[140:143], v[156:159], v[108:123]
    v_mfma_f32_32x32x16_bf16 v[124:139], v[144:147], v[156:159], v[124:139]
    s_add_u32 m0, s73, 122880
    s_mov_b32 s71, 0x90000
    buffer_load_dwordx4 v10, s[8:11], s71 offen lds
    v_mfma_f32_16x16x32_bf16 v[188:191], v[24:27], v[156:159], v[188:191]
    s_waitcnt lgkmcnt(5)
    v_mfma_f32_32x32x16_bf16 v[44:59], v[168:171], v[160:163], v[44:59]
    ds_read_b128 v[140:143], v17
    ds_read_b64_tr_b16 v[148:149], v19 offset:12288
    s_waitcnt lgkmcnt(6)
    v_mfma_f32_32x32x16_bf16 v[60:75], v[168:171], v[164:167], v[60:75]
    ds_read_b64_tr_b16 v[150:151], v19 offset:12800
    ds_read_b128 v[144:147], v17 offset:4096
    buffer_load_dwordx4 v10, s[8:11], s71 offen offset:1024 lds
    s_waitcnt lgkmcnt(6)
    v_mfma_f32_32x32x16_bf16 v[76:91], v[160:163], v[172:175], v[76:91]
    ds_read_b64_tr_b16 v[152:153], v19 offset:13312
    ds_read_b64_tr_b16 v[154:155], v19 offset:13824
    v_mfma_f32_32x32x16_bf16 v[92:107], v[164:167], v[172:175], v[92:107]
    ds_read_b64_tr_b16 v[156:157], v19 offset:14336
    ds_read_b64_tr_b16 v[158:159], v19 offset:14848
    buffer_load_dwordx4 v10, s[8:11], s71 offen offset:2048 lds
    s_waitcnt lgkmcnt(8)
    v_mfma_f32_32x32x16_bf16 v[108:123], v[160:163], v[176:179], v[108:123]
    v_mfma_f32_32x32x16_bf16 v[124:139], v[164:167], v[176:179], v[124:139]
    s_add_u32 m0, s73, 125952
    s_mov_b32 s71, 0x90000
    buffer_load_dwordx4 v11, s[8:11], s71 offen lds
    s_waitcnt lgkmcnt(5)
    v_mfma_f32_32x32x16_bf16 v[44:59], v[148:151], v[140:143], v[44:59]
    ds_read_b128 v[160:163], v18
    ds_read_b64_tr_b16 v[168:169], v20 offset:12288
    s_waitcnt lgkmcnt(6)
    v_mfma_f32_32x32x16_bf16 v[60:75], v[148:151], v[144:147], v[60:75]
    ds_read_b64_tr_b16 v[170:171], v20 offset:12800
    ds_read_b128 v[164:167], v18 offset:4096
    buffer_load_dwordx4 v11, s[8:11], s71 offen offset:1024 lds
    v_mfma_f32_16x16x32_bf16 v[180:183], v[24:27], v[148:151], v[180:183]
    s_waitcnt lgkmcnt(6)
    v_mfma_f32_32x32x16_bf16 v[76:91], v[140:143], v[152:155], v[76:91]
    ds_read_b64_tr_b16 v[172:173], v20 offset:13312
    ds_read_b64_tr_b16 v[174:175], v20 offset:13824
    v_mfma_f32_32x32x16_bf16 v[92:107], v[144:147], v[152:155], v[92:107]
    ds_read_b64_tr_b16 v[176:177], v20 offset:14336
    ds_read_b64_tr_b16 v[178:179], v20 offset:14848
    buffer_load_dwordx4 v11, s[8:11], s71 offen offset:2048 lds
    v_mfma_f32_16x16x32_bf16 v[184:187], v[24:27], v[152:155], v[184:187]
    s_waitcnt lgkmcnt(8)
    v_mfma_f32_32x32x16_bf16 v[108:123], v[140:143], v[156:159], v[108:123]
    v_add_u32 v15, 0xa000, v15
    v_add_u32 v16, 0xa000, v16
    v_add_u32 v17, 0xa000, v17
    v_add_u32 v18, 0xa000, v18
    v_add_u32 v19, 0xa000, v19
    v_add_u32 v20, 0xa000, v20
    v_mfma_f32_32x32x16_bf16 v[124:139], v[144:147], v[156:159], v[124:139]
    v_subrev_u32 v13, 0x0, v12
    buffer_load_dword v14, v13, s[12:15], 0 offen
    v_mfma_f32_16x16x32_bf16 v[188:191], v[24:27], v[156:159], v[188:191]
    s_waitcnt vmcnt(11) lgkmcnt(0)
    s_barrier
    v_mfma_f32_32x32x16_bf16 v[44:59], v[168:171], v[160:163], v[44:59]
    ds_read_b128 v[140:143], v15
    ds_read_b64_tr_b16 v[148:149], v19
    v_mfma_f32_32x32x16_bf16 v[60:75], v[168:171], v[164:167], v[60:75]
    ds_read_b64_tr_b16 v[150:151], v19 offset:512
    ds_read_b128 v[144:147], v15 offset:4096
    s_add_u32 m0, s72, 0
    s_mov_b32 s70, 0x200
    buffer_load_dwordx4 v6, s[4:7], s70 offen lds
    v_mfma_f32_32x32x16_bf16 v[76:91], v[160:163], v[172:175], v[76:91]
    ds_read_b64_tr_b16 v[152:153], v19 offset:1024
    ds_read_b64_tr_b16 v[154:155], v19 offset:1536
    v_mfma_f32_32x32x16_bf16 v[92:107], v[164:167], v[172:175], v[92:107]
    ds_read_b64_tr_b16 v[156:157], v19 offset:2048
    ds_read_b64_tr_b16 v[158:159], v19 offset:2560
    buffer_load_dwordx4 v7, s[4:7], s70 offen offset:1024 lds
    v_mfma_f32_32x32x16_bf16 v[108:123], v[160:163], v[176:179], v[108:123]
    v_mfma_f32_32x32x16_bf16 v[124:139], v[164:167], v[176:179], v[124:139]
    buffer_load_dwordx4 v8, s[4:7], s70 offen offset:2048 lds
    s_waitcnt lgkmcnt(5)
    v_mfma_f32_32x32x16_bf16 v[44:59], v[148:151], v[140:143], v[44:59]
    ds_read_b128 v[160:163], v16
    ds_read_b64_tr_b16 v[168:169], v20
    s_waitcnt lgkmcnt(6)
    v_mfma_f32_32x32x16_bf16 v[60:75], v[148:151], v[144:147], v[60:75]
    ds_read_b64_tr_b16 v[170:171], v20 offset:512
    ds_read_b128 v[164:167], v16 offset:4096
    buffer_load_dwordx4 v9, s[4:7], s70 offen offset:3072 lds
    v_mfma_f32_16x16x32_bf16 v[180:183], v[24:27], v[148:151], v[180:183]
    s_waitcnt lgkmcnt(6)
    v_mfma_f32_32x32x16_bf16 v[76:91], v[140:143], v[152:155], v[76:91]
    ds_read_b64_tr_b16 v[172:173], v20 offset:1024
    ds_read_b64_tr_b16 v[174:175], v20 offset:1536
    v_mfma_f32_32x32x16_bf16 v[92:107], v[144:147], v[152:155], v[92:107]
    ds_read_b64_tr_b16 v[176:177], v20 offset:2048
    ds_read_b64_tr_b16 v[178:179], v20 offset:2560
    s_add_u32 m0, s73, 0
    s_mov_b32 s71, 0xc0000
    buffer_load_dwordx4 v10, s[8:11], s71 offen lds
    v_mfma_f32_16x16x32_bf16 v[184:187], v[24:27], v[152:155], v[184:187]
    s_waitcnt lgkmcnt(8)
    v_mfma_f32_32x32x16_bf16 v[108:123], v[140:143], v[156:159], v[108:123]
    v_mfma_f32_32x32x16_bf16 v[124:139], v[144:147], v[156:159], v[124:139]
    buffer_load_dwordx4 v10, s[8:11], s71 offen offset:1024 lds
    v_mfma_f32_16x16x32_bf16 v[188:191], v[24:27], v[156:159], v[188:191]
    s_waitcnt lgkmcnt(5)
    v_mfma_f32_32x32x16_bf16 v[44:59], v[168:171], v[160:163], v[44:59]
    ds_read_b128 v[140:143], v17
    ds_read_b64_tr_b16 v[148:149], v19 offset:12288
    s_waitcnt lgkmcnt(6)
    v_mfma_f32_32x32x16_bf16 v[60:75], v[168:171], v[164:167], v[60:75]
    ds_read_b64_tr_b16 v[150:151], v19 offset:12800
    ds_read_b128 v[144:147], v17 offset:4096
    buffer_load_dwordx4 v10, s[8:11], s71 offen offset:2048 lds
    s_waitcnt lgkmcnt(6)
    v_mfma_f32_32x32x16_bf16 v[76:91], v[160:163], v[172:175], v[76:91]
    ds_read_b64_tr_b16 v[152:153], v19 offset:13312
    ds_read_b64_tr_b16 v[154:155], v19 offset:13824
    v_mfma_f32_32x32x16_bf16 v[92:107], v[164:167], v[172:175], v[92:107]
    ds_read_b64_tr_b16 v[156:157], v19 offset:14336
    ds_read_b64_tr_b16 v[158:159], v19 offset:14848
    s_add_u32 m0, s73, 3072
    s_mov_b32 s71, 0xc0000
    buffer_load_dwordx4 v11, s[8:11], s71 offen lds
    s_waitcnt lgkmcnt(8)
    v_mfma_f32_32x32x16_bf16 v[108:123], v[160:163], v[176:179], v[108:123]
    v_mfma_f32_32x32x16_bf16 v[124:139], v[164:167], v[176:179], v[124:139]
    buffer_load_dwordx4 v11, s[8:11], s71 offen offset:1024 lds
    s_waitcnt lgkmcnt(5)
    v_mfma_f32_32x32x16_bf16 v[44:59], v[148:151], v[140:143], v[44:59]
    ds_read_b128 v[160:163], v18
    ds_read_b64_tr_b16 v[168:169], v20 offset:12288
    s_waitcnt lgkmcnt(6)
    v_mfma_f32_32x32x16_bf16 v[60:75], v[148:151], v[144:147], v[60:75]
    ds_read_b64_tr_b16 v[170:171], v20 offset:12800
    ds_read_b128 v[164:167], v18 offset:4096
    buffer_load_dwordx4 v11, s[8:11], s71 offen offset:2048 lds
    v_mfma_f32_16x16x32_bf16 v[180:183], v[24:27], v[148:151], v[180:183]
    s_waitcnt lgkmcnt(6)
    v_mfma_f32_32x32x16_bf16 v[76:91], v[140:143], v[152:155], v[76:91]
    ds_read_b64_tr_b16 v[172:173], v20 offset:13312
    ds_read_b64_tr_b16 v[174:175], v20 offset:13824
    v_mfma_f32_32x32x16_bf16 v[92:107], v[144:147], v[152:155], v[92:107]
    ds_read_b64_tr_b16 v[176:177], v20 offset:14336
    ds_read_b64_tr_b16 v[178:179], v20 offset:14848
    s_add_u32 m0, s72, 40960
    s_mov_b32 s70, 0x280
    buffer_load_dwordx4 v6, s[4:7], s70 offen lds
    v_mfma_f32_16x16x32_bf16 v[184:187], v[24:27], v[152:155], v[184:187]
    s_waitcnt lgkmcnt(8)
    v_mfma_f32_32x32x16_bf16 v[108:123], v[140:143], v[156:159], v[108:123]
    v_add_u32 v15, 0xa000, v15
    v_add_u32 v16, 0xa000, v16
    v_add_u32 v17, 0xa000, v17
    v_add_u32 v18, 0xa000, v18
    v_add_u32 v19, 0xa000, v19
    v_add_u32 v20, 0xa000, v20
    v_mfma_f32_32x32x16_bf16 v[124:139], v[144:147], v[156:159], v[124:139]
    buffer_load_dwordx4 v7, s[4:7], s70 offen offset:1024 lds
    v_mfma_f32_16x16x32_bf16 v[188:191], v[24:27], v[156:159], v[188:191]
    s_waitcnt vmcnt(13) lgkmcnt(0)
    s_barrier
    v_mfma_f32_32x32x16_bf16 v[44:59], v[168:171], v[160:163], v[44:59]
    ds_read_b128 v[140:143], v15
    ds_read_b64_tr_b16 v[148:149], v19
    v_mfma_f32_32x32x16_bf16 v[60:75], v[168:171], v[164:167], v[60:75]
    ds_read_b64_tr_b16 v[150:151], v19 offset:512
    ds_read_b128 v[144:147], v15 offset:4096
    buffer_load_dwordx4 v8, s[4:7], s70 offen offset:2048 lds
    v_mfma_f32_32x32x16_bf16 v[76:91], v[160:163], v[172:175], v[76:91]
    ds_read_b64_tr_b16 v[152:153], v19 offset:1024
    ds_read_b64_tr_b16 v[154:155], v19 offset:1536
    v_mfma_f32_32x32x16_bf16 v[92:107], v[164:167], v[172:175], v[92:107]
    ds_read_b64_tr_b16 v[156:157], v19 offset:2048
    ds_read_b64_tr_b16 v[158:159], v19 offset:2560
    buffer_load_dwordx4 v9, s[4:7], s70 offen offset:3072 lds
    v_mfma_f32_32x32x16_bf16 v[108:123], v[160:163], v[176:179], v[108:123]
    v_mfma_f32_32x32x16_bf16 v[124:139], v[164:167], v[176:179], v[124:139]
    s_add_u32 m0, s73, 40960
    s_mov_b32 s71, 0xf0000
    buffer_load_dwordx4 v10, s[8:11], s71 offen lds
    s_waitcnt lgkmcnt(5)
    v_mfma_f32_32x32x16_bf16 v[44:59], v[148:151], v[140:143], v[44:59]
    ds_read_b128 v[160:163], v16
    ds_read_b64_tr_b16 v[168:169], v20
    s_mul_i32 s69, s91, 192
    s_add_u32 s69, s69, 2048
    s_and_b32 s69, s69, 0xffffff80
    s_waitcnt lgkmcnt(6)
    v_mfma_f32_32x32x16_bf16 v[60:75], v[148:151], v[144:147], v[60:75]
    ds_read_b64_tr_b16 v[170:171], v20 offset:512
    ds_read_b128 v[164:167], v16 offset:4096
    buffer_load_dwordx4 v10, s[8:11], s71 offen offset:1024 lds
    v_lshrrev_b32 v3, 4, v1
    v_lshlrev_b32 v4, 2, v3
    v_mfma_f32_16x16x32_bf16 v[180:183], v[24:27], v[148:151], v[180:183]
    s_waitcnt lgkmcnt(6)
    v_mfma_f32_32x32x16_bf16 v[76:91], v[140:143], v[152:155], v[76:91]
    ds_read_b64_tr_b16 v[172:173], v20 offset:1024
    ds_read_b64_tr_b16 v[174:175], v20 offset:1536
    v_xor_b32 v4, v4, v1
    v_and_b32 v4, 15, v4
    v_lshlrev_b32 v4, 4, v4
    v_mfma_f32_32x32x16_bf16 v[92:107], v[144:147], v[152:155], v[92:107]
    ds_read_b64_tr_b16 v[176:177], v20 offset:2048
    ds_read_b64_tr_b16 v[178:179], v20 offset:2560
    buffer_load_dwordx4 v10, s[8:11], s71 offen offset:2048 lds
    s_lshl_b32 s67, s62, 4
    v_add_u32 v3, s67, v3
    v_mfma_f32_16x16x32_bf16 v[184:187], v[24:27], v[152:155], v[184:187]
    s_waitcnt lgkmcnt(8)
    v_mfma_f32_32x32x16_bf16 v[108:123], v[140:143], v[156:159], v[108:123]
    v_mul_u32_u24 v3, 3584, v3
    v_add3_u32 v42, v3, v4, s69
    v_add_u32 v43, 13312, v42
    v_add_u32 v33, 26624, v42
    v_add_u32 v34, 39936, v42
    v_mfma_f32_32x32x16_bf16 v[124:139], v[144:147], v[156:159], v[124:139]
    s_add_u32 m0, s73, 44032
    s_mov_b32 s71, 0xf0000
    buffer_load_dwordx4 v11, s[8:11], s71 offen lds
    s_lshl_b32 s3, s62, 12
    v_lshrrev_b32 v3, 3, v1
    v_mfma_f32_16x16x32_bf16 v[188:191], v[24:27], v[156:159], v[188:191]
    s_waitcnt lgkmcnt(5)
    v_mfma_f32_32x32x16_bf16 v[44:59], v[168:171], v[160:163], v[44:59]
    ds_read_b128 v[140:143], v17
    ds_read_b64_tr_b16 v[148:149], v19 offset:12288
    s_lshl_b32 s67, s62, 5
    v_add_u32 v3, s67, v3
    v_bfe_u32 v4, v1, 4, 1
    s_waitcnt lgkmcnt(6)
    v_mfma_f32_32x32x16_bf16 v[60:75], v[168:171], v[164:167], v[60:75]
    ds_read_b64_tr_b16 v[150:151], v19 offset:12800
    ds_read_b128 v[144:147], v17 offset:4096
    buffer_load_dwordx4 v11, s[8:11], s71 offen offset:1024 lds
    v_lshlrev_b32 v4, 2, v4
    v_xor_b32 v4, v4, v1
    s_waitcnt lgkmcnt(6)
    v_mfma_f32_32x32x16_bf16 v[76:91], v[160:163], v[172:175], v[76:91]
    ds_read_b64_tr_b16 v[152:153], v19 offset:13312
    ds_read_b64_tr_b16 v[154:155], v19 offset:13824
    v_and_b32 v4, 7, v4
    v_lshlrev_b32 v4, 4, v4
    v_lshl_add_u32 v3, v3, 10, v4
    v_mfma_f32_32x32x16_bf16 v[92:107], v[164:167], v[172:175], v[92:107]
    ds_read_b64_tr_b16 v[156:157], v19 offset:14336
    ds_read_b64_tr_b16 v[158:159], v19 offset:14848
    buffer_load_dwordx4 v11, s[8:11], s71 offen offset:2048 lds
    s_lshl_b32 s67, s93, 7
    v_add_u32 v35, s67, v3
    s_waitcnt lgkmcnt(8)
    v_mfma_f32_32x32x16_bf16 v[108:123], v[160:163], v[176:179], v[108:123]
    v_add_u32 v192, 7168, v35
    v_add_u32 v193, 14336, v35
    v_add_u32 v194, 21504, v35
    s_lshr_b32 s79, s62, 1
    s_lshl_b32 s79, s79, 16
    v_mfma_f32_32x32x16_bf16 v[124:139], v[164:167], v[176:179], v[124:139]
    v_subrev_u32 v13, 0x80000, v12
    buffer_load_dword v14, v13, s[16:19], 0 offen
    s_lshr_b32 s61, s79, 1
    s_lshl_b32 s47, s62, 16
    s_lshl_b32 s68, s91, 12
    s_waitcnt lgkmcnt(5)
    v_mfma_f32_32x32x16_bf16 v[44:59], v[148:151], v[140:143], v[44:59]
    ds_read_b128 v[160:163], v18
    ds_read_b64_tr_b16 v[168:169], v20 offset:12288
    s_lshl_b32 s46, s91, 11
    s_sub_u32 s46, 0x8000, s46
    s_lshr_b32 s67, s65, 5
    s_waitcnt lgkmcnt(6)
    v_mfma_f32_32x32x16_bf16 v[60:75], v[148:151], v[144:147], v[60:75]
    ds_read_b64_tr_b16 v[170:171], v20 offset:12800
    ds_read_b128 v[164:167], v18 offset:4096
    s_add_u32 m0, s72, 81920
    s_mov_b32 s70, 0x300
    buffer_load_dwordx4 v6, s[4:7], s70 offen lds
    v_mfma_f32_16x16x32_bf16 v[180:183], v[24:27], v[148:151], v[180:183]
    s_waitcnt lgkmcnt(6)
    v_mfma_f32_32x32x16_bf16 v[76:91], v[140:143], v[152:155], v[76:91]
    ds_read_b64_tr_b16 v[172:173], v20 offset:13312
    ds_read_b64_tr_b16 v[174:175], v20 offset:13824
    s_add_u32 s67, s67, s62
    s_mul_i32 s67, s67, 147456
    s_add_u32 s67, s67, s68
    v_mfma_f32_32x32x16_bf16 v[92:107], v[144:147], v[152:155], v[92:107]
    ds_read_b64_tr_b16 v[176:177], v20 offset:14336
    ds_read_b64_tr_b16 v[178:179], v20 offset:14848
    buffer_load_dwordx4 v7, s[4:7], s70 offen offset:1024 lds
    s_add_u32 s67, s67, 0x400000
    v_and_b32 v3, 31, v1
    v_mfma_f32_16x16x32_bf16 v[184:187], v[24:27], v[152:155], v[184:187]
    s_waitcnt lgkmcnt(8)
    v_mfma_f32_32x32x16_bf16 v[108:123], v[140:143], v[156:159], v[108:123]
    v_add_u32 v15, 0xfffe2000, v15
    v_add_u32 v16, 0xfffe2000, v16
    v_add_u32 v17, 0xfffe2000, v17
    v_add_u32 v18, 0xfffe2000, v18
    v_add_u32 v19, 0xfffe2000, v19
    v_add_u32 v20, 0xfffe2000, v20
    v_mfma_f32_32x32x16_bf16 v[124:139], v[144:147], v[156:159], v[124:139]
    buffer_load_dwordx4 v8, s[4:7], s70 offen offset:2048 lds
    v_lshrrev_b32 v4, 5, v1
    v_add_u32 v195, s67, v2
    v_add_u32 v196, 2048, v195
    v_mfma_f32_16x16x32_bf16 v[188:191], v[24:27], v[156:159], v[188:191]
    s_waitcnt vmcnt(14) lgkmcnt(0)
    s_barrier
    v_mfma_f32_32x32x16_bf16 v[44:59], v[168:171], v[160:163], v[44:59]
    ds_read_b128 v[140:143], v15
    ds_read_b64_tr_b16 v[148:149], v19
    v_min_u32 v5, 47, v1
    v_lshl_add_u32 v197, v5, 7, s67
    s_lshr_b32 s67, s65, 5
    v_mfma_f32_32x32x16_bf16 v[60:75], v[168:171], v[164:167], v[60:75]
    ds_read_b64_tr_b16 v[150:151], v19 offset:512
    ds_read_b128 v[144:147], v15 offset:4096
    buffer_load_dwordx4 v9, s[4:7], s70 offen offset:3072 lds
    s_and_b32 s69, s62, 2
    s_add_u32 s67, s67, s69
    v_mfma_f32_32x32x16_bf16 v[76:91], v[160:163], v[172:175], v[76:91]
    ds_read_b64_tr_b16 v[152:153], v19 offset:1024
    ds_read_b64_tr_b16 v[154:155], v19 offset:1536
    s_mul_i32 s67, s67, 147456
    s_lshl_b32 s68, s91, 1
    s_and_b32 s69, s62, 1
    v_mfma_f32_32x32x16_bf16 v[92:107], v[164:167], v[172:175], v[92:107]
    ds_read_b64_tr_b16 v[156:157], v19 offset:2048
    ds_read_b64_tr_b16 v[158:159], v19 offset:2560
    s_add_u32 m0, s73, 81920
    s_mov_b32 s71, 0x120000
    buffer_load_dwordx4 v10, s[8:11], s71 offen lds
    v_mfma_f32_32x32x16_bf16 v[108:123], v[160:163], v[176:179], v[108:123]
    s_add_u32 s68, s68, s69
    s_lshl_b32 s68, s68, 11
    s_add_u32 s67, s67, s68
    s_add_u32 s88, s67, 0x41c000
    s_add_u32 s89, s68, 0xf00000
    v_mfma_f32_32x32x16_bf16 v[124:139], v[164:167], v[176:179], v[124:139]
    buffer_load_dwordx4 v10, s[8:11], s71 offen offset:1024 lds
    v_and_b32 v5, 15, v1
    v_lshl_add_u32 v5, v5, 7, s88
    v_mul_u32_u24 v4, 147456, v4
    v_add_u32 v198, v4, v5
    s_waitcnt lgkmcnt(5)
    v_mfma_f32_32x32x16_bf16 v[44:59], v[148:151], v[140:143], v[44:59]
    ds_read_b128 v[160:163], v16
    ds_read_b64_tr_b16 v[168:169], v20
    s_and_b32 s69, s62, 1
    s_lshl_b32 s67, s69, 7
    s_add_u32 s67, s67, 32768
    s_waitcnt lgkmcnt(6)
    v_mfma_f32_32x32x16_bf16 v[60:75], v[148:151], v[144:147], v[60:75]
    ds_read_b64_tr_b16 v[170:171], v20 offset:512
    ds_read_b128 v[164:167], v16 offset:4096
    buffer_load_dwordx4 v10, s[8:11], s71 offen offset:2048 lds
    v_and_b32 v3, 31, v1
    v_lshl_add_u32 v201, v3, 2, s67
    v_mfma_f32_16x16x32_bf16 v[180:183], v[24:27], v[148:151], v[180:183]
    s_waitcnt lgkmcnt(6)
    v_mfma_f32_32x32x16_bf16 v[76:91], v[140:143], v[152:155], v[76:91]
    ds_read_b64_tr_b16 v[172:173], v20 offset:1024
    ds_read_b64_tr_b16 v[174:175], v20 offset:1536
    v_lshrrev_b32 v4, 5, v1
    s_lshr_b32 s67, s62, 1
    s_lshl_b32 s68, s67, 10
    v_mfma_f32_32x32x16_bf16 v[92:107], v[144:147], v[152:155], v[92:107]
    ds_read_b64_tr_b16 v[176:177], v20 offset:2048
    ds_read_b64_tr_b16 v[178:179], v20 offset:2560
    s_add_u32 m0, s73, 84992
    s_mov_b32 s71, 0x120000
    buffer_load_dwordx4 v11, s[8:11], s71 offen lds
    v_mfma_f32_16x16x32_bf16 v[184:187], v[24:27], v[152:155], v[184:187]
    s_waitcnt lgkmcnt(8)
    v_mfma_f32_32x32x16_bf16 v[108:123], v[140:143], v[156:159], v[108:123]
    v_lshl_add_u32 v202, v4, 8, v201
    v_add_u32 v202, s68, v202
    s_lshl_b32 s68, s67, 8
    s_add_u32 s68, s68, 34816
    v_lshl_add_u32 v203, v4, 4, s68
    v_mfma_f32_32x32x16_bf16 v[124:139], v[144:147], v[156:159], v[124:139]
    buffer_load_dwordx4 v11, s[8:11], s71 offen offset:1024 lds
    v_lshl_add_u32 v204, v3, 2, s68
    s_lshl_b32 s68, s69, 6
    s_add_u32 s68, s68, s65
    s_lshl_b32 s68, s68, 2
    v_mfma_f32_16x16x32_bf16 v[188:191], v[24:27], v[156:159], v[188:191]
    s_waitcnt lgkmcnt(5)
    v_mfma_f32_32x32x16_bf16 v[44:59], v[168:171], v[160:163], v[44:59]
    ds_read_b128 v[140:143], v17
    ds_read_b64_tr_b16 v[148:149], v19 offset:12288
    v_lshl_add_u32 v200, v1, 2, s68
    s_lshl_b32 s68, s67, 13
    v_add_u32 v200, s68, v200
    s_waitcnt lgkmcnt(6)
    v_mfma_f32_32x32x16_bf16 v[60:75], v[168:171], v[164:167], v[60:75]
    ds_read_b64_tr_b16 v[150:151], v19 offset:12800
    ds_read_b128 v[144:147], v17 offset:4096
    buffer_load_dwordx4 v11, s[8:11], s71 offen offset:2048 lds
    s_lshl_b32 s68, s91, 1
    s_add_u32 s68, s68, s69
    s_waitcnt lgkmcnt(6)
    v_mfma_f32_32x32x16_bf16 v[76:91], v[160:163], v[172:175], v[76:91]
    ds_read_b64_tr_b16 v[152:153], v19 offset:13312
    ds_read_b64_tr_b16 v[154:155], v19 offset:13824
    s_lshl_b32 s68, s68, 5
    s_add_u32 s67, s67, s68
    s_lshl_b32 s68, s63, 1
    v_mfma_f32_32x32x16_bf16 v[92:107], v[164:167], v[172:175], v[92:107]
    ds_read_b64_tr_b16 v[156:157], v19 offset:14336
    ds_read_b64_tr_b16 v[158:159], v19 offset:14848
    s_add_u32 s67, s67, s68
    s_lshl_b32 s67, s67, 12
    s_add_u32 s67, s67, 0xd00000
    s_waitcnt lgkmcnt(8)
    v_mfma_f32_32x32x16_bf16 v[108:123], v[160:163], v[176:179], v[108:123]
    v_add_u32 v205, s67, v2
    s_lshl_b32 s67, s91, 11
    s_add_u32 s67, s67, 0xf44000
    v_lshl_add_u32 v4, v1, 7, s67
    v_mov_b32 v3, 0x80000000
    v_mfma_f32_32x32x16_bf16 v[124:139], v[164:167], v[176:179], v[124:139]
    v_cmp_gt_u32 vcc, 16, v1
    s_lshl_b32 s68, s62, 6
    s_add_u32 s68, s68, s63
    v_cndmask_b32 v206, v3, v4, vcc
    v_cmp_eq_u32 vcc, s68, v1
    s_waitcnt lgkmcnt(5)
    v_mfma_f32_32x32x16_bf16 v[44:59], v[148:151], v[140:143], v[44:59]
    ds_read_b128 v[160:163], v18
    ds_read_b64_tr_b16 v[168:169], v20 offset:12288
    s_lshl_b32 s100, s62, 8
    s_nop 0
    v_cndmask_b32 v207, v3, v4, vcc
    s_waitcnt lgkmcnt(6)
    v_mfma_f32_32x32x16_bf16 v[60:75], v[148:151], v[144:147], v[60:75]
    ds_read_b64_tr_b16 v[170:171], v20 offset:12800
    ds_read_b128 v[164:167], v18 offset:4096
    v_cmp_gt_u32 vcc, 32, v1
    s_nop 1
    v_cndmask_b32_e64 v28, 0, 1, vcc
    v_mfma_f32_16x16x32_bf16 v[180:183], v[24:27], v[148:151], v[180:183]
    s_waitcnt lgkmcnt(6)
    v_mfma_f32_32x32x16_bf16 v[76:91], v[140:143], v[152:155], v[76:91]
    ds_read_b64_tr_b16 v[172:173], v20 offset:13312
    ds_read_b64_tr_b16 v[174:175], v20 offset:13824
    buffer_load_dword v199, v30, s[32:35], 0 offen sc1
    s_add_u32 m0, s72, 122880
    s_mov_b32 s70, 0x380
    buffer_load_dwordx4 v6, s[4:7], s70 offen lds
    v_mfma_f32_32x32x16_bf16 v[92:107], v[144:147], v[152:155], v[92:107]
    ds_read_b64_tr_b16 v[176:177], v20 offset:14336
    ds_read_b64_tr_b16 v[178:179], v20 offset:14848
    v_mfma_f32_16x16x32_bf16 v[184:187], v[24:27], v[152:155], v[184:187]
    s_waitcnt lgkmcnt(8)
    v_mfma_f32_32x32x16_bf16 v[108:123], v[140:143], v[156:159], v[108:123]
    v_add_u32 v15, 0xa000, v15
    v_add_u32 v16, 0xa000, v16
    v_add_u32 v17, 0xa000, v17
    v_add_u32 v18, 0xa000, v18
    v_add_u32 v19, 0xa000, v19
    v_add_u32 v20, 0xa000, v20
    v_mfma_f32_32x32x16_bf16 v[124:139], v[144:147], v[156:159], v[124:139]
    buffer_load_dwordx4 v7, s[4:7], s70 offen offset:1024 lds
    v_mfma_f32_16x16x32_bf16 v[188:191], v[24:27], v[156:159], v[188:191]
    s_waitcnt vmcnt(14) lgkmcnt(0)
    s_barrier
    v_mfma_f32_32x32x16_bf16 v[44:59], v[168:171], v[160:163], v[44:59]
    ds_read_b128 v[140:143], v15
    ds_read_b64_tr_b16 v[148:149], v19
    v_mfma_f32_32x32x16_bf16 v[60:75], v[168:171], v[164:167], v[60:75]
    ds_read_b64_tr_b16 v[150:151], v19 offset:512
    ds_read_b128 v[144:147], v15 offset:4096
    buffer_load_dwordx4 v8, s[4:7], s70 offen offset:2048 lds
    v_mfma_f32_32x32x16_bf16 v[76:91], v[160:163], v[172:175], v[76:91]
    ds_read_b64_tr_b16 v[152:153], v19 offset:1024
    ds_read_b64_tr_b16 v[154:155], v19 offset:1536
    v_mfma_f32_32x32x16_bf16 v[92:107], v[164:167], v[172:175], v[92:107]
    ds_read_b64_tr_b16 v[156:157], v19 offset:2048
    ds_read_b64_tr_b16 v[158:159], v19 offset:2560
    buffer_load_dwordx4 v9, s[4:7], s70 offen offset:3072 lds
    v_mfma_f32_32x32x16_bf16 v[108:123], v[160:163], v[176:179], v[108:123]
    v_mfma_f32_32x32x16_bf16 v[124:139], v[164:167], v[176:179], v[124:139]
    s_add_u32 m0, s73, 122880
    s_mov_b32 s71, 0x150000
    buffer_load_dwordx4 v10, s[8:11], s71 offen lds
    s_waitcnt lgkmcnt(5)
    v_mfma_f32_32x32x16_bf16 v[44:59], v[148:151], v[140:143], v[44:59]
    ds_read_b128 v[160:163], v16
    ds_read_b64_tr_b16 v[168:169], v20
    s_waitcnt lgkmcnt(6)
    v_mfma_f32_32x32x16_bf16 v[60:75], v[148:151], v[144:147], v[60:75]
    ds_read_b64_tr_b16 v[170:171], v20 offset:512
    ds_read_b128 v[164:167], v16 offset:4096
    buffer_load_dwordx4 v10, s[8:11], s71 offen offset:1024 lds
    v_mfma_f32_16x16x32_bf16 v[180:183], v[24:27], v[148:151], v[180:183]
    s_waitcnt lgkmcnt(6)
    v_mfma_f32_32x32x16_bf16 v[76:91], v[140:143], v[152:155], v[76:91]
    ds_read_b64_tr_b16 v[172:173], v20 offset:1024
    ds_read_b64_tr_b16 v[174:175], v20 offset:1536
    v_mfma_f32_32x32x16_bf16 v[92:107], v[144:147], v[152:155], v[92:107]
    ds_read_b64_tr_b16 v[176:177], v20 offset:2048
    ds_read_b64_tr_b16 v[178:179], v20 offset:2560
    buffer_load_dwordx4 v10, s[8:11], s71 offen offset:2048 lds
    v_mfma_f32_16x16x32_bf16 v[184:187], v[24:27], v[152:155], v[184:187]
    s_waitcnt lgkmcnt(8)
    v_mfma_f32_32x32x16_bf16 v[108:123], v[140:143], v[156:159], v[108:123]
    v_mfma_f32_32x32x16_bf16 v[124:139], v[144:147], v[156:159], v[124:139]
    s_add_u32 m0, s73, 125952
    s_mov_b32 s71, 0x150000
    buffer_load_dwordx4 v11, s[8:11], s71 offen lds
    v_mfma_f32_16x16x32_bf16 v[188:191], v[24:27], v[156:159], v[188:191]
    s_waitcnt lgkmcnt(5)
    v_mfma_f32_32x32x16_bf16 v[44:59], v[168:171], v[160:163], v[44:59]
    ds_read_b128 v[140:143], v17
    ds_read_b64_tr_b16 v[148:149], v19 offset:12288
    s_waitcnt lgkmcnt(6)
    v_mfma_f32_32x32x16_bf16 v[60:75], v[168:171], v[164:167], v[60:75]
    ds_read_b64_tr_b16 v[150:151], v19 offset:12800
    ds_read_b128 v[144:147], v17 offset:4096
    buffer_load_dwordx4 v11, s[8:11], s71 offen offset:1024 lds
    s_waitcnt lgkmcnt(6)
    v_mfma_f32_32x32x16_bf16 v[76:91], v[160:163], v[172:175], v[76:91]
    ds_read_b64_tr_b16 v[152:153], v19 offset:13312
    ds_read_b64_tr_b16 v[154:155], v19 offset:13824
    v_mfma_f32_32x32x16_bf16 v[92:107], v[164:167], v[172:175], v[92:107]
    ds_read_b64_tr_b16 v[156:157], v19 offset:14336
    ds_read_b64_tr_b16 v[158:159], v19 offset:14848
    buffer_load_dwordx4 v11, s[8:11], s71 offen offset:2048 lds
    s_waitcnt lgkmcnt(8)
    v_mfma_f32_32x32x16_bf16 v[108:123], v[160:163], v[176:179], v[108:123]
    v_mfma_f32_32x32x16_bf16 v[124:139], v[164:167], v[176:179], v[124:139]
    v_subrev_u32 v13, 0x240000, v12
    buffer_load_dword v14, v13, s[20:23], 0 offen
    s_waitcnt lgkmcnt(5)
    v_mfma_f32_32x32x16_bf16 v[44:59], v[148:151], v[140:143], v[44:59]
    ds_read_b128 v[160:163], v18
    ds_read_b64_tr_b16 v[168:169], v20 offset:12288
    s_waitcnt lgkmcnt(6)
    v_mfma_f32_32x32x16_bf16 v[60:75], v[148:151], v[144:147], v[60:75]
    ds_read_b64_tr_b16 v[170:171], v20 offset:12800
    ds_read_b128 v[164:167], v18 offset:4096
    v_subrev_u32 v13, 0x380000, v12
    buffer_load_dword v14, v13, s[24:27], 0 offen
    v_mfma_f32_16x16x32_bf16 v[180:183], v[24:27], v[148:151], v[180:183]
    s_waitcnt lgkmcnt(6)
    v_mfma_f32_32x32x16_bf16 v[76:91], v[140:143], v[152:155], v[76:91]
    ds_read_b64_tr_b16 v[172:173], v20 offset:13312
    ds_read_b64_tr_b16 v[174:175], v20 offset:13824
    v_mfma_f32_32x32x16_bf16 v[92:107], v[144:147], v[152:155], v[92:107]
    ds_read_b64_tr_b16 v[176:177], v20 offset:14336
    ds_read_b64_tr_b16 v[178:179], v20 offset:14848
    s_add_u32 m0, s3, 0
    s_mov_b32 s71, 0
    buffer_load_dwordx4 v42, s[16:19], s71 offen lds
    v_mfma_f32_16x16x32_bf16 v[184:187], v[24:27], v[152:155], v[184:187]
    s_waitcnt lgkmcnt(8)
    v_mfma_f32_32x32x16_bf16 v[108:123], v[140:143], v[156:159], v[108:123]
    v_add_u32 v15, 0xa000, v15
    v_add_u32 v16, 0xa000, v16
    v_add_u32 v17, 0xa000, v17
    v_add_u32 v18, 0xa000, v18
    v_add_u32 v19, 0xa000, v19
    v_add_u32 v20, 0xa000, v20
    v_mfma_f32_32x32x16_bf16 v[124:139], v[144:147], v[156:159], v[124:139]
    buffer_load_dwordx4 v43, s[16:19], s71 offen offset:1024 lds
    v_mfma_f32_16x16x32_bf16 v[188:191], v[24:27], v[156:159], v[188:191]
    s_waitcnt vmcnt(15) lgkmcnt(0)
    s_barrier
    v_mfma_f32_32x32x16_bf16 v[44:59], v[168:171], v[160:163], v[44:59]
    ds_read_b128 v[140:143], v15
    ds_read_b64_tr_b16 v[148:149], v19
    v_mfma_f32_32x32x16_bf16 v[60:75], v[168:171], v[164:167], v[60:75]
    ds_read_b64_tr_b16 v[150:151], v19 offset:512
    ds_read_b128 v[144:147], v15 offset:4096
    buffer_load_dwordx4 v33, s[16:19], s71 offen offset:2048 lds
    v_mfma_f32_32x32x16_bf16 v[76:91], v[160:163], v[172:175], v[76:91]
    ds_read_b64_tr_b16 v[152:153], v19 offset:1024
    ds_read_b64_tr_b16 v[154:155], v19 offset:1536
    v_mfma_f32_32x32x16_bf16 v[92:107], v[164:167], v[172:175], v[92:107]
    ds_read_b64_tr_b16 v[156:157], v19 offset:2048
    ds_read_b64_tr_b16 v[158:159], v19 offset:2560
    buffer_load_dwordx4 v34, s[16:19], s71 offen offset:3072 lds
    v_mfma_f32_32x32x16_bf16 v[108:123], v[160:163], v[176:179], v[108:123]
    v_mfma_f32_32x32x16_bf16 v[124:139], v[164:167], v[176:179], v[124:139]
    s_add_u32 m0, s3, 16384
    s_mov_b32 s71, 229376
    buffer_load_dwordx4 v42, s[16:19], s71 offen lds
    s_waitcnt lgkmcnt(5)
    v_mfma_f32_32x32x16_bf16 v[44:59], v[148:151], v[140:143], v[44:59]
    ds_read_b128 v[160:163], v16
    ds_read_b64_tr_b16 v[168:169], v20
    s_waitcnt lgkmcnt(6)
    v_mfma_f32_32x32x16_bf16 v[60:75], v[148:151], v[144:147], v[60:75]
    ds_read_b64_tr_b16 v[170:171], v20 offset:512
    ds_read_b128 v[164:167], v16 offset:4096
    buffer_load_dwordx4 v43, s[16:19], s71 offen offset:1024 lds
    v_mfma_f32_16x16x32_bf16 v[180:183], v[24:27], v[148:151], v[180:183]
    s_waitcnt lgkmcnt(6)
    v_mfma_f32_32x32x16_bf16 v[76:91], v[140:143], v[152:155], v[76:91]
    ds_read_b64_tr_b16 v[172:173], v20 offset:1024
    ds_read_b64_tr_b16 v[174:175], v20 offset:1536
    v_mfma_f32_32x32x16_bf16 v[92:107], v[144:147], v[152:155], v[92:107]
    ds_read_b64_tr_b16 v[176:177], v20 offset:2048
    ds_read_b64_tr_b16 v[178:179], v20 offset:2560
    buffer_load_dwordx4 v33, s[16:19], s71 offen offset:2048 lds
    v_mfma_f32_16x16x32_bf16 v[184:187], v[24:27], v[152:155], v[184:187]
    s_waitcnt lgkmcnt(8)
    v_mfma_f32_32x32x16_bf16 v[108:123], v[140:143], v[156:159], v[108:123]
    v_mfma_f32_32x32x16_bf16 v[124:139], v[144:147], v[156:159], v[124:139]
    buffer_load_dwordx4 v34, s[16:19], s71 offen offset:3072 lds
    v_mfma_f32_16x16x32_bf16 v[188:191], v[24:27], v[156:159], v[188:191]
    s_waitcnt lgkmcnt(5)
    v_mfma_f32_32x32x16_bf16 v[44:59], v[168:171], v[160:163], v[44:59]
    ds_read_b128 v[140:143], v17
    ds_read_b64_tr_b16 v[148:149], v19 offset:12288
    s_waitcnt lgkmcnt(6)
    v_mfma_f32_32x32x16_bf16 v[60:75], v[168:171], v[164:167], v[60:75]
    ds_read_b64_tr_b16 v[150:151], v19 offset:12800
    ds_read_b128 v[144:147], v17 offset:4096
    s_waitcnt lgkmcnt(6)
    v_mfma_f32_32x32x16_bf16 v[76:91], v[160:163], v[172:175], v[76:91]
    ds_read_b64_tr_b16 v[152:153], v19 offset:13312
    ds_read_b64_tr_b16 v[154:155], v19 offset:13824
    v_mfma_f32_32x32x16_bf16 v[92:107], v[164:167], v[172:175], v[92:107]
    ds_read_b64_tr_b16 v[156:157], v19 offset:14336
    ds_read_b64_tr_b16 v[158:159], v19 offset:14848
    s_waitcnt vmcnt(20)
    v_readfirstlane_b32 s66, v199
    s_nop 1
    s_cmp_eq_u32 s66, 0
    s_cbranch_scc1 L_nslow_25
L_nback_26:
    s_add_u32 s101, s101, s66
    s_add_u32 s67, s101, 0
    v_mov_b32 v29, s67
    buffer_store_dword v29, v21, s[36:39], 0 offen
    s_waitcnt lgkmcnt(8)
    v_mfma_f32_32x32x16_bf16 v[108:123], v[160:163], v[176:179], v[108:123]
    v_mfma_f32_32x32x16_bf16 v[124:139], v[164:167], v[176:179], v[124:139]
    s_add_u32 m0, s3, 49152
    s_mov_b32 s71, 458752
    buffer_load_dwordx4 v42, s[16:19], s71 offen lds
    s_waitcnt lgkmcnt(5)
    v_mfma_f32_32x32x16_bf16 v[44:59], v[148:151], v[140:143], v[44:59]
    ds_read_b128 v[160:163], v18
    ds_read_b64_tr_b16 v[168:169], v20 offset:12288
    s_waitcnt lgkmcnt(6)
    v_mfma_f32_32x32x16_bf16 v[60:75], v[148:151], v[144:147], v[60:75]
    ds_read_b64_tr_b16 v[170:171], v20 offset:12800
    ds_read_b128 v[164:167], v18 offset:4096
    buffer_load_dwordx4 v43, s[16:19], s71 offen offset:1024 lds
    v_mfma_f32_16x16x32_bf16 v[180:183], v[24:27], v[148:151], v[180:183]
    s_waitcnt lgkmcnt(6)
    v_mfma_f32_32x32x16_bf16 v[76:91], v[140:143], v[152:155], v[76:91]
    ds_read_b64_tr_b16 v[172:173], v20 offset:13312
    ds_read_b64_tr_b16 v[174:175], v20 offset:13824
    v_mfma_f32_32x32x16_bf16 v[92:107], v[144:147], v[152:155], v[92:107]
    ds_read_b64_tr_b16 v[176:177], v20 offset:14336
    ds_read_b64_tr_b16 v[178:179], v20 offset:14848
    buffer_load_dwordx4 v33, s[16:19], s71 offen offset:2048 lds
    v_mfma_f32_16x16x32_bf16 v[184:187], v[24:27], v[152:155], v[184:187]
    s_waitcnt lgkmcnt(8)
    v_mfma_f32_32x32x16_bf16 v[108:123], v[140:143], v[156:159], v[108:123]
    v_add_u32 v15, 0xa000, v15
    v_add_u32 v16, 0xa000, v16
    v_add_u32 v17, 0xa000, v17
    v_add_u32 v18, 0xa000, v18
    v_add_u32 v19, 0xa000, v19
    v_add_u32 v20, 0xa000, v20
    v_mfma_f32_32x32x16_bf16 v[124:139], v[144:147], v[156:159], v[124:139]
    buffer_load_dwordx4 v34, s[16:19], s71 offen offset:3072 lds
    v_mfma_f32_16x16x32_bf16 v[188:191], v[24:27], v[156:159], v[188:191]
    s_waitcnt vmcnt(15) lgkmcnt(0)
    s_barrier
    v_mfma_f32_32x32x16_bf16 v[44:59], v[168:171], v[160:163], v[44:59]
    ds_read_b128 v[140:143], v15
    ds_read_b64_tr_b16 v[148:149], v19
    v_mfma_f32_32x32x16_bf16 v[60:75], v[168:171], v[164:167], v[60:75]
    ds_read_b64_tr_b16 v[150:151], v19 offset:512
    ds_read_b128 v[144:147], v15 offset:4096
    s_add_u32 m0, s3, 65536
    s_mov_b32 s71, 688128
    buffer_load_dwordx4 v42, s[16:19], s71 offen lds
    v_mfma_f32_32x32x16_bf16 v[76:91], v[160:163], v[172:175], v[76:91]
    ds_read_b64_tr_b16 v[152:153], v19 offset:1024
    ds_read_b64_tr_b16 v[154:155], v19 offset:1536
    v_mfma_f32_32x32x16_bf16 v[92:107], v[164:167], v[172:175], v[92:107]
    ds_read_b64_tr_b16 v[156:157], v19 offset:2048
    ds_read_b64_tr_b16 v[158:159], v19 offset:2560
    buffer_load_dwordx4 v43, s[16:19], s71 offen offset:1024 lds
    v_mfma_f32_32x32x16_bf16 v[108:123], v[160:163], v[176:179], v[108:123]
    v_mfma_f32_32x32x16_bf16 v[124:139], v[164:167], v[176:179], v[124:139]
    buffer_load_dwordx4 v33, s[16:19], s71 offen offset:2048 lds
    s_waitcnt lgkmcnt(5)
    v_mfma_f32_32x32x16_bf16 v[44:59], v[148:151], v[140:143], v[44:59]
    ds_read_b128 v[160:163], v16
    ds_read_b64_tr_b16 v[168:169], v20
    s_waitcnt lgkmcnt(6)
    v_mfma_f32_32x32x16_bf16 v[60:75], v[148:151], v[144:147], v[60:75]
    ds_read_b64_tr_b16 v[170:171], v20 offset:512
    ds_read_b128 v[164:167], v16 offset:4096
    buffer_load_dwordx4 v34, s[16:19], s71 offen offset:3072 lds
    buffer_load_dword v23, v22, s[36:39], 0 offen sc1
    v_mfma_f32_16x16x32_bf16 v[180:183], v[24:27], v[148:151], v[180:183]
    s_waitcnt lgkmcnt(6)
    v_mfma_f32_32x32x16_bf16 v[76:91], v[140:143], v[152:155], v[76:91]
    ds_read_b64_tr_b16 v[172:173], v20 offset:1024
    ds_read_b64_tr_b16 v[174:175], v20 offset:1536
    v_mfma_f32_32x32x16_bf16 v[92:107], v[144:147], v[152:155], v[92:107]
    ds_read_b64_tr_b16 v[176:177], v20 offset:2048
    ds_read_b64_tr_b16 v[178:179], v20 offset:2560
    s_add_u32 m0, s3, 81920
    s_mov_b32 s71, 917504
    buffer_load_dwordx4 v42, s[16:19], s71 offen lds
    v_mfma_f32_16x16x32_bf16 v[184:187], v[24:27], v[152:155], v[184:187]
    s_waitcnt lgkmcnt(8)
    v_mfma_f32_32x32x16_bf16 v[108:123], v[140:143], v[156:159], v[108:123]
    v_mfma_f32_32x32x16_bf16 v[124:139], v[144:147], v[156:159], v[124:139]
    buffer_load_dwordx4 v43, s[16:19], s71 offen offset:1024 lds
    v_mfma_f32_16x16x32_bf16 v[188:191], v[24:27], v[156:159], v[188:191]
    s_waitcnt lgkmcnt(5)
    v_mfma_f32_32x32x16_bf16 v[44:59], v[168:171], v[160:163], v[44:59]
    ds_read_b128 v[140:143], v17
    ds_read_b64_tr_b16 v[148:149], v19 offset:12288
    s_waitcnt lgkmcnt(6)
    v_mfma_f32_32x32x16_bf16 v[60:75], v[168:171], v[164:167], v[60:75]
    ds_read_b64_tr_b16 v[150:151], v19 offset:12800
    ds_read_b128 v[144:147], v17 offset:4096
    buffer_load_dwordx4 v33, s[16:19], s71 offen offset:2048 lds
    s_waitcnt lgkmcnt(6)
    v_mfma_f32_32x32x16_bf16 v[76:91], v[160:163], v[172:175], v[76:91]
    ds_read_b64_tr_b16 v[152:153], v19 offset:13312
    ds_read_b64_tr_b16 v[154:155], v19 offset:13824
    v_mfma_f32_32x32x16_bf16 v[92:107], v[164:167], v[172:175], v[92:107]
    ds_read_b64_tr_b16 v[156:157], v19 offset:14336
    ds_read_b64_tr_b16 v[158:159], v19 offset:14848
    buffer_load_dwordx4 v34, s[16:19], s71 offen offset:3072 lds
    s_waitcnt lgkmcnt(8)
    v_mfma_f32_32x32x16_bf16 v[108:123], v[160:163], v[176:179], v[108:123]
    v_mfma_f32_32x32x16_bf16 v[124:139], v[164:167], v[176:179], v[124:139]
    s_add_u32 m0, s3, 98304
    s_mov_b32 s71, 1146880
    buffer_load_dwordx4 v42, s[16:19], s71 offen lds
    s_waitcnt lgkmcnt(5)
    v_mfma_f32_32x32x16_bf16 v[44:59], v[148:151], v[140:143], v[44:59]
    ds_read_b128 v[160:163], v18
    ds_read_b64_tr_b16 v[168:169], v20 offset:12288
    s_waitcnt lgkmcnt(6)
    v_mfma_f32_32x32x16_bf16 v[60:75], v[148:151], v[144:147], v[60:75]
    ds_read_b64_tr_b16 v[170:171], v20 offset:12800
    ds_read_b128 v[164:167], v18 offset:4096
    buffer_load_dwordx4 v43, s[16:19], s71 offen offset:1024 lds
    v_mfma_f32_16x16x32_bf16 v[180:183], v[24:27], v[148:151], v[180:183]
    s_waitcnt lgkmcnt(6)
    v_mfma_f32_32x32x16_bf16 v[76:91], v[140:143], v[152:155], v[76:91]
    ds_read_b64_tr_b16 v[172:173], v20 offset:13312
    ds_read_b64_tr_b16 v[174:175], v20 offset:13824
    v_mfma_f32_32x32x16_bf16 v[92:107], v[144:147], v[152:155], v[92:107]
    ds_read_b64_tr_b16 v[176:177], v20 offset:14336
    ds_read_b64_tr_b16 v[178:179], v20 offset:14848
    buffer_load_dwordx4 v33, s[16:19], s71 offen offset:2048 lds
    v_mfma_f32_16x16x32_bf16 v[184:187], v[24:27], v[152:155], v[184:187]
    s_waitcnt lgkmcnt(8)
    v_mfma_f32_32x32x16_bf16 v[108:123], v[140:143], v[156:159], v[108:123]
    v_mfma_f32_32x32x16_bf16 v[124:139], v[144:147], v[156:159], v[124:139]
    buffer_load_dwordx4 v34, s[16:19], s71 offen offset:3072 lds
    s_waitcnt vmcnt(8)
    v_subrev_u32 v23, s101, v23
    v_cmp_gt_u32 vcc, 8, v23
    s_nop 1
    v_cndmask_b32 v23, 0, v23, vcc
    s_cmp_eq_u64 vcc, -1
    s_cselect_b32 s1, 1, s1
    v_cmp_lt_u32 vcc, v23, v28
    s_nop 1
    s_cbranch_vccnz L_slow_27
L_back_28:
    s_lshl_b32 s67, s62, 8
    s_add_u32 m0, s67, 34816
    s_mov_b32 s70, 15794176
    buffer_load_dword v200, s[36:39], s70 offen sc1 lds
    v_mfma_f32_16x16x32_bf16 v[188:191], v[24:27], v[156:159], v[188:191]
    s_waitcnt lgkmcnt(5)
    v_mfma_f32_32x32x16_bf16 v[44:59], v[168:171], v[160:163], v[44:59]
    s_waitcnt lgkmcnt(4)
    v_mfma_f32_32x32x16_bf16 v[60:75], v[168:171], v[164:167], v[60:75]
    s_waitcnt lgkmcnt(2)
    v_mfma_f32_32x32x16_bf16 v[76:91], v[160:163], v[172:175], v[76:91]
    v_mfma_f32_32x32x16_bf16 v[92:107], v[164:167], v[172:175], v[92:107]
    s_waitcnt lgkmcnt(0)
    v_mfma_f32_32x32x16_bf16 v[108:123], v[160:163], v[176:179], v[108:123]
    v_mfma_f32_32x32x16_bf16 v[124:139], v[164:167], v[176:179], v[124:139]
    v_cndmask_b32_e64 v180, v180, v184, s[86:87]
    ds_write_b32 v202, v188 offset:512
    ds_write_b32 v202, v180
    s_waitcnt vmcnt(0) lgkmcnt(0)
    s_barrier
    ds_read2_b32 v[16:17], v204 offset0:0 offset1:128
    ds_read2_b32 v[18:19], v204 offset0:32 offset1:160
    ds_read2st64_b32 v[38:39], v201 offset0:1 offset1:5
    ds_read2st64_b32 v[40:41], v201 offset0:2 offset1:6
    ds_read2st64_b32 v[36:37], v201 offset0:0 offset1:4
    ds_read_b128 v[208:211], v203 offset:512
    ds_read_b128 v[212:215], v203 offset:544
    ds_read_b128 v[216:219], v203 offset:576
    ds_read_b128 v[220:223], v203 offset:608
    v_mov_b32 v230, 0
    v_mov_b32 v231, 0
    v_mov_b32 v234, 0
    v_mov_b32 v235, 0
    v_mov_b32 v238, 0
    v_mov_b32 v239, 0
    s_waitcnt lgkmcnt(7)
    v_sub_f32 v16, 0, v16
    v_and_b32 v3, 0xffff0000, v16
    v_cvt_pk_bf16_f32 v8, v3, v3
    v_sub_f32 v3, v16, v3
    v_cvt_pk_bf16_f32 v9, v3, 0
    v_mov_b32 v10, 0
    v_mov_b32 v11, 0
    v_sub_f32 v18, 0, v18
    v_and_b32 v3, 0xffff0000, v18
    v_cvt_pk_bf16_f32 v224, v3, v3
    v_sub_f32 v3, v18, v3
    v_cvt_pk_bf16_f32 v225, v3, 0
    v_mov_b32 v226, 0
    v_mov_b32 v227, 0
    s_waitcnt lgkmcnt(6)
    v_add_f32 v38, v38, v39
    v_cndmask_b32_e64 v38, v38, 0, s[86:87]
    v_and_b32 v39, 0xffff0000, v38
    v_sub_f32 v38, v38, v39
    v_lshrrev_b32 v233, 16, v39
    v_cvt_pk_bf16_f32 v232, v39, v38
    s_nop 1
    v_mfma_f32_32x32x16_bf16 v[76:91], v[8:11], v[232:235], v[76:91]
    v_mfma_f32_32x32x16_bf16 v[92:107], v[224:227], v[232:235], v[92:107]
    s_waitcnt lgkmcnt(5)
    v_add_f32 v40, v40, v41
    v_cndmask_b32_e64 v40, v40, 0, s[86:87]
    v_and_b32 v41, 0xffff0000, v40
    v_sub_f32 v40, v40, v41
    v_lshrrev_b32 v237, 16, v41
    v_cvt_pk_bf16_f32 v236, v41, v40
    s_nop 1
    v_mfma_f32_32x32x16_bf16 v[108:123], v[8:11], v[236:239], v[108:123]
    v_mfma_f32_32x32x16_bf16 v[124:139], v[224:227], v[236:239], v[124:139]
    s_waitcnt lgkmcnt(4)
    v_add_f32 v36, v36, v37
    v_cndmask_b32_e64 v36, v36, 0, s[86:87]
    v_and_b32 v37, 0xffff0000, v36
    v_sub_f32 v36, v36, v37
    v_lshrrev_b32 v229, 16, v37
    v_cvt_pk_bf16_f32 v228, v37, v36
    s_nop 1
    v_mfma_f32_32x32x16_bf16 v[44:59], v[228:231], v[8:11], v[44:59]
    v_mfma_f32_32x32x16_bf16 v[60:75], v[228:231], v[224:227], v[60:75]
    v_mov_b32 v152, 0x3f803f80
    v_mov_b32 v153, 0x3f803f80
    v_mov_b32 v154, 0x3f803f80
    v_mov_b32 v155, 0x3f803f80
    s_lshl_b32 s67, s91, 1
    s_lshr_b32 s68, s63, 3
    s_add_u32 s67, s67, s68
    s_bfe_u32 s68, s63, 0x10002
    s_and_b32 s69, s63, 3
    s_lshl_b32 s69, s69, 2
    s_add_u32 s69, s69, s62
    s_lshl_b32 s69, s69, 6
    v_and_b32 v3, 3, v1
    v_lshl_add_u32 v3, v3, 4, s69
    s_lshl_b32 s100, s67, 17
    s_lshl_b32 s69, s68, 11
    s_add_u32 s100, s100, s69
    s_add_u32 s100, s100, 0xd00000
    v_lshrrev_b32 v4, 2, v1
    v_lshl_add_u32 v252, v4, 12, v3
    v_add_u32 v252, s100, v252
    s_lshl_b32 s67, s67, 1
    s_add_u32 s67, s67, s68
    s_lshl_b32 s67, s67, 10
    s_add_u32 s67, s67, 0xf00000
    v_lshrrev_b32 v4, 4, v1
    v_lshl_add_u32 v3, v4, 2, v3
    v_add_u32 v3, s67, v3
    v_and_b32 v4, 12, v1
    v_cmp_eq_u32 vcc, 0, v4
    v_mov_b32 v4, 0x80000000
    s_nop 0
    v_cndmask_b32 v253, v4, v3, vcc
    v_cmp_gt_u32 vcc, 16, v1
    s_nop 1
    v_cndmask_b32_e64 v15, 0, 1, vcc
    s_and_b32 s67, s62, 1
    v_lshrrev_b32 v3, 3, v1
    v_cmp_eq_u32 vcc, s67, v3
    s_nop 1
    v_cndmask_b32_e64 v20, 0, 2, vcc
    s_waitcnt lgkmcnt(2)
    v_pk_fma_f32 v[76:77], v[76:77], v[208:209], s[74:75] op_sel_hi:[1,1,0]
    v_pk_fma_f32 v[78:79], v[78:79], v[210:211], s[74:75] op_sel_hi:[1,1,0]
    v_pk_fma_f32 v[80:81], v[80:81], v[212:213], s[74:75] op_sel_hi:[1,1,0]
    v_pk_fma_f32 v[82:83], v[82:83], v[214:215], s[74:75] op_sel_hi:[1,1,0]
    v_pk_mul_f32 v[108:109], v[108:109], v[208:209]
    v_pk_mul_f32 v[110:111], v[110:111], v[210:211]
    v_pk_mul_f32 v[112:113], v[112:113], v[212:213]
    v_pk_mul_f32 v[114:115], v[114:115], v[214:215]
    ds_read_b128 v[208:211], v203 offset:640
    ds_read_b128 v[212:215], v203 offset:672
    s_add_u32 m0, s3, 131072
    s_mov_b32 s71, 1376256
    buffer_load_dwordx4 v42, s[16:19], s71 offen lds
    v_pk_fma_f32 v[240:241], v[76:77], s[76:77], s[76:77] op_sel:[0,0,1] op_sel_hi:[1,0,1]
    v_pk_fma_f32 v[242:243], v[78:79], s[76:77], s[76:77] op_sel:[0,0,1] op_sel_hi:[1,0,1]
    v_pk_fma_f32 v[244:245], v[80:81], s[76:77], s[76:77] op_sel:[0,0,1] op_sel_hi:[1,0,1]
    v_pk_fma_f32 v[246:247], v[82:83], s[76:77], s[76:77] op_sel:[0,0,1] op_sel_hi:[1,0,1]
    v_exp_f32_e64 v240, v240 clamp
    v_exp_f32_e64 v241, v241 clamp
    v_exp_f32_e64 v242, v242 clamp
    v_exp_f32_e64 v243, v243 clamp
    v_exp_f32_e64 v244, v244 clamp
    v_exp_f32_e64 v245, v245 clamp
    v_exp_f32_e64 v246, v246 clamp
    v_exp_f32_e64 v247, v247 clamp
    buffer_load_dwordx4 v43, s[16:19], s71 offen offset:1024 lds
    v_cvt_pk_bf16_f32 v144, v108, v109
    v_cvt_pk_bf16_f32 v145, v110, v111
    v_cvt_pk_bf16_f32 v146, v112, v113
    v_cvt_pk_bf16_f32 v147, v114, v115
    v_pk_add_f32 v[240:241], v[240:241], s[74:75] op_sel:[0,1] op_sel_hi:[1,1]
    v_pk_add_f32 v[242:243], v[242:243], s[74:75] op_sel:[0,1] op_sel_hi:[1,1]
    v_pk_add_f32 v[244:245], v[244:245], s[74:75] op_sel:[0,1] op_sel_hi:[1,1]
    v_pk_add_f32 v[246:247], v[246:247], s[74:75] op_sel:[0,1] op_sel_hi:[1,1]
    v_max_f32 v240, v240, v76
    v_max_f32 v241, v241, v77
    v_max_f32 v242, v242, v78
    v_max_f32 v243, v243, v79
    v_max_f32 v244, v244, v80
    v_max_f32 v245, v245, v81
    v_max_f32 v246, v246, v82
    v_max_f32 v247, v247, v83
    buffer_load_dwordx4 v33, s[16:19], s71 offen offset:2048 lds
    v_cvt_pk_bf16_f32 v248, v240, v241
    v_cvt_pk_bf16_f32 v249, v242, v243
    v_cvt_pk_bf16_f32 v250, v244, v245
    v_cvt_pk_bf16_f32 v251, v246, v247
    s_nop 1
    v_mfma_f32_32x32x16_bf16 v[172:187], v[248:251], v[152:155], 0
    v_mfma_f32_32x32x16_bf16 v[156:171], v[248:251], v[144:147], 0
    s_waitcnt lgkmcnt(2)
    v_pk_fma_f32 v[84:85], v[84:85], v[216:217], s[74:75] op_sel_hi:[1,1,0]
    v_pk_fma_f32 v[86:87], v[86:87], v[218:219], s[74:75] op_sel_hi:[1,1,0]
    v_pk_fma_f32 v[88:89], v[88:89], v[220:221], s[74:75] op_sel_hi:[1,1,0]
    v_pk_fma_f32 v[90:91], v[90:91], v[222:223], s[74:75] op_sel_hi:[1,1,0]
    v_pk_mul_f32 v[116:117], v[116:117], v[216:217]
    v_pk_mul_f32 v[118:119], v[118:119], v[218:219]
    v_pk_mul_f32 v[120:121], v[120:121], v[220:221]
    v_pk_mul_f32 v[122:123], v[122:123], v[222:223]
    ds_read_b128 v[216:219], v203 offset:704
    ds_read_b128 v[220:223], v203 offset:736
    buffer_load_dwordx4 v34, s[16:19], s71 offen offset:3072 lds
    v_pk_fma_f32 v[240:241], v[84:85], s[76:77], s[76:77] op_sel:[0,0,1] op_sel_hi:[1,0,1]
    v_pk_fma_f32 v[242:243], v[86:87], s[76:77], s[76:77] op_sel:[0,0,1] op_sel_hi:[1,0,1]
    v_pk_fma_f32 v[244:245], v[88:89], s[76:77], s[76:77] op_sel:[0,0,1] op_sel_hi:[1,0,1]
    v_pk_fma_f32 v[246:247], v[90:91], s[76:77], s[76:77] op_sel:[0,0,1] op_sel_hi:[1,0,1]
    v_exp_f32_e64 v240, v240 clamp
    v_exp_f32_e64 v241, v241 clamp
    v_exp_f32_e64 v242, v242 clamp
    v_exp_f32_e64 v243, v243 clamp
    v_exp_f32_e64 v244, v244 clamp
    v_exp_f32_e64 v245, v245 clamp
    v_exp_f32_e64 v246, v246 clamp
    v_exp_f32_e64 v247, v247 clamp
    s_add_u32 m0, s3, 147456
    s_mov_b32 s71, 1605632
    buffer_load_dwordx4 v42, s[16:19], s71 offen lds
    v_cvt_pk_bf16_f32 v148, v116, v117
    v_cvt_pk_bf16_f32 v149, v118, v119
    v_cvt_pk_bf16_f32 v150, v120, v121
    v_cvt_pk_bf16_f32 v151, v122, v123
    v_pk_add_f32 v[240:241], v[240:241], s[74:75] op_sel:[0,1] op_sel_hi:[1,1]
    v_pk_add_f32 v[242:243], v[242:243], s[74:75] op_sel:[0,1] op_sel_hi:[1,1]
    v_pk_add_f32 v[244:245], v[244:245], s[74:75] op_sel:[0,1] op_sel_hi:[1,1]
    v_pk_add_f32 v[246:247], v[246:247], s[74:75] op_sel:[0,1] op_sel_hi:[1,1]
    v_max_f32 v240, v240, v84
    v_max_f32 v241, v241, v85
    v_max_f32 v242, v242, v86
    v_max_f32 v243, v243, v87
    v_max_f32 v244, v244, v88
    v_max_f32 v245, v245, v89
    v_max_f32 v246, v246, v90
    v_max_f32 v247, v247, v91
    buffer_load_dwordx4 v43, s[16:19], s71 offen offset:1024 lds
    v_cvt_pk_bf16_f32 v140, v240, v241
    v_cvt_pk_bf16_f32 v141, v242, v243
    v_cvt_pk_bf16_f32 v142, v244, v245
    v_cvt_pk_bf16_f32 v143, v246, v247
    s_nop 1
    v_mfma_f32_32x32x16_bf16 v[172:187], v[140:143], v[152:155], v[172:187]
    v_mfma_f32_32x32x16_bf16 v[156:171], v[140:143], v[148:151], v[156:171]
    s_waitcnt lgkmcnt(2)
    v_pk_fma_f32 v[92:93], v[92:93], v[208:209], s[74:75] op_sel_hi:[1,1,0]
    v_pk_fma_f32 v[94:95], v[94:95], v[210:211], s[74:75] op_sel_hi:[1,1,0]
    v_pk_fma_f32 v[96:97], v[96:97], v[212:213], s[74:75] op_sel_hi:[1,1,0]
    v_pk_fma_f32 v[98:99], v[98:99], v[214:215], s[74:75] op_sel_hi:[1,1,0]
    v_pk_mul_f32 v[124:125], v[124:125], v[208:209]
    v_pk_mul_f32 v[126:127], v[126:127], v[210:211]
    v_pk_mul_f32 v[128:129], v[128:129], v[212:213]
    v_pk_mul_f32 v[130:131], v[130:131], v[214:215]
    buffer_load_dwordx4 v33, s[16:19], s71 offen offset:2048 lds
    v_pk_fma_f32 v[240:241], v[92:93], s[76:77], s[76:77] op_sel:[0,0,1] op_sel_hi:[1,0,1]
    v_pk_fma_f32 v[242:243], v[94:95], s[76:77], s[76:77] op_sel:[0,0,1] op_sel_hi:[1,0,1]
    v_pk_fma_f32 v[244:245], v[96:97], s[76:77], s[76:77] op_sel:[0,0,1] op_sel_hi:[1,0,1]
    v_pk_fma_f32 v[246:247], v[98:99], s[76:77], s[76:77] op_sel:[0,0,1] op_sel_hi:[1,0,1]
    v_exp_f32_e64 v240, v240 clamp
    v_exp_f32_e64 v241, v241 clamp
    v_exp_f32_e64 v242, v242 clamp
    v_exp_f32_e64 v243, v243 clamp
    v_exp_f32_e64 v244, v244 clamp
    v_exp_f32_e64 v245, v245 clamp
    v_exp_f32_e64 v246, v246 clamp
    v_exp_f32_e64 v247, v247 clamp
    buffer_load_dwordx4 v34, s[16:19], s71 offen offset:3072 lds
    v_cvt_pk_bf16_f32 v144, v124, v125
    v_cvt_pk_bf16_f32 v145, v126, v127
    v_cvt_pk_bf16_f32 v146, v128, v129
    v_cvt_pk_bf16_f32 v147, v130, v131
    v_pk_add_f32 v[240:241], v[240:241], s[74:75] op_sel:[0,1] op_sel_hi:[1,1]
    v_pk_add_f32 v[242:243], v[242:243], s[74:75] op_sel:[0,1] op_sel_hi:[1,1]
    v_pk_add_f32 v[244:245], v[244:245], s[74:75] op_sel:[0,1] op_sel_hi:[1,1]
    v_pk_add_f32 v[246:247], v[246:247], s[74:75] op_sel:[0,1] op_sel_hi:[1,1]
    v_max_f32 v240, v240, v92
    v_max_f32 v241, v241, v93
    v_max_f32 v242, v242, v94
    v_max_f32 v243, v243, v95
    v_max_f32 v244, v244, v96
    v_max_f32 v245, v245, v97
    v_max_f32 v246, v246, v98
    v_max_f32 v247, v247, v99
    v_cvt_pk_bf16_f32 v248, v240, v241
    v_cvt_pk_bf16_f32 v249, v242, v243
    v_cvt_pk_bf16_f32 v250, v244, v245
    v_cvt_pk_bf16_f32 v251, v246, v247
    s_nop 1
    v_mfma_f32_32x32x16_bf16 v[172:187], v[248:251], v[152:155], v[172:187]
    v_mfma_f32_32x32x16_bf16 v[156:171], v[248:251], v[144:147], v[156:171]
    s_waitcnt lgkmcnt(0)
    v_pk_fma_f32 v[100:101], v[100:101], v[216:217], s[74:75] op_sel_hi:[1,1,0]
    v_pk_fma_f32 v[102:103], v[102:103], v[218:219], s[74:75] op_sel_hi:[1,1,0]
    v_pk_fma_f32 v[104:105], v[104:105], v[220:221], s[74:75] op_sel_hi:[1,1,0]
    v_pk_fma_f32 v[106:107], v[106:107], v[222:223], s[74:75] op_sel_hi:[1,1,0]
    v_pk_mul_f32 v[132:133], v[132:133], v[216:217]
    v_pk_mul_f32 v[134:135], v[134:135], v[218:219]
    v_pk_mul_f32 v[136:137], v[136:137], v[220:221]
    v_pk_mul_f32 v[138:139], v[138:139], v[222:223]
    v_pk_fma_f32 v[240:241], v[100:101], s[76:77], s[76:77] op_sel:[0,0,1] op_sel_hi:[1,0,1]
    v_pk_fma_f32 v[242:243], v[102:103], s[76:77], s[76:77] op_sel:[0,0,1] op_sel_hi:[1,0,1]
    v_pk_fma_f32 v[244:245], v[104:105], s[76:77], s[76:77] op_sel:[0,0,1] op_sel_hi:[1,0,1]
    v_pk_fma_f32 v[246:247], v[106:107], s[76:77], s[76:77] op_sel:[0,0,1] op_sel_hi:[1,0,1]
    v_exp_f32_e64 v240, v240 clamp
    v_exp_f32_e64 v241, v241 clamp
    v_exp_f32_e64 v242, v242 clamp
    v_exp_f32_e64 v243, v243 clamp
    v_exp_f32_e64 v244, v244 clamp
    v_exp_f32_e64 v245, v245 clamp
    v_exp_f32_e64 v246, v246 clamp
    v_exp_f32_e64 v247, v247 clamp
    v_cvt_pk_bf16_f32 v148, v132, v133
    v_cvt_pk_bf16_f32 v149, v134, v135
    v_cvt_pk_bf16_f32 v150, v136, v137
    v_cvt_pk_bf16_f32 v151, v138, v139
    v_pk_add_f32 v[240:241], v[240:241], s[74:75] op_sel:[0,1] op_sel_hi:[1,1]
    v_pk_add_f32 v[242:243], v[242:243], s[74:75] op_sel:[0,1] op_sel_hi:[1,1]
    v_pk_add_f32 v[244:245], v[244:245], s[74:75] op_sel:[0,1] op_sel_hi:[1,1]
    v_pk_add_f32 v[246:247], v[246:247], s[74:75] op_sel:[0,1] op_sel_hi:[1,1]
    v_max_f32 v240, v240, v100
    v_max_f32 v241, v241, v101
    v_max_f32 v242, v242, v102
    v_max_f32 v243, v243, v103
    v_max_f32 v244, v244, v104
    v_max_f32 v245, v245, v105
    v_max_f32 v246, v246, v106
    v_max_f32 v247, v247, v107
    v_cvt_pk_bf16_f32 v140, v240, v241
    v_cvt_pk_bf16_f32 v141, v242, v243
    v_cvt_pk_bf16_f32 v142, v244, v245
    v_cvt_pk_bf16_f32 v143, v246, v247
    s_nop 1
    v_mfma_f32_32x32x16_bf16 v[172:187], v[140:143], v[152:155], v[172:187]
    v_mfma_f32_32x32x16_bf16 v[156:171], v[140:143], v[148:151], v[156:171]
    s_and_b32 s68, s62, 1
    s_lshr_b32 s67, s65, 5
    s_add_u32 s67, s67, s62
    s_lshl_b32 s67, s67, 15
    s_add_u32 s67, s67, 0x200000
    s_lshl_b32 s69, s68, 10
    s_add_u32 s100, s67, s69
    v_add_u32 v188, s100, v2
    s_sub_u32 s100, s67, s69
    s_add_u32 s100, s100, 1024
    v_add_u32 v189, s100, v2
    s_lshl_b32 s67, s62, 5
    s_add_u32 s67, s67, s65
    s_lshl_b32 s67, s67, 2
    v_and_b32 v3, 31, v1
    v_lshl_add_u32 v190, v3, 2, s67
    v_lshrrev_b32 v3, 5, v1
    v_lshl_add_u32 v190, v3, 16, v190
    v_bfe_u32 v3, v1, 2, 2
    v_lshrrev_b32 v4, 5, v1
    v_mul_u32_u24 v4, 4, v4
    v_add_u32 v3, v3, v4
    v_mul_u32_u24 v3, 256, v3
    v_bfe_u32 v4, v1, 4, 1
    v_lshl_add_u32 v3, v4, 5, v3
    v_and_b32 v4, 3, v1
    v_lshl_add_u32 v3, v4, 3, v3
    v_bfe_u32 v4, v1, 2, 2
    s_lshl_b32 s69, s68, 12
    s_sub_u32 s100, 4096, s69
    s_and_b32 s67, s91, 1
    s_add_u32 s68, s67, 0
    v_xor_b32 v5, s68, v4
    v_lshl_add_u32 v5, v5, 6, v3
    v_add_u32 v191, s69, v5
    v_add_u32 v38, s100, v5
    s_add_u32 s68, s67, 1
    v_xor_b32 v5, s68, v4
    v_lshl_add_u32 v5, v5, 6, v3
    v_add_u32 v36, s69, v5
    v_add_u32 v39, s100, v5
    s_add_u32 s68, s67, 2
    v_xor_b32 v5, s68, v4
    v_lshl_add_u32 v5, v5, 6, v3
    v_add_u32 v37, s69, v5
    v_add_u32 v40, s100, v5
    v_and_b32 v3, 16, v1
    v_cmp_eq_u32 vcc, 0, v3
    s_nop 1
    v_cndmask_b32 v156, v172, v156, vcc
    v_cndmask_b32 v157, v173, v157, vcc
    v_cndmask_b32 v158, v174, v158, vcc
    v_cndmask_b32 v159, v175, v159, vcc
    v_cndmask_b32 v160, v176, v160, vcc
    v_cndmask_b32 v161, v177, v161, vcc
    v_cndmask_b32 v162, v178, v162, vcc
    v_cndmask_b32 v163, v179, v163, vcc
    v_cndmask_b32 v164, v164, v180, vcc
    v_cndmask_b32 v165, v165, v181, vcc
    v_cndmask_b32 v166, v166, v182, vcc
    v_cndmask_b32 v167, v167, v183, vcc
    v_cndmask_b32 v168, v168, v184, vcc
    v_cndmask_b32 v169, v169, v185, vcc
    v_cndmask_b32 v170, v170, v186, vcc
    v_cndmask_b32 v171, v171, v187, vcc
    buffer_store_dwordx4 v[156:159], v205, s[36:39], 0 offen sc1
    buffer_store_dwordx4 v[160:163], v205, s[36:39], 0 offen offset:1024 sc1
    buffer_store_dwordx4 v[164:167], v205, s[36:39], 0 offen offset:2048 sc1
    buffer_store_dwordx4 v[168:171], v205, s[36:39], 0 offen offset:3072 sc1
    v_lshrrev_b32 v3, 4, v1
    v_bfe_u32 v4, v1, 1, 1
    v_lshl_add_u32 v3, v3, 1, v4
    v_cmp_eq_u32 vcc, s62, v3
    s_nop 1
    v_cndmask_b32_e64 v28, 0, 3, vcc
    buffer_load_dword v23, v22, s[36:39], 0 offen sc1
    v_and_b32 v3, 31, v1
    s_lshl_b32 s67, s62, 9
    s_add_u32 s67, s67, 36864
    v_lshl_add_u32 v7, v1, 2, s67
    v_lshlrev_b32 v41, 2, v3
    v_add_u32 v41, 36864, v41
    v_add_u32 v6, 128, v41
    s_lshl_b32 s68, s92, 1
    s_and_b32 s67, s62, 1
    s_add_u32 s68, s68, s67
    v_and_b32 v3, 3, v1
    v_cmp_eq_u32 vcc, s68, v3
    s_lshl_b32 s67, s92, 1
    s_add_u32 s67, s67, 32
    v_cndmask_b32_e64 v11, 0, 5, vcc
    v_cndmask_b32_e64 v12, 0, 6, vcc
    v_and_b32 v3, 34, v1
    v_cmp_eq_u32 vcc, s67, v3
    s_nop 1
    v_cndmask_b32_e64 v12, v12, 6, vcc
    s_lshr_b32 s67, s65, 5
    s_add_u32 s67, s67, s68
    s_lshl_b32 s0, s67, 15
    s_lshl_b32 s69, s93, 12
    s_add_u32 s0, s0, s69
    s_lshr_b32 s69, s62, 1
    s_lshl_b32 s69, s69, 11
    s_add_u32 s0, s0, s69
    s_add_u32 s0, s0, 0x200000
    s_mul_i32 s67, s67, 147456
    s_lshl_b32 s69, s69, 1
    s_add_u32 s67, s67, s69
    s_add_u32 s67, s67, 0x400000
    v_add_u32 v8, s67, v2
    s_lshl_b32 s67, s92, 2
    s_add_u32 s67, s67, s62
    s_lshl_b32 s67, s67, 4
    s_add_u32 s67, s67, s65
    s_lshl_b32 s67, s67, 10
    s_lshl_b32 s69, s93, 7
    s_add_u32 s67, s67, s69
    v_lshrrev_b32 v3, 3, v1
    v_and_b32 v4, 7, v1
    v_lshlrev_b32 v4, 4, v4
    v_lshl_add_u32 v3, v3, 10, v4
    v_add_u32 v9, s67, v3
    v_add_u32 v10, 8192, v9
    v_mov_b32 v16, s76
    v_fma_f32 v44, v44, v17, s74
    v_fma_f32 v45, v45, v17, s74
    v_fma_f32 v46, v46, v17, s74
    v_fma_f32 v47, v47, v17, s74
    v_fma_f32 v48, v48, v17, s74
    v_fma_f32 v49, v49, v17, s74
    v_fma_f32 v50, v50, v17, s74
    v_fma_f32 v51, v51, v17, s74
    v_fma_f32 v240, v44, v16, s77
    v_fma_f32 v241, v45, v16, s77
    v_fma_f32 v242, v46, v16, s77
    v_fma_f32 v243, v47, v16, s77
    v_fma_f32 v244, v48, v16, s77
    v_fma_f32 v245, v49, v16, s77
    v_fma_f32 v246, v50, v16, s77
    v_fma_f32 v247, v51, v16, s77
    v_exp_f32_e64 v240, v240 clamp
    v_exp_f32_e64 v241, v241 clamp
    v_exp_f32_e64 v242, v242 clamp
    v_exp_f32_e64 v243, v243 clamp
    v_exp_f32_e64 v244, v244 clamp
    v_exp_f32_e64 v245, v245 clamp
    v_exp_f32_e64 v246, v246 clamp
    v_exp_f32_e64 v247, v247 clamp
    v_add_f32 v240, s75, v240
    v_add_f32 v241, s75, v241
    v_add_f32 v242, s75, v242
    v_add_f32 v243, s75, v243
    v_add_f32 v244, s75, v244
    v_add_f32 v245, s75, v245
    v_add_f32 v246, s75, v246
    v_add_f32 v247, s75, v247
    v_max_f32 v240, v240, v44
    v_max_f32 v241, v241, v45
    v_max_f32 v242, v242, v46
    v_max_f32 v243, v243, v47
    v_max_f32 v244, v244, v48
    v_max_f32 v245, v245, v49
    v_max_f32 v246, v246, v50
    v_max_f32 v247, v247, v51
    v_cvt_pk_bf16_f32 v224, v240, v241
    v_cvt_pk_bf16_f32 v225, v242, v243
    v_cvt_pk_bf16_f32 v226, v244, v245
    v_cvt_pk_bf16_f32 v227, v246, v247
    v_fma_f32 v52, v52, v17, s74
    v_fma_f32 v53, v53, v17, s74
    v_fma_f32 v54, v54, v17, s74
    v_fma_f32 v55, v55, v17, s74
    v_fma_f32 v56, v56, v17, s74
    v_fma_f32 v57, v57, v17, s74
    v_fma_f32 v58, v58, v17, s74
    v_fma_f32 v59, v59, v17, s74
    v_fma_f32 v240, v52, v16, s77
    v_fma_f32 v241, v53, v16, s77
    v_fma_f32 v242, v54, v16, s77
    v_fma_f32 v243, v55, v16, s77
    v_fma_f32 v244, v56, v16, s77
    v_fma_f32 v245, v57, v16, s77
    v_fma_f32 v246, v58, v16, s77
    v_fma_f32 v247, v59, v16, s77
    v_exp_f32_e64 v240, v240 clamp
    v_exp_f32_e64 v241, v241 clamp
    v_exp_f32_e64 v242, v242 clamp
    v_exp_f32_e64 v243, v243 clamp
    v_exp_f32_e64 v244, v244 clamp
    v_exp_f32_e64 v245, v245 clamp
    v_exp_f32_e64 v246, v246 clamp
    v_exp_f32_e64 v247, v247 clamp
    v_add_f32 v240, s75, v240
    v_add_f32 v241, s75, v241
    v_add_f32 v242, s75, v242
    v_add_f32 v243, s75, v243
    v_add_f32 v244, s75, v244
    v_add_f32 v245, s75, v245
    v_add_f32 v246, s75, v246
    v_add_f32 v247, s75, v247
    v_max_f32 v240, v240, v52
    v_max_f32 v241, v241, v53
    v_max_f32 v242, v242, v54
    v_max_f32 v243, v243, v55
    v_max_f32 v244, v244, v56
    v_max_f32 v245, v245, v57
    v_max_f32 v246, v246, v58
    v_max_f32 v247, v247, v59
    v_cvt_pk_bf16_f32 v228, v240, v241
    v_cvt_pk_bf16_f32 v229, v242, v243
    v_cvt_pk_bf16_f32 v230, v244, v245
    v_cvt_pk_bf16_f32 v231, v246, v247
    s_waitcnt vmcnt(0)
    v_subrev_u32 v23, s101, v23
    v_cmp_gt_u32 vcc, 8, v23
    s_nop 1
    v_cndmask_b32 v23, 0, v23, vcc
    s_cmp_eq_u64 vcc, -1
    s_cselect_b32 s1, 1, s1
    v_cmp_lt_u32 vcc, v23, v28
    s_nop 1
    s_cbranch_vccnz L_slow_30
L_back_31:
    s_mov_b32 s70, 0x0
    buffer_load_dwordx4 a[0:3], v188, s[36:39], s70 offen sc1
    buffer_load_dwordx4 a[4:7], v189, s[36:39], s70 offen sc1
    buffer_load_dwordx4 a[8:11], v188, s[36:39], s70 offen offset:2048 sc1
    buffer_load_dwordx4 a[12:15], v189, s[36:39], s70 offen offset:2048 sc1
    s_mov_b32 s70, 0x1000
    buffer_load_dwordx4 a[16:19], v188, s[36:39], s70 offen sc1
    buffer_load_dwordx4 a[20:23], v189, s[36:39], s70 offen sc1
    buffer_load_dwordx4 a[24:27], v188, s[36:39], s70 offen offset:2048 sc1
    buffer_load_dwordx4 a[28:31], v189, s[36:39], s70 offen offset:2048 sc1
    s_barrier
    ds_read_b64_tr_b16 v[116:117], v191
    ds_read_b64_tr_b16 v[118:119], v191 offset:2048
    ds_read_b64_tr_b16 v[120:121], v36
    ds_read_b64_tr_b16 v[122:123], v36 offset:2048
    ds_read_b64_tr_b16 v[124:125], v38
    ds_read_b64_tr_b16 v[126:127], v38 offset:2048
    ds_read_b64_tr_b16 v[128:129], v39
    ds_read_b64_tr_b16 v[130:131], v39 offset:2048
    s_waitcnt vmcnt(4) lgkmcnt(6)
    v_mfma_f32_32x32x16_bf16 v[84:99], v[116:119], a[0:3], 0
    ds_read_b64_tr_b16 v[132:133], v191 offset:8192
    ds_read_b64_tr_b16 v[134:135], v191 offset:10240
    ds_read_b64_tr_b16 v[136:137], v36 offset:8192
    s_add_u32 s67, s66, 1
    v_mov_b32 v29, s67
    buffer_store_dword v29, v207, s[36:39], 0 offen sc1
    v_fma_f32 v60, v60, v19, s74
    v_fma_f32 v61, v61, v19, s74
    v_mfma_f32_16x16x32_bf16 v[248:251], v[24:27], v[116:119], 0
    s_waitcnt lgkmcnt(7)
    v_mfma_f32_32x32x16_bf16 v[100:115], v[120:123], a[0:3], 0
    ds_read_b64_tr_b16 v[138:139], v36 offset:10240
    ds_read_b64_tr_b16 v[140:141], v38 offset:8192
    ds_read_b64_tr_b16 v[142:143], v38 offset:10240
    s_mov_b32 s70, 0x2000
    buffer_load_dwordx4 a[32:35], v188, s[36:39], s70 offen sc1
    v_fma_f32 v62, v62, v19, s74
    v_fma_f32 v63, v63, v19, s74
    v_fma_f32 v64, v64, v19, s74
    v_mfma_f32_16x16x32_bf16 v[200:203], v[24:27], v[120:123], 0
    s_waitcnt lgkmcnt(8)
    v_mfma_f32_32x32x16_bf16 v[84:99], v[124:127], a[4:7], v[84:99]
    ds_read_b64_tr_b16 v[144:145], v39 offset:8192
    ds_read_b64_tr_b16 v[146:147], v39 offset:10240
    buffer_load_dwordx4 a[36:39], v189, s[36:39], s70 offen sc1
    v_fma_f32 v65, v65, v19, s74
    v_fma_f32 v66, v66, v19, s74
    v_fma_f32 v67, v67, v19, s74
    v_fma_f32 v240, v60, v16, s77
    v_fma_f32 v241, v61, v16, s77
    s_waitcnt lgkmcnt(8)
    v_mfma_f32_32x32x16_bf16 v[100:115], v[128:131], a[4:7], v[100:115]
    buffer_load_dwordx4 a[40:43], v188, s[36:39], s70 offen offset:2048 sc1
    v_fma_f32 v242, v62, v16, s77
    v_fma_f32 v243, v63, v16, s77
    v_fma_f32 v244, v64, v16, s77
    v_fma_f32 v245, v65, v16, s77
    v_fma_f32 v246, v66, v16, s77
    v_fma_f32 v247, v67, v16, s77
    v_exp_f32_e64 v240, v240 clamp
    s_barrier
    s_waitcnt lgkmcnt(6)
    v_mfma_f32_32x32x16_bf16 v[84:99], v[132:135], a[8:11], v[84:99]
    ds_read_b64_tr_b16 v[116:117], v191 offset:16384
    ds_read_b64_tr_b16 v[118:119], v191 offset:18432
    ds_read_b64_tr_b16 v[120:121], v36 offset:16384
    buffer_load_dwordx4 a[44:47], v189, s[36:39], s70 offen offset:2048 sc1
    v_exp_f32_e64 v241, v241 clamp
    v_exp_f32_e64 v242, v242 clamp
    v_mfma_f32_16x16x32_bf16 v[248:251], v[24:27], v[132:135], v[248:251]
    s_waitcnt lgkmcnt(7)
    v_mfma_f32_32x32x16_bf16 v[100:115], v[136:139], a[8:11], v[100:115]
    ds_read_b64_tr_b16 v[122:123], v36 offset:18432
    ds_read_b64_tr_b16 v[124:125], v38 offset:16384
    ds_read_b64_tr_b16 v[126:127], v38 offset:18432
    s_mov_b32 s70, 0x3000
    buffer_load_dwordx4 a[48:51], v188, s[36:39], s70 offen sc1
    v_exp_f32_e64 v243, v243 clamp
    v_mfma_f32_16x16x32_bf16 v[200:203], v[24:27], v[136:139], v[200:203]
    s_waitcnt lgkmcnt(8)
    v_mfma_f32_32x32x16_bf16 v[84:99], v[140:143], a[12:15], v[84:99]
    ds_read_b64_tr_b16 v[128:129], v39 offset:16384
    ds_read_b64_tr_b16 v[130:131], v39 offset:18432
    buffer_load_dwordx4 a[52:55], v189, s[36:39], s70 offen sc1
    v_exp_f32_e64 v244, v244 clamp
    v_exp_f32_e64 v245, v245 clamp
    v_exp_f32_e64 v246, v246 clamp
    s_waitcnt lgkmcnt(8)
    v_mfma_f32_32x32x16_bf16 v[100:115], v[144:147], a[12:15], v[100:115]
    buffer_load_dwordx4 a[56:59], v188, s[36:39], s70 offen offset:2048 sc1
    v_exp_f32_e64 v247, v247 clamp
    v_add_f32 v240, s75, v240
    v_add_f32 v241, s75, v241
    v_add_f32 v242, s75, v242
    v_add_f32 v243, s75, v243
    s_barrier
    s_waitcnt vmcnt(8) lgkmcnt(6)
    v_mfma_f32_32x32x16_bf16 v[84:99], v[116:119], a[16:19], v[84:99]
    ds_read_b64_tr_b16 v[132:133], v191 offset:24576
    ds_read_b64_tr_b16 v[134:135], v191 offset:26624
    ds_read_b64_tr_b16 v[136:137], v36 offset:24576
    buffer_load_dwordx4 a[60:63], v189, s[36:39], s70 offen offset:2048 sc1
    v_add_f32 v244, s75, v244
    v_add_f32 v245, s75, v245
    v_add_f32 v246, s75, v246
    v_add_f32 v247, s75, v247
    v_mfma_f32_16x16x32_bf16 v[248:251], v[24:27], v[116:119], v[248:251]
    s_waitcnt lgkmcnt(7)
    v_mfma_f32_32x32x16_bf16 v[100:115], v[120:123], a[16:19], v[100:115]
    ds_read_b64_tr_b16 v[138:139], v36 offset:26624
    ds_read_b64_tr_b16 v[140:141], v38 offset:24576
    ds_read_b64_tr_b16 v[142:143], v38 offset:26624
    s_mov_b32 s70, 0x4000
    buffer_load_dwordx4 a[64:67], v188, s[36:39], s70 offen sc1
    v_max_f32 v240, v240, v60
    v_max_f32 v241, v241, v61
    v_max_f32 v242, v242, v62
    v_mfma_f32_16x16x32_bf16 v[200:203], v[24:27], v[120:123], v[200:203]
    s_waitcnt lgkmcnt(8)
    v_mfma_f32_32x32x16_bf16 v[84:99], v[124:127], a[20:23], v[84:99]
    ds_read_b64_tr_b16 v[144:145], v39 offset:24576
    ds_read_b64_tr_b16 v[146:147], v39 offset:26624
    buffer_load_dwordx4 a[68:71], v189, s[36:39], s70 offen sc1
    v_max_f32 v243, v243, v63
    v_max_f32 v244, v244, v64
    v_max_f32 v245, v245, v65
    v_max_f32 v246, v246, v66
    v_max_f32 v247, v247, v67
    s_waitcnt lgkmcnt(8)
    v_mfma_f32_32x32x16_bf16 v[100:115], v[128:131], a[20:23], v[100:115]
    buffer_load_dwordx4 a[72:75], v188, s[36:39], s70 offen offset:2048 sc1
    v_cvt_pk_bf16_f32 v232, v240, v241
    v_cvt_pk_bf16_f32 v233, v242, v243
    v_cvt_pk_bf16_f32 v234, v244, v245
    v_cvt_pk_bf16_f32 v235, v246, v247
    v_fma_f32 v68, v68, v19, s74
    v_fma_f32 v69, v69, v19, s74
    v_fma_f32 v70, v70, v19, s74
    s_waitcnt lgkmcnt(6)
    v_mfma_f32_32x32x16_bf16 v[84:99], v[132:135], a[24:27], v[84:99]
    ds_read_b64_tr_b16 v[116:117], v191 offset:49152
    ds_read_b64_tr_b16 v[118:119], v191 offset:51200
    ds_read_b64_tr_b16 v[120:121], v36 offset:49152
    buffer_load_dwordx4 a[76:79], v189, s[36:39], s70 offen offset:2048 sc1
    v_fma_f32 v71, v71, v19, s74
    v_fma_f32 v72, v72, v19, s74
    v_fma_f32 v73, v73, v19, s74
    v_fma_f32 v74, v74, v19, s74
    v_mfma_f32_16x16x32_bf16 v[248:251], v[24:27], v[132:135], v[248:251]
    s_waitcnt lgkmcnt(7)
    v_mfma_f32_32x32x16_bf16 v[100:115], v[136:139], a[24:27], v[100:115]
    ds_read_b64_tr_b16 v[122:123], v36 offset:51200
    ds_read_b64_tr_b16 v[124:125], v38 offset:49152
    ds_read_b64_tr_b16 v[126:127], v38 offset:51200
    s_mov_b32 s70, 0x5000
    buffer_load_dwordx4 a[80:83], v188, s[36:39], s70 offen sc1
    v_fma_f32 v75, v75, v19, s74
    v_fma_f32 v240, v68, v16, s77
    v_fma_f32 v241, v69, v16, s77
    v_mfma_f32_16x16x32_bf16 v[200:203], v[24:27], v[136:139], v[200:203]
    s_waitcnt lgkmcnt(8)
    v_mfma_f32_32x32x16_bf16 v[84:99], v[140:143], a[28:31], v[84:99]
    ds_read_b64_tr_b16 v[128:129], v39 offset:49152
    ds_read_b64_tr_b16 v[130:131], v39 offset:51200
    buffer_load_dwordx4 a[84:87], v189, s[36:39], s70 offen sc1
    v_fma_f32 v242, v70, v16, s77
    v_fma_f32 v243, v71, v16, s77
    v_fma_f32 v244, v72, v16, s77
    v_fma_f32 v245, v73, v16, s77
    v_fma_f32 v246, v74, v16, s77
    s_waitcnt lgkmcnt(8)
    v_mfma_f32_32x32x16_bf16 v[100:115], v[144:147], a[28:31], v[100:115]
    buffer_load_dwordx4 a[88:91], v188, s[36:39], s70 offen offset:2048 sc1
    v_fma_f32 v247, v75, v16, s77
    v_exp_f32_e64 v240, v240 clamp
    v_exp_f32_e64 v241, v241 clamp
    v_exp_f32_e64 v242, v242 clamp
    s_barrier
    s_waitcnt vmcnt(11) lgkmcnt(6)
    v_mfma_f32_32x32x16_bf16 v[84:99], v[116:119], a[32:35], v[84:99]
    ds_read_b64_tr_b16 v[132:133], v191 offset:57344
    ds_read_b64_tr_b16 v[134:135], v191 offset:59392
    ds_read_b64_tr_b16 v[136:137], v36 offset:57344
    buffer_load_dwordx4 a[92:95], v189, s[36:39], s70 offen offset:2048 sc1
    v_exp_f32_e64 v243, v243 clamp
    v_exp_f32_e64 v244, v244 clamp
    v_mfma_f32_16x16x32_bf16 v[248:251], v[24:27], v[116:119], v[248:251]
    s_waitcnt lgkmcnt(7)
    v_mfma_f32_32x32x16_bf16 v[100:115], v[120:123], a[32:35], v[100:115]
    ds_read_b64_tr_b16 v[138:139], v36 offset:59392
    ds_read_b64_tr_b16 v[140:141], v38 offset:57344
    ds_read_b64_tr_b16 v[142:143], v38 offset:59392
    s_mov_b32 s70, 0x6000
    buffer_load_dwordx4 a[96:99], v188, s[36:39], s70 offen sc1
    v_exp_f32_e64 v245, v245 clamp
    v_exp_f32_e64 v246, v246 clamp
    v_mfma_f32_16x16x32_bf16 v[200:203], v[24:27], v[120:123], v[200:203]
    s_waitcnt lgkmcnt(8)
    v_mfma_f32_32x32x16_bf16 v[84:99], v[124:127], a[36:39], v[84:99]
    ds_read_b64_tr_b16 v[144:145], v39 offset:57344
    ds_read_b64_tr_b16 v[146:147], v39 offset:59392
    v_add_u32 v191, 0x10000, v191
    v_add_u32 v36, 0x10000, v36
    v_add_u32 v37, 0x10000, v37
    v_add_u32 v38, 0x10000, v38
    v_add_u32 v39, 0x10000, v39
    v_add_u32 v40, 0x10000, v40
    s_waitcnt lgkmcnt(8)
    v_mfma_f32_32x32x16_bf16 v[100:115], v[128:131], a[36:39], v[100:115]
    buffer_load_dwordx4 a[100:103], v189, s[36:39], s70 offen sc1
    v_exp_f32_e64 v247, v247 clamp
    v_add_f32 v240, s75, v240
    v_add_f32 v241, s75, v241
    v_add_f32 v242, s75, v242
    v_add_f32 v243, s75, v243
    s_waitcnt lgkmcnt(6)
    v_mfma_f32_32x32x16_bf16 v[84:99], v[132:135], a[40:43], v[84:99]
    ds_read_b64_tr_b16 v[116:117], v191
    ds_read_b64_tr_b16 v[118:119], v191 offset:2048
    ds_read_b64_tr_b16 v[120:121], v36
    buffer_load_dwordx4 a[104:107], v188, s[36:39], s70 offen offset:2048 sc1
    v_add_f32 v244, s75, v244
    v_add_f32 v245, s75, v245
    v_add_f32 v246, s75, v246
    v_add_f32 v247, s75, v247
    v_mfma_f32_16x16x32_bf16 v[248:251], v[24:27], v[132:135], v[248:251]
    s_waitcnt lgkmcnt(7)
    v_mfma_f32_32x32x16_bf16 v[100:115], v[136:139], a[40:43], v[100:115]
    ds_read_b64_tr_b16 v[122:123], v36 offset:2048
    ds_read_b64_tr_b16 v[124:125], v38
    ds_read_b64_tr_b16 v[126:127], v38 offset:2048
    buffer_load_dwordx4 a[108:111], v189, s[36:39], s70 offen offset:2048 sc1
    v_max_f32 v240, v240, v68
    v_max_f32 v241, v241, v69
    v_max_f32 v242, v242, v70
    v_max_f32 v243, v243, v71
    v_mfma_f32_16x16x32_bf16 v[200:203], v[24:27], v[136:139], v[200:203]
    s_waitcnt lgkmcnt(8)
    v_mfma_f32_32x32x16_bf16 v[84:99], v[140:143], a[44:47], v[84:99]
    ds_read_b64_tr_b16 v[128:129], v39
    ds_read_b64_tr_b16 v[130:131], v39 offset:2048
    buffer_load_dword v223, v206, s[36:39], 0 offen sc1
    v_max_f32 v244, v244, v72
    v_max_f32 v245, v245, v73
    v_max_f32 v246, v246, v74
    v_max_f32 v247, v247, v75
    v_cvt_pk_bf16_f32 v236, v240, v241
    s_waitcnt lgkmcnt(8)
    v_mfma_f32_32x32x16_bf16 v[100:115], v[144:147], a[44:47], v[100:115]
    v_cvt_pk_bf16_f32 v237, v242, v243
    v_cvt_pk_bf16_f32 v238, v244, v245
    v_cvt_pk_bf16_f32 v239, v246, v247
    s_barrier
    s_waitcnt vmcnt(13) lgkmcnt(6)
    v_mfma_f32_32x32x16_bf16 v[84:99], v[116:119], a[48:51], v[84:99]
    ds_read_b64_tr_b16 v[132:133], v191 offset:8192
    ds_read_b64_tr_b16 v[134:135], v191 offset:10240
    ds_read_b64_tr_b16 v[136:137], v36 offset:8192
    s_mov_b32 s70, 0x7000
    buffer_load_dwordx4 a[112:115], v188, s[36:39], s70 offen sc1
    v_mfma_f32_16x16x32_bf16 v[248:251], v[24:27], v[116:119], v[248:251]
    s_waitcnt lgkmcnt(7)
    v_mfma_f32_32x32x16_bf16 v[100:115], v[120:123], a[48:51], v[100:115]
    ds_read_b64_tr_b16 v[138:139], v36 offset:10240
    ds_read_b64_tr_b16 v[140:141], v38 offset:8192
    ds_read_b64_tr_b16 v[142:143], v38 offset:10240
    buffer_load_dwordx4 a[116:119], v189, s[36:39], s70 offen sc1
    v_mfma_f32_16x16x32_bf16 v[200:203], v[24:27], v[120:123], v[200:203]
    s_waitcnt lgkmcnt(8)
    v_mfma_f32_32x32x16_bf16 v[84:99], v[124:127], a[52:55], v[84:99]
    ds_read_b64_tr_b16 v[144:145], v39 offset:8192
    ds_read_b64_tr_b16 v[146:147], v39 offset:10240
    buffer_load_dwordx4 a[120:123], v188, s[36:39], s70 offen offset:2048 sc1
    s_waitcnt lgkmcnt(8)
    v_mfma_f32_32x32x16_bf16 v[100:115], v[128:131], a[52:55], v[100:115]
    buffer_load_dwordx4 a[124:127], v189, s[36:39], s70 offen offset:2048 sc1
    s_waitcnt lgkmcnt(6)
    v_mfma_f32_32x32x16_bf16 v[84:99], v[132:135], a[56:59], v[84:99]
    ds_read_b64_tr_b16 v[116:117], v191 offset:16384
    ds_read_b64_tr_b16 v[118:119], v191 offset:18432
    ds_read_b64_tr_b16 v[120:121], v36 offset:16384
    v_mfma_f32_16x16x32_bf16 v[248:251], v[24:27], v[132:135], v[248:251]
    s_waitcnt lgkmcnt(7)
    v_mfma_f32_32x32x16_bf16 v[100:115], v[136:139], a[56:59], v[100:115]
    ds_read_b64_tr_b16 v[122:123], v36 offset:18432
    ds_read_b64_tr_b16 v[124:125], v38 offset:16384
    ds_read_b64_tr_b16 v[126:127], v38 offset:18432
    v_mfma_f32_16x16x32_bf16 v[200:203], v[24:27], v[136:139], v[200:203]
    s_waitcnt lgkmcnt(8)
    v_mfma_f32_32x32x16_bf16 v[84:99], v[140:143], a[60:63], v[84:99]
    ds_read_b64_tr_b16 v[128:129], v39 offset:16384
    ds_read_b64_tr_b16 v[130:131], v39 offset:18432
    s_waitcnt lgkmcnt(8)
    v_mfma_f32_32x32x16_bf16 v[100:115], v[144:147], a[60:63], v[100:115]
    s_barrier
    s_waitcnt vmcnt(13) lgkmcnt(6)
    v_mfma_f32_32x32x16_bf16 v[84:99], v[116:119], a[64:67], v[84:99]
    ds_read_b64_tr_b16 v[132:133], v191 offset:24576
    ds_read_b64_tr_b16 v[134:135], v191 offset:26624
    ds_read_b64_tr_b16 v[136:137], v36 offset:24576
    s_mov_b32 s70, 15859712
    buffer_load_dword v76, v190, s[36:39], s70 offen sc1
    v_mfma_f32_16x16x32_bf16 v[248:251], v[24:27], v[116:119], v[248:251]
    s_waitcnt lgkmcnt(7)
    v_mfma_f32_32x32x16_bf16 v[100:115], v[120:123], a[64:67], v[100:115]
    ds_read_b64_tr_b16 v[138:139], v36 offset:26624
    ds_read_b64_tr_b16 v[140:141], v38 offset:24576
    ds_read_b64_tr_b16 v[142:143], v38 offset:26624
    s_mov_b32 s70, 15867904
    buffer_load_dword v77, v190, s[36:39], s70 offen sc1
    v_mfma_f32_16x16x32_bf16 v[200:203], v[24:27], v[120:123], v[200:203]
    s_waitcnt lgkmcnt(8)
    v_mfma_f32_32x32x16_bf16 v[84:99], v[124:127], a[68:71], v[84:99]
    ds_read_b64_tr_b16 v[144:145], v39 offset:24576
    ds_read_b64_tr_b16 v[146:147], v39 offset:26624
    s_mov_b32 s70, 15876096
    buffer_load_dword v78, v190, s[36:39], s70 offen sc1
    s_waitcnt lgkmcnt(8)
    v_mfma_f32_32x32x16_bf16 v[100:115], v[128:131], a[68:71], v[100:115]
    s_mov_b32 s70, 15884288
    buffer_load_dword v79, v190, s[36:39], s70 offen sc1
    s_waitcnt lgkmcnt(6)
    v_mfma_f32_32x32x16_bf16 v[84:99], v[132:135], a[72:75], v[84:99]
    ds_read_b64_tr_b16 v[116:117], v191 offset:32768
    ds_read_b64_tr_b16 v[118:119], v191 offset:34816
    ds_read_b64_tr_b16 v[120:121], v36 offset:32768
    s_mov_b32 s70, 15892480
    buffer_load_dword v80, v190, s[36:39], s70 offen sc1
    v_mfma_f32_16x16x32_bf16 v[248:251], v[24:27], v[132:135], v[248:251]
    s_waitcnt lgkmcnt(7)
    v_mfma_f32_32x32x16_bf16 v[100:115], v[136:139], a[72:75], v[100:115]
    ds_read_b64_tr_b16 v[122:123], v36 offset:34816
    ds_read_b64_tr_b16 v[124:125], v38 offset:32768
    ds_read_b64_tr_b16 v[126:127], v38 offset:34816
    s_mov_b32 s70, 15900672
    buffer_load_dword v81, v190, s[36:39], s70 offen sc1
    v_mfma_f32_16x16x32_bf16 v[200:203], v[24:27], v[136:139], v[200:203]
    s_waitcnt lgkmcnt(8)
    v_mfma_f32_32x32x16_bf16 v[84:99], v[140:143], a[76:79], v[84:99]
    ds_read_b64_tr_b16 v[128:129], v39 offset:32768
    ds_read_b64_tr_b16 v[130:131], v39 offset:34816
    s_mov_b32 s70, 15908864
    buffer_load_dword v82, v190, s[36:39], s70 offen sc1
    s_waitcnt lgkmcnt(8)
    v_mfma_f32_32x32x16_bf16 v[100:115], v[144:147], a[76:79], v[100:115]
    s_mov_b32 s70, 15917056
    buffer_load_dword v83, v190, s[36:39], s70 offen sc1
    s_waitcnt vmcnt(12)
    v_subrev_u32 v223, s66, v223
    v_cmp_gt_u32 vcc, 8, v223
    s_nop 1
    v_cndmask_b32 v223, 0, v223, vcc
    v_cmp_lt_u32 vcc, v223, v15
    s_nop 1
    s_cbranch_vccnz L_slow_33
L_back_34:
    s_barrier
    s_waitcnt lgkmcnt(6)
    v_mfma_f32_32x32x16_bf16 v[84:99], v[116:119], a[80:83], v[84:99]
    ds_read_b64_tr_b16 v[132:133], v191 offset:40960
    ds_read_b64_tr_b16 v[134:135], v191 offset:43008
    ds_read_b64_tr_b16 v[136:137], v36 offset:40960
    buffer_load_dwordx4 v[208:211], v252, s[36:39], 0 offen sc1
    v_mfma_f32_16x16x32_bf16 v[248:251], v[24:27], v[116:119], v[248:251]
    s_waitcnt lgkmcnt(7)
    v_mfma_f32_32x32x16_bf16 v[100:115], v[120:123], a[80:83], v[100:115]
    ds_read_b64_tr_b16 v[138:139], v36 offset:43008
    ds_read_b64_tr_b16 v[140:141], v38 offset:40960
    ds_read_b64_tr_b16 v[142:143], v38 offset:43008
    buffer_load_dwordx4 v[212:215], v252, s[36:39], 0 offen offset:1024 sc1
    v_mfma_f32_16x16x32_bf16 v[200:203], v[24:27], v[120:123], v[200:203]
    s_waitcnt lgkmcnt(8)
    v_mfma_f32_32x32x16_bf16 v[84:99], v[124:127], a[84:87], v[84:99]
    ds_read_b64_tr_b16 v[144:145], v39 offset:40960
    ds_read_b64_tr_b16 v[146:147], v39 offset:43008
    v_add_u32 v191, 0x10000, v191
    v_add_u32 v36, 0x10000, v36
    v_add_u32 v37, 0x10000, v37
    v_add_u32 v38, 0x10000, v38
    v_add_u32 v39, 0x10000, v39
    v_add_u32 v40, 0x10000, v40
    s_waitcnt lgkmcnt(8)
    v_mfma_f32_32x32x16_bf16 v[100:115], v[128:131], a[84:87], v[100:115]
    s_mov_b32 s70, 65536
    buffer_load_dwordx4 v[216:219], v252, s[36:39], s70 offen sc1
    s_waitcnt lgkmcnt(6)
    v_mfma_f32_32x32x16_bf16 v[84:99], v[132:135], a[88:91], v[84:99]
    ds_read_b64_tr_b16 v[116:117], v191
    ds_read_b64_tr_b16 v[118:119], v191 offset:2048
    ds_read_b64_tr_b16 v[120:121], v36
    buffer_load_dwordx4 v[220:223], v252, s[36:39], s70 offen offset:1024 sc1
    v_mfma_f32_16x16x32_bf16 v[248:251], v[24:27], v[132:135], v[248:251]
    s_waitcnt lgkmcnt(7)
    v_mfma_f32_32x32x16_bf16 v[100:115], v[136:139], a[88:91], v[100:115]
    ds_read_b64_tr_b16 v[122:123], v36 offset:2048
    ds_read_b64_tr_b16 v[124:125], v38
    ds_read_b64_tr_b16 v[126:127], v38 offset:2048
    v_mfma_f32_16x16x32_bf16 v[200:203], v[24:27], v[136:139], v[200:203]
    s_waitcnt lgkmcnt(8)
    v_mfma_f32_32x32x16_bf16 v[84:99], v[140:143], a[92:95], v[84:99]
    ds_read_b64_tr_b16 v[128:129], v39
    ds_read_b64_tr_b16 v[130:131], v39 offset:2048
    s_waitcnt lgkmcnt(8)
    v_mfma_f32_32x32x16_bf16 v[100:115], v[144:147], a[92:95], v[100:115]
    s_barrier
    s_waitcnt lgkmcnt(6)
    v_mfma_f32_32x32x16_bf16 v[84:99], v[116:119], a[96:99], v[84:99]
    ds_read_b64_tr_b16 v[132:133], v191 offset:8192
    ds_read_b64_tr_b16 v[134:135], v191 offset:10240
    ds_read_b64_tr_b16 v[136:137], v36 offset:8192
    s_add_u32 m0, s3, 114688
    s_add_u32 s71, s79, 0x0
    buffer_load_dwordx4 v35, s[20:23], s71 offen lds
    v_mfma_f32_16x16x32_bf16 v[248:251], v[24:27], v[116:119], v[248:251]
    s_waitcnt lgkmcnt(7)
    v_mfma_f32_32x32x16_bf16 v[100:115], v[120:123], a[96:99], v[100:115]
    ds_read_b64_tr_b16 v[138:139], v36 offset:10240
    ds_read_b64_tr_b16 v[140:141], v38 offset:8192
    ds_read_b64_tr_b16 v[142:143], v38 offset:10240
    buffer_load_dwordx4 v192, s[20:23], s71 offen offset:1024 lds
    v_mfma_f32_16x16x32_bf16 v[200:203], v[24:27], v[120:123], v[200:203]
    s_waitcnt lgkmcnt(8)
    v_mfma_f32_32x32x16_bf16 v[84:99], v[124:127], a[100:103], v[84:99]
    ds_read_b64_tr_b16 v[144:145], v39 offset:8192
    ds_read_b64_tr_b16 v[146:147], v39 offset:10240
    buffer_load_dwordx4 v193, s[20:23], s71 offen offset:2048 lds
    s_waitcnt lgkmcnt(8)
    v_mfma_f32_32x32x16_bf16 v[100:115], v[128:131], a[100:103], v[100:115]
    buffer_load_dwordx4 v194, s[20:23], s71 offen offset:3072 lds
    s_waitcnt vmcnt(8)
    v_add_f32 v76, v76, v80
    v_add_f32 v77, v77, v81
    v_add_f32 v78, v78, v82
    v_add_f32 v79, v79, v83
    v_add_f32 v76, v76, v78
    v_add_f32 v77, v77, v79
    s_waitcnt lgkmcnt(6)
    v_mfma_f32_32x32x16_bf16 v[84:99], v[132:135], a[104:107], v[84:99]
    ds_read_b64_tr_b16 v[116:117], v191 offset:16384
    ds_read_b64_tr_b16 v[118:119], v191 offset:18432
    ds_read_b64_tr_b16 v[120:121], v36 offset:16384
    v_add_f32 v76, v76, v77
    v_mov_b32 v77, v76
    s_nop 1
    v_permlane32_swap_b32 v76, v77
    v_mul_f32 v78, 0x3b000000, v76
    v_mul_f32 v79, 0x3b000000, v77
    v_mfma_f32_16x16x32_bf16 v[248:251], v[24:27], v[132:135], v[248:251]
    s_waitcnt lgkmcnt(7)
    v_mfma_f32_32x32x16_bf16 v[100:115], v[136:139], a[104:107], v[100:115]
    ds_read_b64_tr_b16 v[122:123], v36 offset:18432
    ds_read_b64_tr_b16 v[124:125], v38 offset:16384
    ds_read_b64_tr_b16 v[126:127], v38 offset:18432
    v_fma_f32 v79, -v78, v78, v79
    v_max_f32 v79, 0, v79
    v_add_f32 v80, 0x3727c5ac, v79
    v_rsq_f32 v80, v80
    s_nop 0
    v_mul_f32 v152, 0xc0135761, v80
    v_mfma_f32_16x16x32_bf16 v[200:203], v[24:27], v[136:139], v[200:203]
    s_waitcnt lgkmcnt(8)
    v_mfma_f32_32x32x16_bf16 v[84:99], v[140:143], a[108:111], v[84:99]
    ds_read_b64_tr_b16 v[128:129], v39 offset:16384
    ds_read_b64_tr_b16 v[130:131], v39 offset:18432
    v_mul_f32 v81, v80, v80
    v_mul_f32 v81, v81, v80
    v_mul_f32 v153, 0xbdd2d3e8, v81
    v_sub_f32 v154, 0, v78
    v_rcp_f32 v155, v80
    s_waitcnt lgkmcnt(8)
    v_mfma_f32_32x32x16_bf16 v[100:115], v[144:147], a[108:111], v[100:115]
    v_and_b32 v81, 0xffff0000, v154
    v_cvt_pk_bf16_f32 v156, v81, v81
    v_sub_f32 v81, v154, v81
    v_cvt_pk_bf16_f32 v157, v81, 0
    v_mov_b32 v158, 0
    v_mov_b32 v159, 0
    v_mov_b32 v162, 0
    v_mov_b32 v163, 0
    s_waitcnt lgkmcnt(6)
    v_mfma_f32_32x32x16_bf16 v[84:99], v[116:119], a[112:115], v[84:99]
    ds_read_b64_tr_b16 v[132:133], v191 offset:24576
    ds_read_b64_tr_b16 v[134:135], v191 offset:26624
    ds_read_b64_tr_b16 v[136:137], v36 offset:24576
    v_mov_b32 v166, 0
    v_mov_b32 v167, 0
    s_waitcnt vmcnt(4)
    v_add_f32 v208, v208, v216
    v_add_f32 v209, v209, v217
    v_mfma_f32_16x16x32_bf16 v[248:251], v[24:27], v[116:119], v[248:251]
    s_waitcnt lgkmcnt(7)
    v_mfma_f32_32x32x16_bf16 v[100:115], v[120:123], a[112:115], v[100:115]
    ds_read_b64_tr_b16 v[138:139], v36 offset:26624
    ds_read_b64_tr_b16 v[140:141], v38 offset:24576
    ds_read_b64_tr_b16 v[142:143], v38 offset:26624
    v_add_f32 v210, v210, v218
    v_add_f32 v211, v211, v219
    v_add_f32 v212, v212, v220
    v_add_f32 v213, v213, v221
    v_add_f32 v214, v214, v222
    v_mfma_f32_16x16x32_bf16 v[200:203], v[24:27], v[120:123], v[200:203]
    s_waitcnt lgkmcnt(8)
    v_mfma_f32_32x32x16_bf16 v[84:99], v[124:127], a[116:119], v[84:99]
    ds_read_b64_tr_b16 v[144:145], v39 offset:24576
    ds_read_b64_tr_b16 v[146:147], v39 offset:26624
    v_add_f32 v215, v215, v223
    v_permlane32_swap_b32 v208, v212
    v_permlane32_swap_b32 v209, v213
    v_permlane32_swap_b32 v210, v214
    v_permlane32_swap_b32 v211, v215
    v_add_f32 v208, v208, v212
    s_waitcnt lgkmcnt(8)
    v_mfma_f32_32x32x16_bf16 v[100:115], v[128:131], a[116:119], v[100:115]
    v_add_f32 v209, v209, v213
    v_add_f32 v210, v210, v214
    v_add_f32 v211, v211, v215
    s_nop 0
    v_permlane16_swap_b32 v208, v210
    v_permlane16_swap_b32 v209, v211
    v_add_f32 v208, v208, v210
    v_add_f32 v209, v209, v211
    s_nop 0
    v_add_f32_dpp v208, v208, v208 row_ror:4 row_mask:0xf bank_mask:0xf
    s_waitcnt lgkmcnt(6)
    v_mfma_f32_32x32x16_bf16 v[84:99], v[132:135], a[120:123], v[84:99]
    v_add_f32_dpp v209, v209, v209 row_ror:4 row_mask:0xf bank_mask:0xf
    v_add_f32_dpp v208, v208, v208 row_ror:8 row_mask:0xf bank_mask:0xf
    s_nop 0
    v_add_f32_dpp v209, v209, v209 row_ror:8 row_mask:0xf bank_mask:0xf
    v_cvt_pk_bf16_f32 v216, v208, v209
    buffer_store_dword v216, v253, s[36:39], 0 offen sc1
    v_add_u32 v252, s88, v2
    v_add_u32 v253, 147456, v252
    v_mfma_f32_16x16x32_bf16 v[248:251], v[24:27], v[132:135], v[248:251]
    s_waitcnt lgkmcnt(4)
    v_mfma_f32_32x32x16_bf16 v[100:115], v[136:139], a[120:123], v[100:115]
    v_mfma_f32_16x16x32_bf16 v[200:203], v[24:27], v[136:139], v[200:203]
    s_waitcnt lgkmcnt(2)
    v_mfma_f32_32x32x16_bf16 v[84:99], v[140:143], a[124:127], v[84:99]
    s_waitcnt lgkmcnt(0)
    v_mfma_f32_32x32x16_bf16 v[100:115], v[144:147], a[124:127], v[100:115]
    s_nop 3
    v_cndmask_b32_e64 v248, v248, v200, s[86:87]
    ds_write_b32 v7, v248
    v_add_u32 v191, 0xfffe0000, v191
    v_add_u32 v36, 0xfffe0000, v36
    v_add_u32 v37, 0xfffe0000, v37
    v_add_u32 v38, 0xfffe0000, v38
    v_add_u32 v39, 0xfffe0000, v39
    v_add_u32 v40, 0xfffe0000, v40
    s_waitcnt lgkmcnt(0)
    s_barrier
    ds_read_b64_tr_b16 v[116:117], v37
    ds_read_b64_tr_b16 v[118:119], v37 offset:2048
    ds_read_b64_tr_b16 v[124:125], v40
    ds_read_b64_tr_b16 v[126:127], v40 offset:2048
    s_waitcnt lgkmcnt(2)
    v_mfma_f32_32x32x16_bf16 v[44:59], v[116:119], a[0:3], 0
    ds_read_b64_tr_b16 v[132:133], v37 offset:8192
    ds_read_b64_tr_b16 v[134:135], v37 offset:10240
    s_add_u32 s67, s66, 2
    v_mov_b32 v29, s67
    buffer_store_dword v29, v207, s[36:39], 0 offen sc1
    ds_read2st64_b32 v[168:169], v41 offset0:0 offset1:2
    ds_read2st64_b32 v[170:171], v6 offset0:0 offset1:2
    s_waitcnt lgkmcnt(0)
    v_add_f32 v168, v168, v169
    v_cndmask_b32_e64 v168, v168, 0, s[86:87]
    v_and_b32 v169, 0xffff0000, v168
    v_sub_f32 v168, v168, v169
    v_lshrrev_b32 v161, 16, v169
    v_cvt_pk_bf16_f32 v160, v169, v168
    v_add_f32 v170, v170, v171
    v_mfma_f32_16x16x32_bf16 v[148:151], v[24:27], v[116:119], 0
    v_mfma_f32_32x32x16_bf16 v[44:59], v[124:127], a[4:7], v[44:59]
    ds_read_b64_tr_b16 v[140:141], v40 offset:8192
    ds_read_b64_tr_b16 v[142:143], v40 offset:10240
    s_sub_u32 s67, s44, 0
    s_lshl_b32 s67, s67, 16
    s_add_u32 s67, s67, 384
    v_lshl_add_u32 v13, v1, 10, s67
    buffer_load_dword v14, v13, s[20:23], 0 offen
    v_cndmask_b32_e64 v170, v170, 0, s[86:87]
    v_and_b32 v171, 0xffff0000, v170
    v_sub_f32 v170, v170, v171
    v_lshrrev_b32 v165, 16, v171
    v_cvt_pk_bf16_f32 v164, v171, v170
    v_mfma_f32_32x32x16_bf16 v[84:99], v[160:163], v[156:159], v[84:99]
    s_nop 0
    v_mfma_f32_32x32x16_bf16 v[100:115], v[164:167], v[156:159], v[100:115]
    s_nop 9
    v_mul_f32 v240, v84, v84
    v_mfma_f32_32x32x16_bf16 v[44:59], v[132:135], a[8:11], v[44:59]
    ds_read_b64_tr_b16 v[116:117], v37 offset:16384
    ds_read_b64_tr_b16 v[118:119], v37 offset:18432
    s_sub_u32 s67, s44, 28
    s_lshl_b32 s67, s67, 16
    s_add_u32 s67, s67, 384
    v_lshl_add_u32 v13, v1, 10, s67
    buffer_load_dword v14, v13, s[24:27], 0 offen
    v_mul_f32 v241, v85, v85
    v_mul_f32 v242, v86, v86
    v_mul_f32 v243, v87, v87
    v_mul_f32 v244, v88, v88
    v_mul_f32 v245, v89, v89
    v_mul_f32 v246, v90, v90
    v_mul_f32 v247, v91, v91
    v_fma_f32 v240, v240, v153, v152
    v_mfma_f32_16x16x32_bf16 v[148:151], v[24:27], v[132:135], v[148:151]
    s_waitcnt lgkmcnt(2)
    v_mfma_f32_32x32x16_bf16 v[44:59], v[140:143], a[12:15], v[44:59]
    ds_read_b64_tr_b16 v[124:125], v40 offset:16384
    ds_read_b64_tr_b16 v[126:127], v40 offset:18432
    v_fma_f32 v241, v241, v153, v152
    v_fma_f32 v242, v242, v153, v152
    v_fma_f32 v243, v243, v153, v152
    v_fma_f32 v244, v244, v153, v152
    v_fma_f32 v245, v245, v153, v152
    v_fma_f32 v246, v246, v153, v152
    v_fma_f32 v247, v247, v153, v152
    v_mul_f32 v240, v240, v84
    v_mul_f32 v241, v241, v85
    v_mul_f32 v242, v242, v86
    v_mul_f32 v243, v243, v87
    v_mul_f32 v244, v244, v88
    v_mul_f32 v245, v245, v89
    s_waitcnt lgkmcnt(2)
    v_mfma_f32_32x32x16_bf16 v[44:59], v[116:119], a[16:19], v[44:59]
    ds_read_b64_tr_b16 v[132:133], v37 offset:24576
    ds_read_b64_tr_b16 v[134:135], v37 offset:26624
    v_mul_f32 v246, v246, v90
    v_mul_f32 v247, v247, v91
    v_exp_f32 v240, v240
    v_exp_f32 v241, v241
    v_exp_f32 v242, v242
    v_exp_f32 v243, v243
    v_exp_f32 v244, v244
    v_exp_f32 v245, v245
    v_mfma_f32_16x16x32_bf16 v[148:151], v[24:27], v[116:119], v[148:151]
    s_waitcnt lgkmcnt(2)
    v_mfma_f32_32x32x16_bf16 v[44:59], v[124:127], a[20:23], v[44:59]
    ds_read_b64_tr_b16 v[140:141], v40 offset:24576
    ds_read_b64_tr_b16 v[142:143], v40 offset:26624
    v_exp_f32 v246, v246
    v_exp_f32 v247, v247
    v_fma_f32 v240, v240, v155, v155
    v_fma_f32 v241, v241, v155, v155
    v_fma_f32 v242, v242, v155, v155
    v_fma_f32 v243, v243, v155, v155
    v_fma_f32 v244, v244, v155, v155
    v_fma_f32 v245, v245, v155, v155
    v_fma_f32 v246, v246, v155, v155
    v_fma_f32 v247, v247, v155, v155
    s_waitcnt lgkmcnt(2)
    v_mfma_f32_32x32x16_bf16 v[44:59], v[132:135], a[24:27], v[44:59]
    ds_read_b64_tr_b16 v[116:117], v37 offset:49152
    ds_read_b64_tr_b16 v[118:119], v37 offset:51200
    v_rcp_f32 v240, v240
    v_rcp_f32 v241, v241
    v_rcp_f32 v242, v242
    v_rcp_f32 v243, v243
    v_rcp_f32 v244, v244
    v_rcp_f32 v245, v245
    v_rcp_f32 v246, v246
    v_mfma_f32_16x16x32_bf16 v[148:151], v[24:27], v[132:135], v[148:151]
    s_waitcnt lgkmcnt(2)
    v_mfma_f32_32x32x16_bf16 v[44:59], v[140:143], a[28:31], v[44:59]
    ds_read_b64_tr_b16 v[124:125], v40 offset:49152
    ds_read_b64_tr_b16 v[126:127], v40 offset:51200
    v_rcp_f32 v247, v247
    v_mul_f32 v240, v240, v84
    v_mul_f32 v241, v241, v85
    v_mul_f32 v242, v242, v86
    v_mul_f32 v243, v243, v87
    v_mul_f32 v244, v244, v88
    v_mul_f32 v245, v245, v89
    v_mul_f32 v246, v246, v90
    v_mul_f32 v247, v247, v91
    v_cvt_pk_bf16_f32 v172, v240, v241
    v_cvt_pk_bf16_f32 v173, v242, v243
    s_waitcnt lgkmcnt(2)
    v_mfma_f32_32x32x16_bf16 v[44:59], v[116:119], a[32:35], v[44:59]
    ds_read_b64_tr_b16 v[132:133], v37 offset:57344
    ds_read_b64_tr_b16 v[134:135], v37 offset:59392
    v_cvt_pk_bf16_f32 v174, v244, v245
    v_cvt_pk_bf16_f32 v175, v246, v247
    buffer_store_dwordx4 v[172:175], v195, s[36:39], 0 offen sc1
    v_mul_f32 v240, v92, v92
    v_mul_f32 v241, v93, v93
    v_mul_f32 v242, v94, v94
    v_mul_f32 v243, v95, v95
    v_mul_f32 v244, v96, v96
    v_mul_f32 v245, v97, v97
    v_mul_f32 v246, v98, v98
    v_mul_f32 v247, v99, v99
    v_fma_f32 v240, v240, v153, v152
    v_fma_f32 v241, v241, v153, v152
    v_mfma_f32_16x16x32_bf16 v[148:151], v[24:27], v[116:119], v[148:151]
    s_waitcnt lgkmcnt(2)
    v_mfma_f32_32x32x16_bf16 v[44:59], v[124:127], a[36:39], v[44:59]
    ds_read_b64_tr_b16 v[140:141], v40 offset:57344
    ds_read_b64_tr_b16 v[142:143], v40 offset:59392
    v_fma_f32 v242, v242, v153, v152
    v_fma_f32 v243, v243, v153, v152
    v_fma_f32 v244, v244, v153, v152
    v_fma_f32 v245, v245, v153, v152
    v_fma_f32 v246, v246, v153, v152
    v_fma_f32 v247, v247, v153, v152
    v_mul_f32 v240, v240, v92
    v_mul_f32 v241, v241, v93
    v_mul_f32 v242, v242, v94
    v_mul_f32 v243, v243, v95
    v_mul_f32 v244, v244, v96
    v_mul_f32 v245, v245, v97
    v_mul_f32 v246, v246, v98
    v_add_u32 v191, 0x10000, v191
    v_add_u32 v36, 0x10000, v36
    v_add_u32 v37, 0x10000, v37
    v_add_u32 v38, 0x10000, v38
    v_add_u32 v39, 0x10000, v39
    v_add_u32 v40, 0x10000, v40
    s_waitcnt lgkmcnt(2)
    v_mfma_f32_32x32x16_bf16 v[44:59], v[132:135], a[40:43], v[44:59]
    ds_read_b64_tr_b16 v[116:117], v37
    ds_read_b64_tr_b16 v[118:119], v37 offset:2048
    v_mul_f32 v247, v247, v99
    v_exp_f32 v240, v240
    v_exp_f32 v241, v241
    v_exp_f32 v242, v242
    v_exp_f32 v243, v243
    v_exp_f32 v244, v244
    v_exp_f32 v245, v245
    v_mfma_f32_16x16x32_bf16 v[148:151], v[24:27], v[132:135], v[148:151]
    s_waitcnt lgkmcnt(2)
    v_mfma_f32_32x32x16_bf16 v[44:59], v[140:143], a[44:47], v[44:59]
    ds_read_b64_tr_b16 v[124:125], v40
    ds_read_b64_tr_b16 v[126:127], v40 offset:2048
    v_exp_f32 v246, v246
    v_exp_f32 v247, v247
    v_fma_f32 v240, v240, v155, v155
    v_fma_f32 v241, v241, v155, v155
    v_fma_f32 v242, v242, v155, v155
    v_fma_f32 v243, v243, v155, v155
    v_fma_f32 v244, v244, v155, v155
    v_fma_f32 v245, v245, v155, v155
    v_fma_f32 v246, v246, v155, v155
    v_fma_f32 v247, v247, v155, v155
    v_rcp_f32 v240, v240
    s_waitcnt lgkmcnt(2)
    v_mfma_f32_32x32x16_bf16 v[44:59], v[116:119], a[48:51], v[44:59]
    ds_read_b64_tr_b16 v[132:133], v37 offset:8192
    ds_read_b64_tr_b16 v[134:135], v37 offset:10240
    buffer_load_dwordx4 v[180:183], v2, s[36:39], s0 offen sc1
    v_rcp_f32 v241, v241
    v_rcp_f32 v242, v242
    v_rcp_f32 v243, v243
    v_rcp_f32 v244, v244
    v_rcp_f32 v245, v245
    v_rcp_f32 v246, v246
    v_mfma_f32_16x16x32_bf16 v[148:151], v[24:27], v[116:119], v[148:151]
    s_waitcnt lgkmcnt(2)
    v_mfma_f32_32x32x16_bf16 v[44:59], v[124:127], a[52:55], v[44:59]
    ds_read_b64_tr_b16 v[140:141], v40 offset:8192
    ds_read_b64_tr_b16 v[142:143], v40 offset:10240
    buffer_load_dwordx4 v[184:187], v2, s[36:39], s0 offen offset:1024 sc1
    v_rcp_f32 v247, v247
    v_mul_f32 v240, v240, v92
    v_mul_f32 v241, v241, v93
    v_mul_f32 v242, v242, v94
    v_mul_f32 v243, v243, v95
    v_mul_f32 v244, v244, v96
    v_mul_f32 v245, v245, v97
    v_mul_f32 v246, v246, v98
    v_mul_f32 v247, v247, v99
    v_cvt_pk_bf16_f32 v176, v240, v241
    s_waitcnt lgkmcnt(2)
    v_mfma_f32_32x32x16_bf16 v[44:59], v[132:135], a[56:59], v[44:59]
    ds_read_b64_tr_b16 v[116:117], v37 offset:16384
    ds_read_b64_tr_b16 v[118:119], v37 offset:18432
    buffer_load_dwordx4 v[60:63], v9, s[4:7], 0 offen
    v_cvt_pk_bf16_f32 v177, v242, v243
    v_cvt_pk_bf16_f32 v178, v244, v245
    v_cvt_pk_bf16_f32 v179, v246, v247
    buffer_store_dwordx4 v[176:179], v195, s[36:39], 0 offen offset:1024 sc1
    v_mul_f32 v240, v100, v100
    v_mul_f32 v241, v101, v101
    v_mul_f32 v242, v102, v102
    v_mul_f32 v243, v103, v103
    v_mul_f32 v244, v104, v104
    v_mul_f32 v245, v105, v105
    v_mul_f32 v246, v106, v106
    v_mul_f32 v247, v107, v107
    v_mfma_f32_16x16x32_bf16 v[148:151], v[24:27], v[132:135], v[148:151]
    s_waitcnt lgkmcnt(2)
    v_mfma_f32_32x32x16_bf16 v[44:59], v[140:143], a[60:63], v[44:59]
    ds_read_b64_tr_b16 v[124:125], v40 offset:16384
    ds_read_b64_tr_b16 v[126:127], v40 offset:18432
    buffer_load_dwordx4 v[64:67], v10, s[4:7], 0 offen
    v_fma_f32 v240, v240, v153, v152
    v_fma_f32 v241, v241, v153, v152
    v_fma_f32 v242, v242, v153, v152
    v_fma_f32 v243, v243, v153, v152
    v_fma_f32 v244, v244, v153, v152
    v_fma_f32 v245, v245, v153, v152
    v_fma_f32 v246, v246, v153, v152
    v_fma_f32 v247, v247, v153, v152
    v_mul_f32 v240, v240, v100
    v_mul_f32 v241, v241, v101
    v_mul_f32 v242, v242, v102
    v_mul_f32 v243, v243, v103
    s_waitcnt lgkmcnt(2)
    v_mfma_f32_32x32x16_bf16 v[44:59], v[116:119], a[64:67], v[44:59]
    ds_read_b64_tr_b16 v[132:133], v37 offset:24576
    ds_read_b64_tr_b16 v[134:135], v37 offset:26624
    buffer_load_dword v223, v206, s[36:39], 0 offen sc1
    v_mul_f32 v244, v244, v104
    v_mul_f32 v245, v245, v105
    v_mul_f32 v246, v246, v106
    v_mul_f32 v247, v247, v107
    v_exp_f32 v240, v240
    v_exp_f32 v241, v241
    v_exp_f32 v242, v242
    v_exp_f32 v243, v243
    v_mfma_f32_16x16x32_bf16 v[148:151], v[24:27], v[116:119], v[148:151]
    s_waitcnt lgkmcnt(2)
    v_mfma_f32_32x32x16_bf16 v[44:59], v[124:127], a[68:71], v[44:59]
    ds_read_b64_tr_b16 v[140:141], v40 offset:24576
    ds_read_b64_tr_b16 v[142:143], v40 offset:26624
    v_exp_f32 v244, v244
    v_exp_f32 v245, v245
    v_exp_f32 v246, v246
    v_exp_f32 v247, v247
    v_fma_f32 v240, v240, v155, v155
    v_fma_f32 v241, v241, v155, v155
    v_fma_f32 v242, v242, v155, v155
    v_fma_f32 v243, v243, v155, v155
    v_fma_f32 v244, v244, v155, v155
    s_waitcnt lgkmcnt(2)
    v_mfma_f32_32x32x16_bf16 v[44:59], v[132:135], a[72:75], v[44:59]
    ds_read_b64_tr_b16 v[116:117], v37 offset:32768
    ds_read_b64_tr_b16 v[118:119], v37 offset:34816
    v_fma_f32 v245, v245, v155, v155
    v_fma_f32 v246, v246, v155, v155
    v_fma_f32 v247, v247, v155, v155
    v_rcp_f32 v240, v240
    v_rcp_f32 v241, v241
    v_rcp_f32 v242, v242
    v_rcp_f32 v243, v243
    v_rcp_f32 v244, v244
    v_mfma_f32_16x16x32_bf16 v[148:151], v[24:27], v[132:135], v[148:151]
    s_waitcnt lgkmcnt(2)
    v_mfma_f32_32x32x16_bf16 v[44:59], v[140:143], a[76:79], v[44:59]
    ds_read_b64_tr_b16 v[124:125], v40 offset:32768
    ds_read_b64_tr_b16 v[126:127], v40 offset:34816
    v_rcp_f32 v245, v245
    v_rcp_f32 v246, v246
    v_rcp_f32 v247, v247
    v_mul_f32 v240, v240, v100
    v_mul_f32 v241, v241, v101
    v_mul_f32 v242, v242, v102
    v_mul_f32 v243, v243, v103
    v_mul_f32 v244, v244, v104
    v_mul_f32 v245, v245, v105
    v_mul_f32 v246, v246, v106
    s_barrier
    s_waitcnt lgkmcnt(2)
    v_mfma_f32_32x32x16_bf16 v[44:59], v[116:119], a[80:83], v[44:59]
    ds_read_b64_tr_b16 v[132:133], v37 offset:40960
    ds_read_b64_tr_b16 v[134:135], v37 offset:43008
    s_add_u32 m0, s3, 0
    s_add_u32 s71, s79, 0x40000
    buffer_load_dwordx4 v35, s[20:23], s71 offen lds
    v_mul_f32 v247, v247, v107
    v_cvt_pk_bf16_f32 v172, v240, v241
    v_cvt_pk_bf16_f32 v173, v242, v243
    v_cvt_pk_bf16_f32 v174, v244, v245
    v_cvt_pk_bf16_f32 v175, v246, v247
    buffer_store_dwordx4 v[172:175], v196, s[36:39], 0 offen sc1
    v_mul_f32 v240, v108, v108
    v_mul_f32 v241, v109, v109
    v_mul_f32 v242, v110, v110
    v_mul_f32 v243, v111, v111
    v_mfma_f32_16x16x32_bf16 v[148:151], v[24:27], v[116:119], v[148:151]
    s_waitcnt lgkmcnt(2)
    v_mfma_f32_32x32x16_bf16 v[44:59], v[124:127], a[84:87], v[44:59]
    ds_read_b64_tr_b16 v[140:141], v40 offset:40960
    ds_read_b64_tr_b16 v[142:143], v40 offset:43008
    buffer_load_dwordx4 v192, s[20:23], s71 offen offset:1024 lds
    v_mul_f32 v244, v112, v112
    v_mul_f32 v245, v113, v113
    v_mul_f32 v246, v114, v114
    v_mul_f32 v247, v115, v115
    v_fma_f32 v240, v240, v153, v152
    v_fma_f32 v241, v241, v153, v152
    v_fma_f32 v242, v242, v153, v152
    v_fma_f32 v243, v243, v153, v152
    v_fma_f32 v244, v244, v153, v152
    v_fma_f32 v245, v245, v153, v152
    v_fma_f32 v246, v246, v153, v152
    v_fma_f32 v247, v247, v153, v152
    v_add_u32 v191, 0x10000, v191
    v_add_u32 v36, 0x10000, v36
    v_add_u32 v37, 0x10000, v37
    v_add_u32 v38, 0x10000, v38
    v_add_u32 v39, 0x10000, v39
    v_add_u32 v40, 0x10000, v40
    s_waitcnt lgkmcnt(2)
    v_mfma_f32_32x32x16_bf16 v[44:59], v[132:135], a[88:91], v[44:59]
    ds_read_b64_tr_b16 v[116:117], v37
    ds_read_b64_tr_b16 v[118:119], v37 offset:2048
    buffer_load_dwordx4 v193, s[20:23], s71 offen offset:2048 lds
    v_mul_f32 v240, v240, v108
    v_mul_f32 v241, v241, v109
    v_mul_f32 v242, v242, v110
    v_mul_f32 v243, v243, v111
    v_mul_f32 v244, v244, v112
    v_mul_f32 v245, v245, v113
    v_mul_f32 v246, v246, v114
    v_mul_f32 v247, v247, v115
    v_exp_f32 v240, v240
    v_exp_f32 v241, v241
    v_mfma_f32_16x16x32_bf16 v[148:151], v[24:27], v[132:135], v[148:151]
    s_waitcnt lgkmcnt(2)
    v_mfma_f32_32x32x16_bf16 v[44:59], v[140:143], a[92:95], v[44:59]
    ds_read_b64_tr_b16 v[124:125], v40
    ds_read_b64_tr_b16 v[126:127], v40 offset:2048
    buffer_load_dwordx4 v194, s[20:23], s71 offen offset:3072 lds
    v_exp_f32 v242, v242
    v_exp_f32 v243, v243
    v_exp_f32 v244, v244
    v_exp_f32 v245, v245
    v_exp_f32 v246, v246
    v_exp_f32 v247, v247
    s_waitcnt lgkmcnt(2)
    v_mfma_f32_32x32x16_bf16 v[44:59], v[116:119], a[96:99], v[44:59]
    ds_read_b64_tr_b16 v[132:133], v37 offset:8192
    ds_read_b64_tr_b16 v[134:135], v37 offset:10240
    s_add_u32 m0, s3, 16384
    s_add_u32 s71, s79, 0x80000
    buffer_load_dwordx4 v35, s[20:23], s71 offen lds
    v_fma_f32 v240, v240, v155, v155
    v_fma_f32 v241, v241, v155, v155
    v_fma_f32 v242, v242, v155, v155
    v_fma_f32 v243, v243, v155, v155
    v_fma_f32 v244, v244, v155, v155
    v_fma_f32 v245, v245, v155, v155
    v_fma_f32 v246, v246, v155, v155
    v_fma_f32 v247, v247, v155, v155
    v_rcp_f32 v240, v240
    v_mfma_f32_16x16x32_bf16 v[148:151], v[24:27], v[116:119], v[148:151]
    s_waitcnt lgkmcnt(2)
    v_mfma_f32_32x32x16_bf16 v[44:59], v[124:127], a[100:103], v[44:59]
    ds_read_b64_tr_b16 v[140:141], v40 offset:8192
    ds_read_b64_tr_b16 v[142:143], v40 offset:10240
    buffer_load_dwordx4 v192, s[20:23], s71 offen offset:1024 lds
    v_rcp_f32 v241, v241
    v_rcp_f32 v242, v242
    v_rcp_f32 v243, v243
    v_rcp_f32 v244, v244
    v_rcp_f32 v245, v245
    v_rcp_f32 v246, v246
    s_waitcnt lgkmcnt(2)
    v_mfma_f32_32x32x16_bf16 v[44:59], v[132:135], a[104:107], v[44:59]
    ds_read_b64_tr_b16 v[116:117], v37 offset:16384
    ds_read_b64_tr_b16 v[118:119], v37 offset:18432
    buffer_load_dwordx4 v193, s[20:23], s71 offen offset:2048 lds
    v_rcp_f32 v247, v247
    v_mul_f32 v240, v240, v108
    v_mul_f32 v241, v241, v109
    v_mul_f32 v242, v242, v110
    v_mul_f32 v243, v243, v111
    v_mul_f32 v244, v244, v112
    v_mul_f32 v245, v245, v113
    v_mul_f32 v246, v246, v114
    v_mul_f32 v247, v247, v115
    v_cvt_pk_bf16_f32 v176, v240, v241
    v_cvt_pk_bf16_f32 v177, v242, v243
    v_mfma_f32_16x16x32_bf16 v[148:151], v[24:27], v[132:135], v[148:151]
    s_waitcnt lgkmcnt(2)
    v_mfma_f32_32x32x16_bf16 v[44:59], v[140:143], a[108:111], v[44:59]
    ds_read_b64_tr_b16 v[124:125], v40 offset:16384
    ds_read_b64_tr_b16 v[126:127], v40 offset:18432
    buffer_load_dwordx4 v194, s[20:23], s71 offen offset:3072 lds
    v_cvt_pk_bf16_f32 v178, v244, v245
    v_cvt_pk_bf16_f32 v179, v246, v247
    buffer_store_dwordx4 v[176:179], v196, s[36:39], 0 offen offset:1024 sc1
    s_barrier
    s_waitcnt lgkmcnt(2)
    v_mfma_f32_32x32x16_bf16 v[44:59], v[116:119], a[112:115], v[44:59]
    ds_read_b64_tr_b16 v[132:133], v37 offset:24576
    ds_read_b64_tr_b16 v[134:135], v37 offset:26624
    s_add_u32 m0, s3, 49152
    s_add_u32 s71, s79, 0xc0000
    buffer_load_dwordx4 v35, s[20:23], s71 offen lds
    v_mfma_f32_16x16x32_bf16 v[148:151], v[24:27], v[116:119], v[148:151]
    s_waitcnt lgkmcnt(2)
    v_mfma_f32_32x32x16_bf16 v[44:59], v[124:127], a[116:119], v[44:59]
    ds_read_b64_tr_b16 v[140:141], v40 offset:24576
    ds_read_b64_tr_b16 v[142:143], v40 offset:26624
    buffer_load_dwordx4 v192, s[20:23], s71 offen offset:1024 lds
    s_waitcnt lgkmcnt(2)
    v_mfma_f32_32x32x16_bf16 v[44:59], v[132:135], a[120:123], v[44:59]
    buffer_load_dwordx4 v193, s[20:23], s71 offen offset:2048 lds
    v_mfma_f32_16x16x32_bf16 v[148:151], v[24:27], v[132:135], v[148:151]
    s_waitcnt lgkmcnt(0)
    v_mfma_f32_32x32x16_bf16 v[44:59], v[140:143], a[124:127], v[44:59]
    buffer_load_dwordx4 v194, s[20:23], s71 offen offset:3072 lds
    s_nop 4
    ds_write_b32 v7, v148 offset:256
    s_waitcnt lgkmcnt(0)
    s_barrier
    ds_read2st64_b32 v[168:169], v41 offset0:1 offset1:3
    s_add_u32 s67, s101, 5
    v_mov_b32 v29, s67
    s_add_u32 s67, s66, 5
    v_mov_b32 v31, s67
    s_waitcnt vmcnt(4)
    buffer_store_dword v29, v21, s[36:39], 0 offen
    s_cmp_eq_u32 s1, 0
    s_cbranch_scc1 L_fq_36
L_fqb_37:
    s_waitcnt lgkmcnt(0)
    v_add_f32 v168, v168, v169
    v_cndmask_b32_e64 v168, v168, 0, s[86:87]
    v_and_b32 v169, 0xffff0000, v168
    v_sub_f32 v168, v168, v169
    v_lshrrev_b32 v161, 16, v169
    v_cvt_pk_bf16_f32 v160, v169, v168
    s_nop 1
    v_mfma_f32_32x32x16_bf16 v[44:59], v[160:163], v[156:159], v[44:59]
    s_mov_b32 s45, s46
    v_bfe_u32 v3, v1, 2, 2
    v_lshrrev_b32 v4, 5, v1
    v_mul_u32_u24 v4, 4, v4
    v_add_u32 v3, v3, v4
    v_mul_u32_u24 v3, 128, v3
    v_bfe_u32 v4, v1, 4, 1
    v_lshl_add_u32 v3, v4, 5, v3
    v_and_b32 v4, 3, v1
    v_lshl_add_u32 v3, v4, 3, v3
    s_lshr_b32 s67, s62, 1
    v_bfe_u32 v4, v1, 3, 1
    v_xor_b32 v4, s67, v4
    v_lshl_add_u32 v3, v4, 6, v3
    s_lshl_b32 s67, s67, 13
    s_add_u32 s67, s67, 65536
    v_add_u32 v7, s67, v3
    v_xor_b32 v33, 64, v7
    v_lshlrev_b32 v68, 16, v180
    v_and_b32 v69, 0xffff0000, v180
    v_lshlrev_b32 v70, 16, v181
    v_and_b32 v71, 0xffff0000, v181
    v_lshlrev_b32 v72, 16, v182
    v_and_b32 v73, 0xffff0000, v182
    v_lshlrev_b32 v74, 16, v183
    v_and_b32 v75, 0xffff0000, v183
    v_lshlrev_b32 v76, 16, v184
    v_and_b32 v77, 0xffff0000, v184
    v_lshlrev_b32 v78, 16, v185
    v_and_b32 v79, 0xffff0000, v185
    v_lshlrev_b32 v80, 16, v186
    v_and_b32 v81, 0xffff0000, v186
    v_lshlrev_b32 v82, 16, v187
    v_and_b32 v83, 0xffff0000, v187
    v_subrev_u32 v223, s66, v223
    v_cmp_gt_u32 vcc, 8, v223
    s_nop 1
    v_cndmask_b32 v223, 0, v223, vcc
    v_cmp_lt_u32 vcc, v223, v20
    s_nop 1
    s_cbranch_vccnz L_slow_38
L_back_39:
    buffer_load_dwordx4 v[208:211], v2, s[36:39], s89 offen sc1
    buffer_load_dwordx4 v[212:215], v2, s[36:39], s89 offen offset:1024 sc1
    v_pk_mul_f32 v[240:241], v[44:45], v[44:45]
    v_pk_mul_f32 v[242:243], v[46:47], v[46:47]
    v_pk_mul_f32 v[244:245], v[48:49], v[48:49]
    v_pk_mul_f32 v[246:247], v[50:51], v[50:51]
    s_add_u32 m0, s3, 65536
    s_add_u32 s71, s61, 0x100000
    buffer_load_dwordx4 v35, s[20:23], s71 offen lds
    v_pk_fma_f32 v[240:241], v[240:241], v[152:153], v[152:153] op_sel:[0,1,0] op_sel_hi:[1,1,0]
    v_pk_fma_f32 v[242:243], v[242:243], v[152:153], v[152:153] op_sel:[0,1,0] op_sel_hi:[1,1,0]
    v_pk_fma_f32 v[244:245], v[244:245], v[152:153], v[152:153] op_sel:[0,1,0] op_sel_hi:[1,1,0]
    v_pk_fma_f32 v[246:247], v[246:247], v[152:153], v[152:153] op_sel:[0,1,0] op_sel_hi:[1,1,0]
    v_pk_mul_f32 v[240:241], v[240:241], v[44:45]
    v_pk_mul_f32 v[242:243], v[242:243], v[46:47]
    v_pk_mul_f32 v[244:245], v[244:245], v[48:49]
    v_pk_mul_f32 v[246:247], v[246:247], v[50:51]
    v_exp_f32 v240, v240
    v_exp_f32 v241, v241
    v_exp_f32 v242, v242
    v_exp_f32 v243, v243
    v_exp_f32 v244, v244
    v_exp_f32 v245, v245
    v_exp_f32 v246, v246
    v_exp_f32 v247, v247
    buffer_load_dwordx4 v192, s[20:23], s71 offen offset:1024 lds
    v_pk_fma_f32 v[240:241], v[240:241], v[154:155], v[154:155] op_sel:[0,1,1] op_sel_hi:[1,1,1]
    v_pk_fma_f32 v[242:243], v[242:243], v[154:155], v[154:155] op_sel:[0,1,1] op_sel_hi:[1,1,1]
    v_pk_fma_f32 v[244:245], v[244:245], v[154:155], v[154:155] op_sel:[0,1,1] op_sel_hi:[1,1,1]
    v_pk_fma_f32 v[246:247], v[246:247], v[154:155], v[154:155] op_sel:[0,1,1] op_sel_hi:[1,1,1]
    v_rcp_f32 v240, v240
    v_rcp_f32 v241, v241
    v_rcp_f32 v242, v242
    v_rcp_f32 v243, v243
    v_rcp_f32 v244, v244
    v_rcp_f32 v245, v245
    v_rcp_f32 v246, v246
    v_rcp_f32 v247, v247
    buffer_load_dwordx4 v193, s[20:23], s71 offen offset:2048 lds
    v_pk_mul_f32 v[240:241], v[240:241], v[44:45]
    v_pk_mul_f32 v[242:243], v[242:243], v[46:47]
    v_pk_mul_f32 v[244:245], v[244:245], v[48:49]
    v_pk_mul_f32 v[246:247], v[246:247], v[50:51]
    v_cvt_pk_bf16_f32 v172, v240, v241
    v_cvt_pk_bf16_f32 v173, v242, v243
    v_cvt_pk_bf16_f32 v174, v244, v245
    v_cvt_pk_bf16_f32 v175, v246, v247
    buffer_store_dwordx4 v[172:175], v195, s[36:39], s45 offen sc1
    v_pk_mul_f32 v[240:241], v[52:53], v[52:53]
    v_pk_mul_f32 v[242:243], v[54:55], v[54:55]
    v_pk_mul_f32 v[244:245], v[56:57], v[56:57]
    v_pk_mul_f32 v[246:247], v[58:59], v[58:59]
    buffer_load_dwordx4 v194, s[20:23], s71 offen offset:3072 lds
    v_pk_fma_f32 v[240:241], v[240:241], v[152:153], v[152:153] op_sel:[0,1,0] op_sel_hi:[1,1,0]
    v_pk_fma_f32 v[242:243], v[242:243], v[152:153], v[152:153] op_sel:[0,1,0] op_sel_hi:[1,1,0]
    v_pk_fma_f32 v[244:245], v[244:245], v[152:153], v[152:153] op_sel:[0,1,0] op_sel_hi:[1,1,0]
    v_pk_fma_f32 v[246:247], v[246:247], v[152:153], v[152:153] op_sel:[0,1,0] op_sel_hi:[1,1,0]
    v_pk_mul_f32 v[240:241], v[240:241], v[52:53]
    v_pk_mul_f32 v[242:243], v[242:243], v[54:55]
    v_pk_mul_f32 v[244:245], v[244:245], v[56:57]
    v_pk_mul_f32 v[246:247], v[246:247], v[58:59]
    v_exp_f32 v240, v240
    v_exp_f32 v241, v241
    v_exp_f32 v242, v242
    v_exp_f32 v243, v243
    v_exp_f32 v244, v244
    v_exp_f32 v245, v245
    v_exp_f32 v246, v246
    v_exp_f32 v247, v247
    s_add_u32 m0, s3, 81920
    s_add_u32 s71, s61, 0x130000
    buffer_load_dwordx4 v35, s[20:23], s71 offen lds
    v_pk_fma_f32 v[240:241], v[240:241], v[154:155], v[154:155] op_sel:[0,1,1] op_sel_hi:[1,1,1]
    v_pk_fma_f32 v[242:243], v[242:243], v[154:155], v[154:155] op_sel:[0,1,1] op_sel_hi:[1,1,1]
    v_pk_fma_f32 v[244:245], v[244:245], v[154:155], v[154:155] op_sel:[0,1,1] op_sel_hi:[1,1,1]
    v_pk_fma_f32 v[246:247], v[246:247], v[154:155], v[154:155] op_sel:[0,1,1] op_sel_hi:[1,1,1]
    v_rcp_f32 v240, v240
    v_rcp_f32 v241, v241
    v_rcp_f32 v242, v242
    v_rcp_f32 v243, v243
    v_rcp_f32 v244, v244
    v_rcp_f32 v245, v245
    v_rcp_f32 v246, v246
    v_rcp_f32 v247, v247
    buffer_load_dwordx4 v192, s[20:23], s71 offen offset:1024 lds
    v_pk_mul_f32 v[240:241], v[240:241], v[52:53]
    v_pk_mul_f32 v[242:243], v[242:243], v[54:55]
    v_pk_mul_f32 v[244:245], v[244:245], v[56:57]
    v_pk_mul_f32 v[246:247], v[246:247], v[58:59]
    v_cvt_pk_bf16_f32 v176, v240, v241
    v_cvt_pk_bf16_f32 v177, v242, v243
    v_cvt_pk_bf16_f32 v178, v244, v245
    v_cvt_pk_bf16_f32 v179, v246, v247
    buffer_store_dwordx4 v[176:179], v195, s[36:39], s45 offen offset:1024 sc1
    buffer_load_dword v23, v22, s[36:39], 0 offen sc1
    s_waitcnt vmcnt(9)
    v_mfma_f32_32x32x16_bf16 v[84:99], v[208:211], v[224:227], 0
    v_mfma_f32_32x32x16_bf16 v[100:115], v[212:215], v[228:231], 0
    buffer_load_dwordx4 v193, s[20:23], s71 offen offset:2048 lds
    buffer_load_dwordx4 v194, s[20:23], s71 offen offset:3072 lds
    s_nop 8
    v_add_f32 v92, s75, v92
    v_rcp_f32 v92, v92
    s_nop 0
    v_pk_mul_f32 v[84:85], v[84:85], v[92:93] op_sel_hi:[1,0]
    v_pk_mul_f32 v[86:87], v[86:87], v[92:93] op_sel_hi:[1,0]
    v_pk_mul_f32 v[88:89], v[88:89], v[92:93] op_sel_hi:[1,0]
    v_pk_mul_f32 v[90:91], v[90:91], v[92:93] op_sel_hi:[1,0]
    v_cvt_pk_bf16_f32 v180, v84, v85
    v_cvt_pk_bf16_f32 v181, v86, v87
    v_cvt_pk_bf16_f32 v182, v88, v89
    v_cvt_pk_bf16_f32 v183, v90, v91
    buffer_store_dwordx4 v[180:183], v252, s[36:39], 0 offen sc1
    v_add_f32 v100, s75, v100
    v_rcp_f32 v100, v100
    s_nop 0
    v_pk_mul_f32 v[108:109], v[108:109], v[100:101] op_sel_hi:[1,0]
    v_pk_mul_f32 v[110:111], v[110:111], v[100:101] op_sel_hi:[1,0]
    v_pk_mul_f32 v[112:113], v[112:113], v[100:101] op_sel_hi:[1,0]
    v_pk_mul_f32 v[114:115], v[114:115], v[100:101] op_sel_hi:[1,0]
    v_cvt_pk_bf16_f32 v184, v108, v109
    v_cvt_pk_bf16_f32 v185, v110, v111
    v_cvt_pk_bf16_f32 v186, v112, v113
    v_cvt_pk_bf16_f32 v187, v114, v115
    buffer_store_dwordx4 v[184:187], v252, s[36:39], 0 offen offset:1024 sc1
    v_mfma_f32_32x32x16_bf16 v[84:99], v[208:211], v[232:235], 0
    v_mfma_f32_32x32x16_bf16 v[100:115], v[212:215], v[236:239], 0
    s_nop 10
    v_add_f32 v92, s75, v92
    v_rcp_f32 v92, v92
    s_nop 0
    v_pk_mul_f32 v[84:85], v[84:85], v[92:93] op_sel_hi:[1,0]
    v_pk_mul_f32 v[86:87], v[86:87], v[92:93] op_sel_hi:[1,0]
    v_pk_mul_f32 v[88:89], v[88:89], v[92:93] op_sel_hi:[1,0]
    v_pk_mul_f32 v[90:91], v[90:91], v[92:93] op_sel_hi:[1,0]
    v_cvt_pk_bf16_f32 v180, v84, v85
    v_cvt_pk_bf16_f32 v181, v86, v87
    v_cvt_pk_bf16_f32 v182, v88, v89
    v_cvt_pk_bf16_f32 v183, v90, v91
    buffer_store_dwordx4 v[180:183], v253, s[36:39], 0 offen sc1
    v_add_f32 v100, s75, v100
    v_rcp_f32 v100, v100
    s_nop 0
    v_pk_mul_f32 v[108:109], v[108:109], v[100:101] op_sel_hi:[1,0]
    v_pk_mul_f32 v[110:111], v[110:111], v[100:101] op_sel_hi:[1,0]
    v_pk_mul_f32 v[112:113], v[112:113], v[100:101] op_sel_hi:[1,0]
    v_pk_mul_f32 v[114:115], v[114:115], v[100:101] op_sel_hi:[1,0]
    v_cvt_pk_bf16_f32 v184, v108, v109
    v_cvt_pk_bf16_f32 v185, v110, v111
    v_cvt_pk_bf16_f32 v186, v112, v113
    v_cvt_pk_bf16_f32 v187, v114, v115
    buffer_store_dwordx4 v[184:187], v253, s[36:39], 0 offen offset:1024 sc1
    s_waitcnt vmcnt(6)
    v_subrev_u32 v23, s101, v23
    v_cmp_gt_u32 vcc, 8, v23
    s_nop 1
    v_cndmask_b32 v23, 0, v23, vcc
    v_cmp_lt_u32 vcc, v23, v11
    s_nop 1
    s_cbranch_vccnz L_slow_41
L_back_42:
    s_mov_b32 s70, 0xc000
    buffer_load_dwordx4 a[128:131], v8, s[36:39], s70 offen sc1
    buffer_load_dwordx4 a[132:135], v8, s[36:39], s70 offen offset:1024 sc1
    buffer_load_dwordx4 a[136:139], v8, s[36:39], s70 offen offset:2048 sc1
    buffer_load_dwordx4 a[140:143], v8, s[36:39], s70 offen offset:3072 sc1
    s_mov_b32 s70, 0xe000
    buffer_load_dwordx4 a[144:147], v8, s[36:39], s70 offen sc1
    buffer_load_dwordx4 a[148:151], v8, s[36:39], s70 offen offset:1024 sc1
    buffer_load_dwordx4 a[152:155], v8, s[36:39], s70 offen offset:2048 sc1
    buffer_load_dwordx4 a[156:159], v8, s[36:39], s70 offen offset:3072 sc1
    s_mov_b32 s70, 0x10000
    buffer_load_dwordx4 a[160:163], v8, s[36:39], s70 offen sc1
    buffer_load_dwordx4 a[164:167], v8, s[36:39], s70 offen offset:1024 sc1
    buffer_load_dwordx4 a[168:171], v8, s[36:39], s70 offen offset:2048 sc1
    buffer_load_dwordx4 a[172:175], v8, s[36:39], s70 offen offset:3072 sc1
    s_barrier
    ds_read_b64_tr_b16 v[52:53], v7 offset:49152
    ds_read_b64_tr_b16 v[54:55], v7 offset:50176
    ds_read_b64_tr_b16 v[56:57], v33 offset:49152
    ds_read_b64_tr_b16 v[58:59], v33 offset:50176
    ds_read_b64_tr_b16 v[196:197], v7 offset:51200
    ds_read_b64_tr_b16 v[198:199], v7 offset:52224
    ds_read_b64_tr_b16 v[200:201], v33 offset:51200
    ds_read_b64_tr_b16 v[202:203], v33 offset:52224
    s_waitcnt vmcnt(8) lgkmcnt(6)
    v_mfma_f32_32x32x16_bf16 v[68:83], v[52:55], a[128:131], v[68:83]
    ds_read_b64_tr_b16 v[208:209], v7 offset:53248
    ds_read_b64_tr_b16 v[210:211], v7 offset:54272
    ds_read_b64_tr_b16 v[212:213], v33 offset:53248
    s_add_u32 m0, s3, 98304
    s_add_u32 s71, s61, 0x160000
    buffer_load_dwordx4 v35, s[20:23], s71 offen lds
    s_waitcnt lgkmcnt(7)
    v_mfma_f32_32x32x16_bf16 v[36:51], v[56:59], a[128:131], 0
    ds_read_b64_tr_b16 v[214:215], v33 offset:54272
    ds_read_b64_tr_b16 v[216:217], v7 offset:55296
    ds_read_b64_tr_b16 v[218:219], v7 offset:56320
    buffer_load_dwordx4 v192, s[20:23], s71 offen offset:1024 lds
    s_waitcnt lgkmcnt(8)
    v_mfma_f32_32x32x16_bf16 v[68:83], v[196:199], a[132:135], v[68:83]
    ds_read_b64_tr_b16 v[220:221], v33 offset:55296
    ds_read_b64_tr_b16 v[222:223], v33 offset:56320
    v_add_u32 v7, 0xffff0000, v7
    v_add_u32 v33, 0xffff0000, v33
    buffer_load_dwordx4 v193, s[20:23], s71 offen offset:2048 lds
    s_waitcnt lgkmcnt(8)
    v_mfma_f32_32x32x16_bf16 v[36:51], v[200:203], a[132:135], v[36:51]
    buffer_load_dwordx4 v194, s[20:23], s71 offen offset:3072 lds
    s_barrier
    s_waitcnt lgkmcnt(6)
    v_mfma_f32_32x32x16_bf16 v[68:83], v[208:211], a[136:139], v[68:83]
    ds_read_b64_tr_b16 v[52:53], v7
    ds_read_b64_tr_b16 v[54:55], v7 offset:1024
    ds_read_b64_tr_b16 v[56:57], v33
    s_add_u32 m0, s3, 131072
    s_add_u32 s71, s61, 0x190000
    buffer_load_dwordx4 v35, s[20:23], s71 offen lds
    s_waitcnt lgkmcnt(7)
    v_mfma_f32_32x32x16_bf16 v[36:51], v[212:215], a[136:139], v[36:51]
    ds_read_b64_tr_b16 v[58:59], v33 offset:1024
    ds_read_b64_tr_b16 v[196:197], v7 offset:2048
    ds_read_b64_tr_b16 v[198:199], v7 offset:3072
    buffer_load_dwordx4 v192, s[20:23], s71 offen offset:1024 lds
    s_waitcnt lgkmcnt(8)
    v_mfma_f32_32x32x16_bf16 v[68:83], v[216:219], a[140:143], v[68:83]
    ds_read_b64_tr_b16 v[200:201], v33 offset:2048
    ds_read_b64_tr_b16 v[202:203], v33 offset:3072
    buffer_load_dwordx4 v193, s[20:23], s71 offen offset:2048 lds
    s_waitcnt lgkmcnt(8)
    v_mfma_f32_32x32x16_bf16 v[36:51], v[220:223], a[140:143], v[36:51]
    buffer_load_dwordx4 v194, s[20:23], s71 offen offset:3072 lds
    s_barrier
    s_waitcnt vmcnt(12) lgkmcnt(6)
    v_mfma_f32_32x32x16_bf16 v[68:83], v[52:55], a[144:147], v[68:83]
    ds_read_b64_tr_b16 v[208:209], v7 offset:4096
    ds_read_b64_tr_b16 v[210:211], v7 offset:5120
    ds_read_b64_tr_b16 v[212:213], v33 offset:4096
    s_add_u32 m0, s3, 147456
    s_add_u32 s71, s79, 0x10000
    buffer_load_dwordx4 v35, s[20:23], s71 offen lds
    s_waitcnt lgkmcnt(7)
    v_mfma_f32_32x32x16_bf16 v[36:51], v[56:59], a[144:147], v[36:51]
    ds_read_b64_tr_b16 v[214:215], v33 offset:5120
    ds_read_b64_tr_b16 v[216:217], v7 offset:6144
    ds_read_b64_tr_b16 v[218:219], v7 offset:7168
    buffer_load_dwordx4 v192, s[20:23], s71 offen offset:1024 lds
    s_waitcnt lgkmcnt(8)
    v_mfma_f32_32x32x16_bf16 v[68:83], v[196:199], a[148:151], v[68:83]
    ds_read_b64_tr_b16 v[220:221], v33 offset:6144
    ds_read_b64_tr_b16 v[222:223], v33 offset:7168
    buffer_load_dwordx4 v193, s[20:23], s71 offen offset:2048 lds
    s_waitcnt lgkmcnt(8)
    v_mfma_f32_32x32x16_bf16 v[36:51], v[200:203], a[148:151], v[36:51]
    buffer_load_dwordx4 v194, s[20:23], s71 offen offset:3072 lds
    s_waitcnt lgkmcnt(6)
    v_mfma_f32_32x32x16_bf16 v[68:83], v[208:211], a[152:155], v[68:83]
    ds_read_b64_tr_b16 v[52:53], v7 offset:16384
    ds_read_b64_tr_b16 v[54:55], v7 offset:17408
    ds_read_b64_tr_b16 v[56:57], v33 offset:16384
    s_mov_b32 s70, 0x12000
    buffer_load_dwordx4 a[176:179], v8, s[36:39], s70 offen sc1
    s_waitcnt lgkmcnt(7)
    v_mfma_f32_32x32x16_bf16 v[36:51], v[212:215], a[152:155], v[36:51]
    ds_read_b64_tr_b16 v[58:59], v33 offset:17408
    ds_read_b64_tr_b16 v[196:197], v7 offset:18432
    ds_read_b64_tr_b16 v[198:199], v7 offset:19456
    buffer_load_dwordx4 a[180:183], v8, s[36:39], s70 offen offset:1024 sc1
    s_waitcnt lgkmcnt(8)
    v_mfma_f32_32x32x16_bf16 v[68:83], v[216:219], a[156:159], v[68:83]
    ds_read_b64_tr_b16 v[200:201], v33 offset:18432
    ds_read_b64_tr_b16 v[202:203], v33 offset:19456
    buffer_load_dwordx4 a[184:187], v8, s[36:39], s70 offen offset:2048 sc1
    s_waitcnt lgkmcnt(8)
    v_mfma_f32_32x32x16_bf16 v[36:51], v[220:223], a[156:159], v[36:51]
    buffer_load_dwordx4 a[188:191], v8, s[36:39], s70 offen offset:3072 sc1
    s_barrier
    s_waitcnt vmcnt(16) lgkmcnt(6)
    v_mfma_f32_32x32x16_bf16 v[68:83], v[52:55], a[160:163], v[68:83]
    ds_read_b64_tr_b16 v[208:209], v7 offset:20480
    ds_read_b64_tr_b16 v[210:211], v7 offset:21504
    ds_read_b64_tr_b16 v[212:213], v33 offset:20480
    s_add_u32 m0, s3, 114688
    s_add_u32 s71, s79, 0x50000
    buffer_load_dwordx4 v35, s[20:23], s71 offen lds
    s_waitcnt lgkmcnt(7)
    v_mfma_f32_32x32x16_bf16 v[36:51], v[56:59], a[160:163], v[36:51]
    ds_read_b64_tr_b16 v[214:215], v33 offset:21504
    ds_read_b64_tr_b16 v[216:217], v7 offset:22528
    ds_read_b64_tr_b16 v[218:219], v7 offset:23552
    buffer_load_dwordx4 v192, s[20:23], s71 offen offset:1024 lds
    s_waitcnt lgkmcnt(8)
    v_mfma_f32_32x32x16_bf16 v[68:83], v[196:199], a[164:167], v[68:83]
    ds_read_b64_tr_b16 v[220:221], v33 offset:22528
    ds_read_b64_tr_b16 v[222:223], v33 offset:23552
    buffer_load_dwordx4 v193, s[20:23], s71 offen offset:2048 lds
    s_waitcnt lgkmcnt(8)
    v_mfma_f32_32x32x16_bf16 v[36:51], v[200:203], a[164:167], v[36:51]
    buffer_load_dwordx4 v194, s[20:23], s71 offen offset:3072 lds
    s_add_u32 s67, s101, 6
    v_mov_b32 v29, s67
    s_add_u32 s67, s66, 6
    v_mov_b32 v31, s67
    buffer_store_dword v29, v21, s[36:39], 0 offen
    s_cmp_eq_u32 s1, 0
    s_cbranch_scc1 L_fq_44
L_fqb_45:
    s_waitcnt lgkmcnt(6)
    v_mfma_f32_32x32x16_bf16 v[68:83], v[208:211], a[168:171], v[68:83]
    ds_read_b64_tr_b16 v[52:53], v7 offset:49152
    ds_read_b64_tr_b16 v[54:55], v7 offset:50176
    ds_read_b64_tr_b16 v[56:57], v33 offset:49152
    s_mov_b32 s70, 0x0
    buffer_load_dwordx4 a[192:195], v8, s[36:39], s70 offen sc1
    s_waitcnt lgkmcnt(7)
    v_mfma_f32_32x32x16_bf16 v[36:51], v[212:215], a[168:171], v[36:51]
    ds_read_b64_tr_b16 v[58:59], v33 offset:50176
    ds_read_b64_tr_b16 v[196:197], v7 offset:51200
    ds_read_b64_tr_b16 v[198:199], v7 offset:52224
    buffer_load_dwordx4 a[196:199], v8, s[36:39], s70 offen offset:1024 sc1
    s_waitcnt lgkmcnt(8)
    v_mfma_f32_32x32x16_bf16 v[68:83], v[216:219], a[172:175], v[68:83]
    ds_read_b64_tr_b16 v[200:201], v33 offset:51200
    ds_read_b64_tr_b16 v[202:203], v33 offset:52224
    buffer_load_dwordx4 a[200:203], v8, s[36:39], s70 offen offset:2048 sc1
    s_waitcnt lgkmcnt(8)
    v_mfma_f32_32x32x16_bf16 v[36:51], v[220:223], a[172:175], v[36:51]
    buffer_load_dwordx4 a[204:207], v8, s[36:39], s70 offen offset:3072 sc1
    s_barrier
    s_waitcnt vmcnt(9) lgkmcnt(6)
    v_mfma_f32_32x32x16_bf16 v[68:83], v[52:55], a[176:179], v[68:83]
    ds_read_b64_tr_b16 v[208:209], v7 offset:53248
    ds_read_b64_tr_b16 v[210:211], v7 offset:54272
    ds_read_b64_tr_b16 v[212:213], v33 offset:53248
    s_add_u32 m0, s3, 0
    s_add_u32 s71, s79, 0x90000
    buffer_load_dwordx4 v35, s[20:23], s71 offen lds
    s_waitcnt lgkmcnt(7)
    v_mfma_f32_32x32x16_bf16 v[36:51], v[56:59], a[176:179], v[36:51]
    ds_read_b64_tr_b16 v[214:215], v33 offset:54272
    ds_read_b64_tr_b16 v[216:217], v7 offset:55296
    ds_read_b64_tr_b16 v[218:219], v7 offset:56320
    buffer_load_dwordx4 v192, s[20:23], s71 offen offset:1024 lds
    s_waitcnt lgkmcnt(8)
    v_mfma_f32_32x32x16_bf16 v[68:83], v[196:199], a[180:183], v[68:83]
    ds_read_b64_tr_b16 v[220:221], v33 offset:55296
    ds_read_b64_tr_b16 v[222:223], v33 offset:56320
    v_add_u32 v7, 0x10000, v7
    v_add_u32 v33, 0x10000, v33
    buffer_load_dwordx4 v193, s[20:23], s71 offen offset:2048 lds
    s_waitcnt lgkmcnt(8)
    v_mfma_f32_32x32x16_bf16 v[36:51], v[200:203], a[180:183], v[36:51]
    buffer_load_dwordx4 v194, s[20:23], s71 offen offset:3072 lds
    s_waitcnt lgkmcnt(6)
    v_mfma_f32_32x32x16_bf16 v[68:83], v[208:211], a[184:187], v[68:83]
    ds_read_b64_tr_b16 v[52:53], v7
    ds_read_b64_tr_b16 v[54:55], v7 offset:1024
    ds_read_b64_tr_b16 v[56:57], v33
    s_mov_b32 s70, 0x2000
    buffer_load_dwordx4 a[208:211], v8, s[36:39], s70 offen sc1
    s_waitcnt lgkmcnt(7)
    v_mfma_f32_32x32x16_bf16 v[36:51], v[212:215], a[184:187], v[36:51]
    ds_read_b64_tr_b16 v[58:59], v33 offset:1024
    ds_read_b64_tr_b16 v[196:197], v7 offset:2048
    ds_read_b64_tr_b16 v[198:199], v7 offset:3072
    buffer_load_dwordx4 a[212:215], v8, s[36:39], s70 offen offset:1024 sc1
    s_waitcnt lgkmcnt(8)
    v_mfma_f32_32x32x16_bf16 v[68:83], v[216:219], a[188:191], v[68:83]
    ds_read_b64_tr_b16 v[200:201], v33 offset:2048
    ds_read_b64_tr_b16 v[202:203], v33 offset:3072
    buffer_load_dwordx4 a[216:219], v8, s[36:39], s70 offen offset:2048 sc1
    s_waitcnt lgkmcnt(8)
    v_mfma_f32_32x32x16_bf16 v[36:51], v[220:223], a[188:191], v[36:51]
    buffer_load_dwordx4 a[220:223], v8, s[36:39], s70 offen offset:3072 sc1
    s_barrier
    s_waitcnt vmcnt(8) lgkmcnt(6)
    v_mfma_f32_32x32x16_bf16 v[68:83], v[52:55], a[192:195], v[68:83]
    ds_read_b64_tr_b16 v[208:209], v7 offset:4096
    ds_read_b64_tr_b16 v[210:211], v7 offset:5120
    ds_read_b64_tr_b16 v[212:213], v33 offset:4096
    s_add_u32 m0, s3, 16384
    s_add_u32 s71, s79, 0xd0000
    buffer_load_dwordx4 v35, s[20:23], s71 offen lds
    s_waitcnt lgkmcnt(7)
    v_mfma_f32_32x32x16_bf16 v[36:51], v[56:59], a[192:195], v[36:51]
    ds_read_b64_tr_b16 v[214:215], v33 offset:5120
    ds_read_b64_tr_b16 v[216:217], v7 offset:6144
    ds_read_b64_tr_b16 v[218:219], v7 offset:7168
    buffer_load_dwordx4 v192, s[20:23], s71 offen offset:1024 lds
    s_waitcnt lgkmcnt(8)
    v_mfma_f32_32x32x16_bf16 v[68:83], v[196:199], a[196:199], v[68:83]
    ds_read_b64_tr_b16 v[220:221], v33 offset:6144
    ds_read_b64_tr_b16 v[222:223], v33 offset:7168
    buffer_load_dwordx4 v193, s[20:23], s71 offen offset:2048 lds
    s_waitcnt lgkmcnt(8)
    v_mfma_f32_32x32x16_bf16 v[36:51], v[200:203], a[196:199], v[36:51]
    buffer_load_dwordx4 v194, s[20:23], s71 offen offset:3072 lds
    buffer_load_dword v23, v22, s[36:39], 0 offen sc1
    s_waitcnt lgkmcnt(6)
    v_mfma_f32_32x32x16_bf16 v[68:83], v[208:211], a[200:203], v[68:83]
    ds_read_b64_tr_b16 v[52:53], v7 offset:16384
    ds_read_b64_tr_b16 v[54:55], v7 offset:17408
    ds_read_b64_tr_b16 v[56:57], v33 offset:16384
    s_mov_b32 s70, 0x4000
    buffer_load_dwordx4 a[224:227], v8, s[36:39], s70 offen sc1
    s_waitcnt lgkmcnt(7)
    v_mfma_f32_32x32x16_bf16 v[36:51], v[212:215], a[200:203], v[36:51]
    ds_read_b64_tr_b16 v[58:59], v33 offset:17408
    ds_read_b64_tr_b16 v[196:197], v7 offset:18432
    ds_read_b64_tr_b16 v[198:199], v7 offset:19456
    buffer_load_dwordx4 a[228:231], v8, s[36:39], s70 offen offset:1024 sc1
    s_waitcnt lgkmcnt(8)
    v_mfma_f32_32x32x16_bf16 v[68:83], v[216:219], a[204:207], v[68:83]
    ds_read_b64_tr_b16 v[200:201], v33 offset:18432
    ds_read_b64_tr_b16 v[202:203], v33 offset:19456
    buffer_load_dwordx4 a[232:235], v8, s[36:39], s70 offen offset:2048 sc1
    s_waitcnt lgkmcnt(8)
    v_mfma_f32_32x32x16_bf16 v[36:51], v[220:223], a[204:207], v[36:51]
    buffer_load_dwordx4 a[236:239], v8, s[36:39], s70 offen offset:3072 sc1
    s_barrier
    s_waitcnt vmcnt(9) lgkmcnt(6)
    v_mfma_f32_32x32x16_bf16 v[68:83], v[52:55], a[208:211], v[68:83]
    ds_read_b64_tr_b16 v[208:209], v7 offset:20480
    ds_read_b64_tr_b16 v[210:211], v7 offset:21504
    ds_read_b64_tr_b16 v[212:213], v33 offset:20480
    s_add_u32 m0, s3, 49152
    s_add_u32 s71, s47, 0x110000
    buffer_load_dwordx4 v35, s[20:23], s71 offen lds
    s_waitcnt lgkmcnt(7)
    v_mfma_f32_32x32x16_bf16 v[36:51], v[56:59], a[208:211], v[36:51]
    ds_read_b64_tr_b16 v[214:215], v33 offset:21504
    ds_read_b64_tr_b16 v[216:217], v7 offset:22528
    ds_read_b64_tr_b16 v[218:219], v7 offset:23552
    buffer_load_dwordx4 v192, s[20:23], s71 offen offset:1024 lds
    s_waitcnt lgkmcnt(8)
    v_mfma_f32_32x32x16_bf16 v[68:83], v[196:199], a[212:215], v[68:83]
    ds_read_b64_tr_b16 v[220:221], v33 offset:22528
    ds_read_b64_tr_b16 v[222:223], v33 offset:23552
    buffer_load_dwordx4 v193, s[20:23], s71 offen offset:2048 lds
    s_waitcnt lgkmcnt(8)
    v_mfma_f32_32x32x16_bf16 v[36:51], v[200:203], a[212:215], v[36:51]
    buffer_load_dwordx4 v194, s[20:23], s71 offen offset:3072 lds
    s_waitcnt lgkmcnt(6)
    v_mfma_f32_32x32x16_bf16 v[68:83], v[208:211], a[216:219], v[68:83]
    ds_read_b64_tr_b16 v[52:53], v7 offset:32768
    ds_read_b64_tr_b16 v[54:55], v7 offset:33792
    ds_read_b64_tr_b16 v[56:57], v33 offset:32768
    s_mov_b32 s70, 0x6000
    buffer_load_dwordx4 a[240:243], v8, s[36:39], s70 offen sc1
    s_waitcnt lgkmcnt(7)
    v_mfma_f32_32x32x16_bf16 v[36:51], v[212:215], a[216:219], v[36:51]
    ds_read_b64_tr_b16 v[58:59], v33 offset:33792
    ds_read_b64_tr_b16 v[196:197], v7 offset:34816
    ds_read_b64_tr_b16 v[198:199], v7 offset:35840
    buffer_load_dwordx4 a[244:247], v8, s[36:39], s70 offen offset:1024 sc1
    s_waitcnt lgkmcnt(8)
    v_mfma_f32_32x32x16_bf16 v[68:83], v[216:219], a[220:223], v[68:83]
    ds_read_b64_tr_b16 v[200:201], v33 offset:34816
    ds_read_b64_tr_b16 v[202:203], v33 offset:35840
    buffer_load_dwordx4 a[248:251], v8, s[36:39], s70 offen offset:2048 sc1
    s_waitcnt lgkmcnt(8)
    v_mfma_f32_32x32x16_bf16 v[36:51], v[220:223], a[220:223], v[36:51]
    buffer_load_dwordx4 a[252:255], v8, s[36:39], s70 offen offset:3072 sc1
    s_barrier
    s_waitcnt vmcnt(8) lgkmcnt(6)
    v_mfma_f32_32x32x16_bf16 v[68:83], v[52:55], a[224:227], v[68:83]
    ds_read_b64_tr_b16 v[208:209], v7 offset:36864
    ds_read_b64_tr_b16 v[210:211], v7 offset:37888
    ds_read_b64_tr_b16 v[212:213], v33 offset:36864
    s_add_u32 m0, s3, 65536
    s_add_u32 s71, s47, 0x170000
    buffer_load_dwordx4 v35, s[20:23], s71 offen lds
    s_waitcnt lgkmcnt(7)
    v_mfma_f32_32x32x16_bf16 v[36:51], v[56:59], a[224:227], v[36:51]
    ds_read_b64_tr_b16 v[214:215], v33 offset:37888
    ds_read_b64_tr_b16 v[216:217], v7 offset:38912
    ds_read_b64_tr_b16 v[218:219], v7 offset:39936
    buffer_load_dwordx4 v192, s[20:23], s71 offen offset:1024 lds
    s_waitcnt lgkmcnt(8)
    v_mfma_f32_32x32x16_bf16 v[68:83], v[196:199], a[228:231], v[68:83]
    ds_read_b64_tr_b16 v[220:221], v33 offset:38912
    ds_read_b64_tr_b16 v[222:223], v33 offset:39936
    v_add_u32 v7, 0x10000, v7
    v_add_u32 v33, 0x10000, v33
    buffer_load_dwordx4 v193, s[20:23], s71 offen offset:2048 lds
    s_waitcnt lgkmcnt(8)
    v_mfma_f32_32x32x16_bf16 v[36:51], v[200:203], a[228:231], v[36:51]
    buffer_load_dwordx4 v194, s[20:23], s71 offen offset:3072 lds
    v_subrev_u32 v23, s101, v23
    v_cmp_gt_u32 vcc, 8, v23
    s_nop 1
    v_cndmask_b32 v23, 0, v23, vcc
    v_cmp_lt_u32 vcc, v23, v12
    s_nop 1
    s_cbranch_vccnz L_slow_46
L_back_47:
    s_waitcnt lgkmcnt(6)
    v_mfma_f32_32x32x16_bf16 v[68:83], v[208:211], a[232:235], v[68:83]
    ds_read_b64_tr_b16 v[52:53], v7
    ds_read_b64_tr_b16 v[54:55], v7 offset:1024
    ds_read_b64_tr_b16 v[56:57], v33
    s_mov_b32 s70, 0x14000
    buffer_load_dwordx4 a[128:131], v8, s[36:39], s70 offen sc1
    s_waitcnt lgkmcnt(7)
    v_mfma_f32_32x32x16_bf16 v[36:51], v[212:215], a[232:235], v[36:51]
    ds_read_b64_tr_b16 v[58:59], v33 offset:1024
    ds_read_b64_tr_b16 v[196:197], v7 offset:2048
    ds_read_b64_tr_b16 v[198:199], v7 offset:3072
    buffer_load_dwordx4 a[132:135], v8, s[36:39], s70 offen offset:1024 sc1
    s_waitcnt lgkmcnt(8)
    v_mfma_f32_32x32x16_bf16 v[68:83], v[216:219], a[236:239], v[68:83]
    ds_read_b64_tr_b16 v[200:201], v33 offset:2048
    ds_read_b64_tr_b16 v[202:203], v33 offset:3072
    buffer_load_dwordx4 a[136:139], v8, s[36:39], s70 offen offset:2048 sc1
    s_waitcnt lgkmcnt(8)
    v_mfma_f32_32x32x16_bf16 v[36:51], v[220:223], a[236:239], v[36:51]
    buffer_load_dwordx4 a[140:143], v8, s[36:39], s70 offen offset:3072 sc1
    s_barrier
    s_waitcnt vmcnt(8) lgkmcnt(6)
    v_mfma_f32_32x32x16_bf16 v[68:83], v[52:55], a[240:243], v[68:83]
    ds_read_b64_tr_b16 v[208:209], v7 offset:4096
    ds_read_b64_tr_b16 v[210:211], v7 offset:5120
    ds_read_b64_tr_b16 v[212:213], v33 offset:4096
    s_add_u32 m0, s3, 81920
    s_mov_b32 s71, 0x0
    buffer_load_dwordx4 v35, s[24:27], s71 offen lds
    s_waitcnt lgkmcnt(7)
    v_mfma_f32_32x32x16_bf16 v[36:51], v[56:59], a[240:243], v[36:51]
    ds_read_b64_tr_b16 v[214:215], v33 offset:5120
    ds_read_b64_tr_b16 v[216:217], v7 offset:6144
    ds_read_b64_tr_b16 v[218:219], v7 offset:7168
    buffer_load_dwordx4 v192, s[24:27], s71 offen offset:1024 lds
    s_waitcnt lgkmcnt(8)
    v_mfma_f32_32x32x16_bf16 v[68:83], v[196:199], a[244:247], v[68:83]
    ds_read_b64_tr_b16 v[220:221], v33 offset:6144
    ds_read_b64_tr_b16 v[222:223], v33 offset:7168
    buffer_load_dwordx4 v193, s[24:27], s71 offen offset:2048 lds
    s_waitcnt lgkmcnt(8)
    v_mfma_f32_32x32x16_bf16 v[36:51], v[200:203], a[244:247], v[36:51]
    buffer_load_dwordx4 v194, s[24:27], s71 offen offset:3072 lds
    s_waitcnt lgkmcnt(6)
    v_mfma_f32_32x32x16_bf16 v[68:83], v[208:211], a[248:251], v[68:83]
    ds_read_b64_tr_b16 v[52:53], v7 offset:16384
    ds_read_b64_tr_b16 v[54:55], v7 offset:17408
    ds_read_b64_tr_b16 v[56:57], v33 offset:16384
    s_mov_b32 s70, 0x16000
    buffer_load_dwordx4 a[144:147], v8, s[36:39], s70 offen sc1
    s_waitcnt lgkmcnt(7)
    v_mfma_f32_32x32x16_bf16 v[36:51], v[212:215], a[248:251], v[36:51]
    ds_read_b64_tr_b16 v[58:59], v33 offset:17408
    ds_read_b64_tr_b16 v[196:197], v7 offset:18432
    ds_read_b64_tr_b16 v[198:199], v7 offset:19456
    buffer_load_dwordx4 a[148:151], v8, s[36:39], s70 offen offset:1024 sc1
    s_waitcnt lgkmcnt(8)
    v_mfma_f32_32x32x16_bf16 v[68:83], v[216:219], a[252:255], v[68:83]
    ds_read_b64_tr_b16 v[200:201], v33 offset:18432
    ds_read_b64_tr_b16 v[202:203], v33 offset:19456
    buffer_load_dwordx4 a[152:155], v8, s[36:39], s70 offen offset:2048 sc1
    s_waitcnt lgkmcnt(8)
    v_mfma_f32_32x32x16_bf16 v[36:51], v[220:223], a[252:255], v[36:51]
    buffer_load_dwordx4 a[156:159], v8, s[36:39], s70 offen offset:3072 sc1
    s_barrier
    s_waitcnt vmcnt(8) lgkmcnt(6)
    v_mfma_f32_32x32x16_bf16 v[68:83], v[52:55], a[128:131], v[68:83]
    ds_read_b64_tr_b16 v[208:209], v7 offset:20480
    ds_read_b64_tr_b16 v[210:211], v7 offset:21504
    ds_read_b64_tr_b16 v[212:213], v33 offset:20480
    s_add_u32 m0, s3, 98304
    s_mov_b32 s71, 0x20000
    buffer_load_dwordx4 v35, s[24:27], s71 offen lds
    s_waitcnt lgkmcnt(7)
    v_mfma_f32_32x32x16_bf16 v[36:51], v[56:59], a[128:131], v[36:51]
    ds_read_b64_tr_b16 v[214:215], v33 offset:21504
    ds_read_b64_tr_b16 v[216:217], v7 offset:22528
    ds_read_b64_tr_b16 v[218:219], v7 offset:23552
    buffer_load_dwordx4 v192, s[24:27], s71 offen offset:1024 lds
    s_waitcnt lgkmcnt(8)
    v_mfma_f32_32x32x16_bf16 v[68:83], v[196:199], a[132:135], v[68:83]
    ds_read_b64_tr_b16 v[220:221], v33 offset:22528
    ds_read_b64_tr_b16 v[222:223], v33 offset:23552
    v_add_u32 v7, 0xffff0000, v7
    v_add_u32 v33, 0xffff0000, v33
    buffer_load_dwordx4 v193, s[24:27], s71 offen offset:2048 lds
    s_waitcnt lgkmcnt(8)
    v_mfma_f32_32x32x16_bf16 v[36:51], v[200:203], a[132:135], v[36:51]
    buffer_load_dwordx4 v194, s[24:27], s71 offen offset:3072 lds
    s_waitcnt lgkmcnt(6)
    v_mfma_f32_32x32x16_bf16 v[68:83], v[208:211], a[136:139], v[68:83]
    ds_read_b64_tr_b16 v[52:53], v7 offset:49152
    ds_read_b64_tr_b16 v[54:55], v7 offset:50176
    ds_read_b64_tr_b16 v[56:57], v33 offset:49152
    s_mov_b32 s70, 0x18000
    buffer_load_dwordx4 a[160:163], v8, s[36:39], s70 offen sc1
    s_waitcnt lgkmcnt(7)
    v_mfma_f32_32x32x16_bf16 v[36:51], v[212:215], a[136:139], v[36:51]
    ds_read_b64_tr_b16 v[58:59], v33 offset:50176
    ds_read_b64_tr_b16 v[196:197], v7 offset:51200
    ds_read_b64_tr_b16 v[198:199], v7 offset:52224
    buffer_load_dwordx4 a[164:167], v8, s[36:39], s70 offen offset:1024 sc1
    s_waitcnt lgkmcnt(8)
    v_mfma_f32_32x32x16_bf16 v[68:83], v[216:219], a[140:143], v[68:83]
    ds_read_b64_tr_b16 v[200:201], v33 offset:51200
    ds_read_b64_tr_b16 v[202:203], v33 offset:52224
    buffer_load_dwordx4 a[168:171], v8, s[36:39], s70 offen offset:2048 sc1
    s_waitcnt lgkmcnt(8)
    v_mfma_f32_32x32x16_bf16 v[36:51], v[220:223], a[140:143], v[36:51]
    buffer_load_dwordx4 a[172:175], v8, s[36:39], s70 offen offset:3072 sc1
    s_barrier
    s_waitcnt vmcnt(8) lgkmcnt(6)
    v_mfma_f32_32x32x16_bf16 v[68:83], v[52:55], a[144:147], v[68:83]
    ds_read_b64_tr_b16 v[208:209], v7 offset:53248
    ds_read_b64_tr_b16 v[210:211], v7 offset:54272
    ds_read_b64_tr_b16 v[212:213], v33 offset:53248
    s_add_u32 m0, s3, 131072
    s_mov_b32 s71, 0x40000
    buffer_load_dwordx4 v35, s[24:27], s71 offen lds
    s_waitcnt lgkmcnt(7)
    v_mfma_f32_32x32x16_bf16 v[36:51], v[56:59], a[144:147], v[36:51]
    ds_read_b64_tr_b16 v[214:215], v33 offset:54272
    ds_read_b64_tr_b16 v[216:217], v7 offset:55296
    ds_read_b64_tr_b16 v[218:219], v7 offset:56320
    buffer_load_dwordx4 v192, s[24:27], s71 offen offset:1024 lds
    s_waitcnt lgkmcnt(8)
    v_mfma_f32_32x32x16_bf16 v[68:83], v[196:199], a[148:151], v[68:83]
    ds_read_b64_tr_b16 v[220:221], v33 offset:55296
    ds_read_b64_tr_b16 v[222:223], v33 offset:56320
    v_add_u32 v7, 0xffff0000, v7
    v_add_u32 v33, 0xffff0000, v33
    buffer_load_dwordx4 v193, s[24:27], s71 offen offset:2048 lds
    s_waitcnt lgkmcnt(8)
    v_mfma_f32_32x32x16_bf16 v[36:51], v[200:203], a[148:151], v[36:51]
    buffer_load_dwordx4 v194, s[24:27], s71 offen offset:3072 lds
    s_waitcnt lgkmcnt(6)
    v_mfma_f32_32x32x16_bf16 v[68:83], v[208:211], a[152:155], v[68:83]
    ds_read_b64_tr_b16 v[52:53], v7
    ds_read_b64_tr_b16 v[54:55], v7 offset:1024
    ds_read_b64_tr_b16 v[56:57], v33
    s_mov_b32 s70, 0x1a000
    buffer_load_dwordx4 a[176:179], v8, s[36:39], s70 offen sc1
    s_waitcnt lgkmcnt(7)
    v_mfma_f32_32x32x16_bf16 v[36:51], v[212:215], a[152:155], v[36:51]
    ds_read_b64_tr_b16 v[58:59], v33 offset:1024
    ds_read_b64_tr_b16 v[196:197], v7 offset:2048
    ds_read_b64_tr_b16 v[198:199], v7 offset:3072
    buffer_load_dwordx4 a[180:183], v8, s[36:39], s70 offen offset:1024 sc1
    s_waitcnt lgkmcnt(8)
    v_mfma_f32_32x32x16_bf16 v[68:83], v[216:219], a[156:159], v[68:83]
    ds_read_b64_tr_b16 v[200:201], v33 offset:2048
    ds_read_b64_tr_b16 v[202:203], v33 offset:3072
    buffer_load_dwordx4 a[184:187], v8, s[36:39], s70 offen offset:2048 sc1
    s_waitcnt lgkmcnt(8)
    v_mfma_f32_32x32x16_bf16 v[36:51], v[220:223], a[156:159], v[36:51]
    buffer_load_dwordx4 a[188:191], v8, s[36:39], s70 offen offset:3072 sc1
    s_barrier
    s_waitcnt vmcnt(8) lgkmcnt(6)
    v_mfma_f32_32x32x16_bf16 v[68:83], v[52:55], a[160:163], v[68:83]
    ds_read_b64_tr_b16 v[208:209], v7 offset:4096
    ds_read_b64_tr_b16 v[210:211], v7 offset:5120
    ds_read_b64_tr_b16 v[212:213], v33 offset:4096
    s_add_u32 m0, s3, 147456
    s_mov_b32 s71, 0x60000
    buffer_load_dwordx4 v35, s[24:27], s71 offen lds
    s_waitcnt lgkmcnt(7)
    v_mfma_f32_32x32x16_bf16 v[36:51], v[56:59], a[160:163], v[36:51]
    ds_read_b64_tr_b16 v[214:215], v33 offset:5120
    ds_read_b64_tr_b16 v[216:217], v7 offset:6144
    ds_read_b64_tr_b16 v[218:219], v7 offset:7168
    buffer_load_dwordx4 v192, s[24:27], s71 offen offset:1024 lds
    s_waitcnt lgkmcnt(8)
    v_mfma_f32_32x32x16_bf16 v[68:83], v[196:199], a[164:167], v[68:83]
    ds_read_b64_tr_b16 v[220:221], v33 offset:6144
    ds_read_b64_tr_b16 v[222:223], v33 offset:7168
    buffer_load_dwordx4 v193, s[24:27], s71 offen offset:2048 lds
    s_waitcnt lgkmcnt(8)
    v_mfma_f32_32x32x16_bf16 v[36:51], v[200:203], a[164:167], v[36:51]
    buffer_load_dwordx4 v194, s[24:27], s71 offen offset:3072 lds
    s_waitcnt lgkmcnt(6)
    v_mfma_f32_32x32x16_bf16 v[68:83], v[208:211], a[168:171], v[68:83]
    ds_read_b64_tr_b16 v[52:53], v7 offset:16384
    ds_read_b64_tr_b16 v[54:55], v7 offset:17408
    ds_read_b64_tr_b16 v[56:57], v33 offset:16384
    s_mov_b32 s70, 0x8000
    buffer_load_dwordx4 a[192:195], v8, s[36:39], s70 offen sc1
    s_and_b32 s67, s62, 1
    s_lshl_b32 s67, s67, 13
    s_waitcnt lgkmcnt(7)
    v_mfma_f32_32x32x16_bf16 v[36:51], v[212:215], a[168:171], v[36:51]
    ds_read_b64_tr_b16 v[58:59], v33 offset:17408
    ds_read_b64_tr_b16 v[196:197], v7 offset:18432
    ds_read_b64_tr_b16 v[198:199], v7 offset:19456
    buffer_load_dwordx4 a[196:199], v8, s[36:39], s70 offen offset:1024 sc1
    s_lshr_b32 s68, s62, 1
    s_mul_i32 s68, s68, 16512
    s_add_u32 s67, s67, s68
    s_waitcnt lgkmcnt(8)
    v_mfma_f32_32x32x16_bf16 v[68:83], v[216:219], a[172:175], v[68:83]
    ds_read_b64_tr_b16 v[200:201], v33 offset:18432
    ds_read_b64_tr_b16 v[202:203], v33 offset:19456
    buffer_load_dwordx4 a[200:203], v8, s[36:39], s70 offen offset:2048 sc1
    s_add_u32 s67, s67, 0
    v_and_b32 v3, 31, v1
    v_lshl_add_u32 v3, v3, 8, s67
    v_lshrrev_b32 v4, 5, v1
    s_waitcnt lgkmcnt(8)
    v_mfma_f32_32x32x16_bf16 v[36:51], v[220:223], a[172:175], v[36:51]
    buffer_load_dwordx4 a[204:207], v8, s[36:39], s70 offen offset:3072 sc1
    v_xor_b32 v4, v4, v1
    v_and_b32 v4, 7, v4
    v_xor_b32 v5, 0, v4
    v_lshl_add_u32 v84, v5, 4, v3
    v_xor_b32 v88, 128, v84
    v_xor_b32 v5, 2, v4
    s_barrier
    s_waitcnt vmcnt(8) lgkmcnt(6)
    v_mfma_f32_32x32x16_bf16 v[68:83], v[52:55], a[176:179], v[68:83]
    ds_read_b64_tr_b16 v[208:209], v7 offset:20480
    ds_read_b64_tr_b16 v[210:211], v7 offset:21504
    ds_read_b64_tr_b16 v[212:213], v33 offset:20480
    s_mov_b32 s70, 0xa000
    buffer_load_dwordx4 a[208:211], v8, s[36:39], s70 offen sc1
    v_lshl_add_u32 v85, v5, 4, v3
    v_xor_b32 v89, 128, v85
    s_waitcnt lgkmcnt(7)
    v_mfma_f32_32x32x16_bf16 v[36:51], v[56:59], a[176:179], v[36:51]
    ds_read_b64_tr_b16 v[214:215], v33 offset:21504
    ds_read_b64_tr_b16 v[216:217], v7 offset:22528
    ds_read_b64_tr_b16 v[218:219], v7 offset:23552
    buffer_load_dwordx4 a[212:215], v8, s[36:39], s70 offen offset:1024 sc1
    v_xor_b32 v5, 4, v4
    v_lshl_add_u32 v86, v5, 4, v3
    v_xor_b32 v90, 128, v86
    s_waitcnt lgkmcnt(8)
    v_mfma_f32_32x32x16_bf16 v[68:83], v[196:199], a[180:183], v[68:83]
    ds_read_b64_tr_b16 v[220:221], v33 offset:22528
    ds_read_b64_tr_b16 v[222:223], v33 offset:23552
    buffer_load_dwordx4 a[216:219], v8, s[36:39], s70 offen offset:2048 sc1
    v_xor_b32 v5, 6, v4
    v_lshl_add_u32 v87, v5, 4, v3
    v_xor_b32 v91, 128, v87
    v_lshrrev_b32 v3, 3, v1
    s_waitcnt lgkmcnt(8)
    v_mfma_f32_32x32x16_bf16 v[36:51], v[200:203], a[180:183], v[36:51]
    buffer_load_dwordx4 a[220:223], v8, s[36:39], s70 offen offset:3072 sc1
    v_and_b32 v4, 7, v1
    v_lshlrev_b32 v4, 1, v4
    v_xor_b32 v4, v4, v3
    s_lshl_b32 s67, s62, 12
    s_add_u32 s67, s67, 0
    v_lshl_add_u32 v3, v3, 8, s67
    s_waitcnt lgkmcnt(6)
    v_mfma_f32_32x32x16_bf16 v[68:83], v[208:211], a[184:187], v[68:83]
    ds_read_b64_tr_b16 v[52:53], v7 offset:49152
    ds_read_b64_tr_b16 v[54:55], v7 offset:50176
    ds_read_b64_tr_b16 v[56:57], v33 offset:49152
    s_mov_b32 s70, 0x1c000
    buffer_load_dwordx4 a[224:227], v8, s[36:39], s70 offen sc1
    v_lshl_add_u32 v92, v4, 4, v3
    v_xor_b32 v93, 16, v92
    s_waitcnt lgkmcnt(7)
    v_mfma_f32_32x32x16_bf16 v[36:51], v[212:215], a[184:187], v[36:51]
    ds_read_b64_tr_b16 v[58:59], v33 offset:50176
    ds_read_b64_tr_b16 v[196:197], v7 offset:51200
    ds_read_b64_tr_b16 v[198:199], v7 offset:52224
    buffer_load_dwordx4 a[228:231], v8, s[36:39], s70 offen offset:1024 sc1
    s_waitcnt lgkmcnt(8)
    v_mfma_f32_32x32x16_bf16 v[68:83], v[216:219], a[188:191], v[68:83]
    ds_read_b64_tr_b16 v[200:201], v33 offset:51200
    ds_read_b64_tr_b16 v[202:203], v33 offset:52224
    buffer_load_dwordx4 a[232:235], v8, s[36:39], s70 offen offset:2048 sc1
    s_waitcnt lgkmcnt(8)
    v_mfma_f32_32x32x16_bf16 v[36:51], v[220:223], a[188:191], v[36:51]
    buffer_load_dwordx4 a[236:239], v8, s[36:39], s70 offen offset:3072 sc1
    s_barrier
    s_waitcnt vmcnt(8) lgkmcnt(6)
    v_mfma_f32_32x32x16_bf16 v[68:83], v[52:55], a[192:195], v[68:83]
    ds_read_b64_tr_b16 v[208:209], v7 offset:53248
    ds_read_b64_tr_b16 v[210:211], v7 offset:54272
    ds_read_b64_tr_b16 v[212:213], v33 offset:53248
    s_mov_b32 s70, 0x1e000
    buffer_load_dwordx4 a[240:243], v8, s[36:39], s70 offen sc1
    s_waitcnt lgkmcnt(7)
    v_mfma_f32_32x32x16_bf16 v[36:51], v[56:59], a[192:195], v[36:51]
    ds_read_b64_tr_b16 v[214:215], v33 offset:54272
    ds_read_b64_tr_b16 v[216:217], v7 offset:55296
    ds_read_b64_tr_b16 v[218:219], v7 offset:56320
    buffer_load_dwordx4 a[244:247], v8, s[36:39], s70 offen offset:1024 sc1
    s_waitcnt lgkmcnt(8)
    v_mfma_f32_32x32x16_bf16 v[68:83], v[196:199], a[196:199], v[68:83]
    ds_read_b64_tr_b16 v[220:221], v33 offset:55296
    ds_read_b64_tr_b16 v[222:223], v33 offset:56320
    v_add_u32 v7, 0x10000, v7
    v_add_u32 v33, 0x10000, v33
    buffer_load_dwordx4 a[248:251], v8, s[36:39], s70 offen offset:2048 sc1
    s_waitcnt lgkmcnt(8)
    v_mfma_f32_32x32x16_bf16 v[36:51], v[200:203], a[196:199], v[36:51]
    buffer_load_dwordx4 a[252:255], v8, s[36:39], s70 offen offset:3072 sc1
    s_waitcnt lgkmcnt(6)
    v_mfma_f32_32x32x16_bf16 v[68:83], v[208:211], a[200:203], v[68:83]
    ds_read_b64_tr_b16 v[52:53], v7
    ds_read_b64_tr_b16 v[54:55], v7 offset:1024
    ds_read_b64_tr_b16 v[56:57], v33
    s_waitcnt lgkmcnt(7)
    v_mfma_f32_32x32x16_bf16 v[36:51], v[212:215], a[200:203], v[36:51]
    ds_read_b64_tr_b16 v[58:59], v33 offset:1024
    ds_read_b64_tr_b16 v[196:197], v7 offset:2048
    ds_read_b64_tr_b16 v[198:199], v7 offset:3072
    s_waitcnt lgkmcnt(8)
    v_mfma_f32_32x32x16_bf16 v[68:83], v[216:219], a[204:207], v[68:83]
    ds_read_b64_tr_b16 v[200:201], v33 offset:2048
    ds_read_b64_tr_b16 v[202:203], v33 offset:3072
    s_waitcnt lgkmcnt(8)
    v_mfma_f32_32x32x16_bf16 v[36:51], v[220:223], a[204:207], v[36:51]
    s_barrier
    s_waitcnt vmcnt(8) lgkmcnt(6)
    v_mfma_f32_32x32x16_bf16 v[68:83], v[52:55], a[208:211], v[68:83]
    ds_read_b64_tr_b16 v[208:209], v7 offset:4096
    ds_read_b64_tr_b16 v[210:211], v7 offset:5120
    ds_read_b64_tr_b16 v[212:213], v33 offset:4096
    s_mov_b32 s70, 0x20000
    buffer_load_dwordx4 a[128:131], v8, s[36:39], s70 offen sc1
    s_waitcnt lgkmcnt(7)
    v_mfma_f32_32x32x16_bf16 v[36:51], v[56:59], a[208:211], v[36:51]
    ds_read_b64_tr_b16 v[214:215], v33 offset:5120
    ds_read_b64_tr_b16 v[216:217], v7 offset:6144
    ds_read_b64_tr_b16 v[218:219], v7 offset:7168
    buffer_load_dwordx4 a[132:135], v8, s[36:39], s70 offen offset:1024 sc1
    s_waitcnt lgkmcnt(8)
    v_mfma_f32_32x32x16_bf16 v[68:83], v[196:199], a[212:215], v[68:83]
    ds_read_b64_tr_b16 v[220:221], v33 offset:6144
    ds_read_b64_tr_b16 v[222:223], v33 offset:7168
    buffer_load_dwordx4 a[136:139], v8, s[36:39], s70 offen offset:2048 sc1
    s_waitcnt lgkmcnt(8)
    v_mfma_f32_32x32x16_bf16 v[36:51], v[200:203], a[212:215], v[36:51]
    buffer_load_dwordx4 a[140:143], v8, s[36:39], s70 offen offset:3072 sc1
    s_waitcnt lgkmcnt(6)
    v_mfma_f32_32x32x16_bf16 v[68:83], v[208:211], a[216:219], v[68:83]
    ds_read_b64_tr_b16 v[52:53], v7 offset:16384
    ds_read_b64_tr_b16 v[54:55], v7 offset:17408
    ds_read_b64_tr_b16 v[56:57], v33 offset:16384
    s_waitcnt lgkmcnt(7)
    v_mfma_f32_32x32x16_bf16 v[36:51], v[212:215], a[216:219], v[36:51]
    ds_read_b64_tr_b16 v[58:59], v33 offset:17408
    ds_read_b64_tr_b16 v[196:197], v7 offset:18432
    ds_read_b64_tr_b16 v[198:199], v7 offset:19456
    s_waitcnt lgkmcnt(8)
    v_mfma_f32_32x32x16_bf16 v[68:83], v[216:219], a[220:223], v[68:83]
    ds_read_b64_tr_b16 v[200:201], v33 offset:18432
    ds_read_b64_tr_b16 v[202:203], v33 offset:19456
    s_waitcnt lgkmcnt(8)
    v_mfma_f32_32x32x16_bf16 v[36:51], v[220:223], a[220:223], v[36:51]
    s_barrier
    s_waitcnt vmcnt(8) lgkmcnt(6)
    v_mfma_f32_32x32x16_bf16 v[68:83], v[52:55], a[224:227], v[68:83]
    ds_read_b64_tr_b16 v[208:209], v7 offset:20480
    ds_read_b64_tr_b16 v[210:211], v7 offset:21504
    ds_read_b64_tr_b16 v[212:213], v33 offset:20480
    s_mov_b32 s70, 0x22000
    buffer_load_dwordx4 a[144:147], v8, s[36:39], s70 offen sc1
    s_waitcnt lgkmcnt(7)
    v_mfma_f32_32x32x16_bf16 v[36:51], v[56:59], a[224:227], v[36:51]
    ds_read_b64_tr_b16 v[214:215], v33 offset:21504
    ds_read_b64_tr_b16 v[216:217], v7 offset:22528
    ds_read_b64_tr_b16 v[218:219], v7 offset:23552
    buffer_load_dwordx4 a[148:151], v8, s[36:39], s70 offen offset:1024 sc1
    s_waitcnt lgkmcnt(8)
    v_mfma_f32_32x32x16_bf16 v[68:83], v[196:199], a[228:231], v[68:83]
    ds_read_b64_tr_b16 v[220:221], v33 offset:22528
    ds_read_b64_tr_b16 v[222:223], v33 offset:23552
    buffer_load_dwordx4 a[152:155], v8, s[36:39], s70 offen offset:2048 sc1
    s_waitcnt lgkmcnt(8)
    v_mfma_f32_32x32x16_bf16 v[36:51], v[200:203], a[228:231], v[36:51]
    buffer_load_dwordx4 a[156:159], v8, s[36:39], s70 offen offset:3072 sc1
    s_waitcnt lgkmcnt(6)
    v_mfma_f32_32x32x16_bf16 v[68:83], v[208:211], a[232:235], v[68:83]
    ds_read_b64_tr_b16 v[52:53], v7 offset:32768
    ds_read_b64_tr_b16 v[54:55], v7 offset:33792
    ds_read_b64_tr_b16 v[56:57], v33 offset:32768
    v_lshlrev_b32 v224, 16, v60
    v_and_b32 v225, 0xffff0000, v60
    v_lshlrev_b32 v226, 16, v61
    v_and_b32 v227, 0xffff0000, v61
    s_waitcnt lgkmcnt(7)
    v_mfma_f32_32x32x16_bf16 v[36:51], v[212:215], a[232:235], v[36:51]
    ds_read_b64_tr_b16 v[58:59], v33 offset:33792
    ds_read_b64_tr_b16 v[196:197], v7 offset:34816
    ds_read_b64_tr_b16 v[198:199], v7 offset:35840
    v_lshlrev_b32 v228, 16, v62
    v_and_b32 v229, 0xffff0000, v62
    v_lshlrev_b32 v230, 16, v63
    v_and_b32 v231, 0xffff0000, v63
    s_waitcnt lgkmcnt(8)
    v_mfma_f32_32x32x16_bf16 v[68:83], v[216:219], a[236:239], v[68:83]
    ds_read_b64_tr_b16 v[200:201], v33 offset:34816
    ds_read_b64_tr_b16 v[202:203], v33 offset:35840
    v_lshlrev_b32 v232, 16, v64
    v_and_b32 v233, 0xffff0000, v64
    v_lshlrev_b32 v234, 16, v65
    v_and_b32 v235, 0xffff0000, v65
    v_lshlrev_b32 v236, 16, v66
    s_waitcnt lgkmcnt(8)
    v_mfma_f32_32x32x16_bf16 v[36:51], v[220:223], a[236:239], v[36:51]
    v_and_b32 v237, 0xffff0000, v66
    v_lshlrev_b32 v238, 16, v67
    v_and_b32 v239, 0xffff0000, v67
    s_barrier
    s_waitcnt vmcnt(8) lgkmcnt(6)
    v_mfma_f32_32x32x16_bf16 v[68:83], v[52:55], a[240:243], v[68:83]
    ds_read_b64_tr_b16 v[208:209], v7 offset:36864
    ds_read_b64_tr_b16 v[210:211], v7 offset:37888
    ds_read_b64_tr_b16 v[212:213], v33 offset:36864
    s_waitcnt lgkmcnt(7)
    v_mfma_f32_32x32x16_bf16 v[36:51], v[56:59], a[240:243], v[36:51]
    ds_read_b64_tr_b16 v[214:215], v33 offset:37888
    ds_read_b64_tr_b16 v[216:217], v7 offset:38912
    ds_read_b64_tr_b16 v[218:219], v7 offset:39936
    s_waitcnt lgkmcnt(8)
    v_mfma_f32_32x32x16_bf16 v[68:83], v[196:199], a[244:247], v[68:83]
    ds_read_b64_tr_b16 v[220:221], v33 offset:38912
    ds_read_b64_tr_b16 v[222:223], v33 offset:39936
    v_add_u32 v7, 0x10000, v7
    v_add_u32 v33, 0x10000, v33
    s_waitcnt lgkmcnt(8)
    v_mfma_f32_32x32x16_bf16 v[36:51], v[200:203], a[244:247], v[36:51]
    s_waitcnt lgkmcnt(6)
    v_mfma_f32_32x32x16_bf16 v[68:83], v[208:211], a[248:251], v[68:83]
    ds_read_b64_tr_b16 v[52:53], v7
    ds_read_b64_tr_b16 v[54:55], v7 offset:1024
    ds_read_b64_tr_b16 v[56:57], v33
    s_waitcnt lgkmcnt(7)
    v_mfma_f32_32x32x16_bf16 v[36:51], v[212:215], a[248:251], v[36:51]
    ds_read_b64_tr_b16 v[58:59], v33 offset:1024
    ds_read_b64_tr_b16 v[196:197], v7 offset:2048
    ds_read_b64_tr_b16 v[198:199], v7 offset:3072
    s_waitcnt lgkmcnt(8)
    v_mfma_f32_32x32x16_bf16 v[68:83], v[216:219], a[252:255], v[68:83]
    ds_read_b64_tr_b16 v[200:201], v33 offset:2048
    ds_read_b64_tr_b16 v[202:203], v33 offset:3072
    s_waitcnt lgkmcnt(8)
    v_mfma_f32_32x32x16_bf16 v[36:51], v[220:223], a[252:255], v[36:51]
    s_barrier
    s_waitcnt vmcnt(4) lgkmcnt(6)
    v_mfma_f32_32x32x16_bf16 v[68:83], v[52:55], a[128:131], v[68:83]
    ds_read_b64_tr_b16 v[208:209], v7 offset:4096
    ds_read_b64_tr_b16 v[210:211], v7 offset:5120
    ds_read_b64_tr_b16 v[212:213], v33 offset:4096
    s_waitcnt lgkmcnt(7)
    v_mfma_f32_32x32x16_bf16 v[36:51], v[56:59], a[128:131], v[36:51]
    ds_read_b64_tr_b16 v[214:215], v33 offset:5120
    ds_read_b64_tr_b16 v[216:217], v7 offset:6144
    ds_read_b64_tr_b16 v[218:219], v7 offset:7168
    s_waitcnt lgkmcnt(8)
    v_mfma_f32_32x32x16_bf16 v[68:83], v[196:199], a[132:135], v[68:83]
    ds_read_b64_tr_b16 v[220:221], v33 offset:6144
    ds_read_b64_tr_b16 v[222:223], v33 offset:7168
    s_waitcnt lgkmcnt(8)
    v_mfma_f32_32x32x16_bf16 v[36:51], v[200:203], a[132:135], v[36:51]
    s_waitcnt lgkmcnt(6)
    v_mfma_f32_32x32x16_bf16 v[68:83], v[208:211], a[136:139], v[68:83]
    ds_read_b64_tr_b16 v[52:53], v7 offset:16384
    ds_read_b64_tr_b16 v[54:55], v7 offset:17408
    ds_read_b64_tr_b16 v[56:57], v33 offset:16384
    s_waitcnt lgkmcnt(7)
    v_mfma_f32_32x32x16_bf16 v[36:51], v[212:215], a[136:139], v[36:51]
    ds_read_b64_tr_b16 v[58:59], v33 offset:17408
    ds_read_b64_tr_b16 v[196:197], v7 offset:18432
    ds_read_b64_tr_b16 v[198:199], v7 offset:19456
    s_waitcnt lgkmcnt(8)
    v_mfma_f32_32x32x16_bf16 v[68:83], v[216:219], a[140:143], v[68:83]
    ds_read_b64_tr_b16 v[200:201], v33 offset:18432
    ds_read_b64_tr_b16 v[202:203], v33 offset:19456
    s_waitcnt lgkmcnt(8)
    v_mfma_f32_32x32x16_bf16 v[36:51], v[220:223], a[140:143], v[36:51]
    s_waitcnt vmcnt(0) lgkmcnt(6)
    v_mfma_f32_32x32x16_bf16 v[68:83], v[52:55], a[144:147], v[68:83]
    ds_read_b64_tr_b16 v[208:209], v7 offset:20480
    ds_read_b64_tr_b16 v[210:211], v7 offset:21504
    ds_read_b64_tr_b16 v[212:213], v33 offset:20480
    s_waitcnt lgkmcnt(7)
    v_mfma_f32_32x32x16_bf16 v[36:51], v[56:59], a[144:147], v[36:51]
    ds_read_b64_tr_b16 v[214:215], v33 offset:21504
    ds_read_b64_tr_b16 v[216:217], v7 offset:22528
    ds_read_b64_tr_b16 v[218:219], v7 offset:23552
    s_waitcnt lgkmcnt(8)
    v_mfma_f32_32x32x16_bf16 v[68:83], v[196:199], a[148:151], v[68:83]
    ds_read_b64_tr_b16 v[220:221], v33 offset:22528
    ds_read_b64_tr_b16 v[222:223], v33 offset:23552
    s_waitcnt lgkmcnt(8)
    v_mfma_f32_32x32x16_bf16 v[36:51], v[200:203], a[148:151], v[36:51]
    s_waitcnt lgkmcnt(6)
    v_mfma_f32_32x32x16_bf16 v[68:83], v[208:211], a[152:155], v[68:83]
    s_waitcnt lgkmcnt(4)
    v_mfma_f32_32x32x16_bf16 v[36:51], v[212:215], a[152:155], v[36:51]
    s_waitcnt lgkmcnt(2)
    v_mfma_f32_32x32x16_bf16 v[68:83], v[216:219], a[156:159], v[68:83]
    s_waitcnt lgkmcnt(0)
    v_mfma_f32_32x32x16_bf16 v[36:51], v[220:223], a[156:159], v[36:51]
    s_nop 9
    ds_write_b128 v84, v[68:71]
    ds_write_b128 v85, v[72:75]
    ds_write_b128 v86, v[76:79]
    ds_write_b128 v87, v[80:83]
    ds_write_b128 v88, v[36:39]
    ds_write_b128 v89, v[40:43]
    ds_write_b128 v90, v[44:47]
    ds_write_b128 v91, v[48:51]
    s_waitcnt lgkmcnt(0)
    s_barrier
    ds_read_b128 v[52:55], v92 offset:0
    ds_read_b128 v[208:211], v92 offset:16384
    ds_read_b128 v[56:59], v93 offset:0
    ds_read_b128 v[212:215], v93 offset:16384
    ds_read_b128 v[196:199], v92 offset:2048
    ds_read_b128 v[216:219], v92 offset:18432
    ds_read_b128 v[200:203], v93 offset:2048
    ds_read_b128 v[220:223], v93 offset:18432
    s_waitcnt lgkmcnt(4)
    v_pk_add_f32 v[52:53], v[52:53], v[208:209]
    v_pk_add_f32 v[54:55], v[54:55], v[210:211]
    v_pk_add_f32 v[56:57], v[56:57], v[212:213]
    v_pk_add_f32 v[58:59], v[58:59], v[214:215]
    v_pk_add_f32 v[52:53], v[52:53], v[224:225]
    v_pk_add_f32 v[54:55], v[54:55], v[226:227]
    v_pk_add_f32 v[56:57], v[56:57], v[228:229]
    v_pk_add_f32 v[58:59], v[58:59], v[230:231]
    v_cvt_pk_bf16_f32 v60, v52, v53
    v_cvt_pk_bf16_f32 v61, v54, v55
    v_cvt_pk_bf16_f32 v62, v56, v57
    v_cvt_pk_bf16_f32 v63, v58, v59
    buffer_store_dwordx4 v[60:63], v9, s[28:31], 0 offen sc1
    s_waitcnt lgkmcnt(0)
    v_pk_add_f32 v[196:197], v[196:197], v[216:217]
    v_pk_add_f32 v[198:199], v[198:199], v[218:219]
    v_pk_add_f32 v[200:201], v[200:201], v[220:221]
    v_pk_add_f32 v[202:203], v[202:203], v[222:223]
    v_pk_add_f32 v[196:197], v[196:197], v[232:233]
    v_pk_add_f32 v[198:199], v[198:199], v[234:235]
    v_pk_add_f32 v[200:201], v[200:201], v[236:237]
    v_pk_add_f32 v[202:203], v[202:203], v[238:239]
    v_cvt_pk_bf16_f32 v64, v196, v197
    v_cvt_pk_bf16_f32 v65, v198, v199
    v_cvt_pk_bf16_f32 v66, v200, v201
    v_cvt_pk_bf16_f32 v67, v202, v203
    buffer_store_dwordx4 v[64:67], v10, s[28:31], 0 offen sc1
    s_endpgm
L_nslow_1:
    s_mov_b32 s78, 131079
L_nslow_1_l:
    s_sleep 2
    buffer_load_dword v35, v60, s[32:35], 0 offen sc1
    s_waitcnt vmcnt(0)
    v_readfirstlane_b32 s66, v35
    s_nop 1
    s_cmp_lg_u32 s66, 0
    s_cbranch_scc1 L_nback_2
    s_sub_u32 s78, s78, 1
    s_cmp_lg_u32 s78, 0
    s_cbranch_scc1 L_nslow_1_l
    s_branch L_nback_2
L_slow_3:
    s_mov_b32 s78, 131079
    v_mov_b32 v59, 0
L_loop_5_l:
    s_and_b32 s100, s78, 7
    s_cbranch_scc1 L_loop_5_p
    buffer_store_dword v61, v62, s[36:39], 0 offen sc1
    s_movk_i32 s100, 0x1000
    buffer_load_dword v59, v56, s[36:39], s100 offen sc1
    s_waitcnt vmcnt(0)
    v_subrev_u32 v59, s66, v59
    v_cmp_gt_u32 vcc, 8, v59
    s_nop 1
    v_cndmask_b32 v59, 0, v59, vcc
L_loop_5_p:
    buffer_load_dword v57, v56, s[36:39], 0 offen sc1
    s_waitcnt vmcnt(0)
    v_subrev_u32 v57, s101, v57
    v_cmp_gt_u32 vcc, 8, v57
    s_nop 1
    v_cndmask_b32 v57, 0, v57, vcc
    v_max_u32 v57, v57, v59
    v_cmp_lt_u32 vcc, v57, v58
    s_nop 1
    s_cbranch_vccz L_back_4
    s_sub_u32 s78, s78, 1
    s_cmp_lg_u32 s78, 0
    s_cbranch_scc1 L_loop_5_l
    s_branch L_back_4
L_slow_6:
    s_mov_b32 s78, 131079
    v_mov_b32 v59, 0
L_loop_8_l:
    s_and_b32 s100, s78, 7
    s_cbranch_scc1 L_loop_8_p
    buffer_store_dword v61, v62, s[36:39], 0 offen sc1
    s_movk_i32 s100, 0x1000
    buffer_load_dword v59, v56, s[36:39], s100 offen sc1
    s_waitcnt vmcnt(0)
    v_subrev_u32 v59, s66, v59
    v_cmp_gt_u32 vcc, 8, v59
    s_nop 1
    v_cndmask_b32 v59, 0, v59, vcc
L_loop_8_p:
    buffer_load_dword v57, v56, s[36:39], 0 offen sc1
    s_waitcnt vmcnt(0)
    v_subrev_u32 v57, s101, v57
    v_cmp_gt_u32 vcc, 8, v57
    s_nop 1
    v_cndmask_b32 v57, 0, v57, vcc
    s_cmp_eq_u64 vcc, -1
    s_cselect_b32 s1, 1, s1
    v_max_u32 v57, v57, v59
    v_cmp_lt_u32 vcc, v57, v6
    s_nop 1
    s_cbranch_vccz L_back_7
    s_sub_u32 s78, s78, 1
    s_cmp_lg_u32 s78, 0
    s_cbranch_scc1 L_loop_8_l
    s_branch L_back_7
L_slow_9:
    s_mov_b32 s78, 131079
    v_mov_b32 v59, 0
L_loop_11_l:
    s_and_b32 s100, s78, 7
    s_cbranch_scc1 L_loop_11_p
    buffer_store_dword v61, v62, s[36:39], 0 offen sc1
    s_movk_i32 s100, 0x1000
    buffer_load_dword v59, v56, s[36:39], s100 offen sc1
    s_waitcnt vmcnt(0)
    v_subrev_u32 v59, s66, v59
    v_cmp_gt_u32 vcc, 8, v59
    s_nop 1
    v_cndmask_b32 v59, 0, v59, vcc
L_loop_11_p:
    buffer_load_dword v57, v56, s[36:39], 0 offen sc1
    s_waitcnt vmcnt(0)
    v_subrev_u32 v57, s101, v57
    v_cmp_gt_u32 vcc, 8, v57
    s_nop 1
    v_cndmask_b32 v57, 0, v57, vcc
    s_cmp_eq_u64 vcc, -1
    s_cselect_b32 s1, 1, s1
    v_max_u32 v57, v57, v59
    v_cmp_lt_u32 vcc, v57, v58
    s_nop 1
    s_cbranch_vccz L_back_10
    s_sub_u32 s78, s78, 1
    s_cmp_lg_u32 s78, 0
    s_cbranch_scc1 L_loop_11_l
    s_branch L_back_10
L_fq_12:
    buffer_store_dword v61, v62, s[36:39], 0 offen sc1
    s_branch L_fqb_13
L_fq_14:
    buffer_store_dword v61, v62, s[36:39], 0 offen sc1
    s_branch L_fqb_15
L_slow_16:
    s_mov_b32 s78, 131079
    v_mov_b32 v59, 0
L_loop_18_l:
    s_and_b32 s100, s78, 7
    s_cbranch_scc1 L_loop_18_p
    s_movk_i32 s100, 0x1000
    buffer_load_dword v59, v56, s[36:39], s100 offen sc1
    s_waitcnt vmcnt(0)
    v_subrev_u32 v59, s66, v59
    v_cmp_gt_u32 vcc, 8, v59
    s_nop 1
    v_cndmask_b32 v59, 0, v59, vcc
L_loop_18_p:
    buffer_load_dword v57, v56, s[36:39], 0 offen sc1
    s_waitcnt vmcnt(0)
    v_subrev_u32 v57, s101, v57
    v_cmp_gt_u32 vcc, 8, v57
    s_nop 1
    v_cndmask_b32 v57, 0, v57, vcc
    v_max_u32 v57, v57, v59
    v_cmp_lt_u32 vcc, v57, v11
    s_nop 1
    s_cbranch_vccz L_back_17
    s_sub_u32 s78, s78, 1
    s_cmp_lg_u32 s78, 0
    s_cbranch_scc1 L_loop_18_l
    s_branch L_back_17
L_fq_19:
    buffer_store_dword v61, v62, s[36:39], 0 offen sc1
    s_branch L_fqb_20
L_slow_21:
    s_mov_b32 s78, 131079
    v_mov_b32 v59, 0
L_loop_23_l:
    s_and_b32 s100, s78, 7
    s_cbranch_scc1 L_loop_23_p
    s_movk_i32 s100, 0x1000
    buffer_load_dword v59, v56, s[36:39], s100 offen sc1
    s_waitcnt vmcnt(0)
    v_subrev_u32 v59, s66, v59
    v_cmp_gt_u32 vcc, 8, v59
    s_nop 1
    v_cndmask_b32 v59, 0, v59, vcc
L_loop_23_p:
    buffer_load_dword v57, v56, s[36:39], 0 offen sc1
    s_waitcnt vmcnt(0)
    v_subrev_u32 v57, s101, v57
    v_cmp_gt_u32 vcc, 8, v57
    s_nop 1
    v_cndmask_b32 v57, 0, v57, vcc
    v_max_u32 v57, v57, v59
    v_cmp_lt_u32 vcc, v57, v12
    s_nop 1
    s_cbranch_vccz L_back_22
    s_sub_u32 s78, s78, 1
    s_cmp_lg_u32 s78, 0
    s_cbranch_scc1 L_loop_23_l
    s_branch L_back_22
L_pick:
    v_lshlrev_b32 v99, 7, v1
    s_mov_b32 s67, 0xf40000
    buffer_load_dwordx4 v[100:103], v2, s[36:39], s67 offen offset:0 sc1
    buffer_load_dwordx4 v[104:107], v2, s[36:39], s67 offen offset:1024 sc1
    buffer_load_dwordx4 v[108:111], v2, s[36:39], s67 offen offset:2048 sc1
    buffer_load_dwordx4 v[112:115], v2, s[36:39], s67 offen offset:3072 sc1
    s_mov_b32 s67, 0xf41000
    buffer_load_dwordx4 v[116:119], v2, s[36:39], s67 offen offset:0 sc1
    buffer_load_dwordx4 v[120:123], v2, s[36:39], s67 offen offset:1024 sc1
    buffer_load_dwordx4 v[124:127], v2, s[36:39], s67 offen offset:2048 sc1
    buffer_load_dwordx4 v[128:131], v2, s[36:39], s67 offen offset:3072 sc1
    s_mov_b32 s67, 0xf44000
    buffer_load_dword v132, v99, s[36:39], s67 offen sc1
    s_mov_b32 s67, 0xf46000
    buffer_load_dword v133, v99, s[36:39], s67 offen sc1
    v_mov_b32 v99, 0
    s_waitcnt lgkmcnt(0)
    s_waitcnt vmcnt(6)
    v_lshrrev_b32 v100, 7, v100
    v_lshrrev_b32 v101, 7, v101
    v_lshrrev_b32 v102, 7, v102
    v_lshrrev_b32 v103, 7, v103
    v_lshrrev_b32 v104, 7, v104
    v_lshrrev_b32 v105, 7, v105
    v_lshrrev_b32 v106, 7, v106
    v_lshrrev_b32 v107, 7, v107
    v_lshrrev_b32 v108, 7, v108
    v_lshrrev_b32 v109, 7, v109
    v_lshrrev_b32 v110, 7, v110
    v_lshrrev_b32 v111, 7, v111
    v_lshrrev_b32 v112, 7, v112
    v_lshrrev_b32 v113, 7, v113
    v_lshrrev_b32 v114, 7, v114
    v_lshrrev_b32 v115, 7, v115
    s_waitcnt vmcnt(2)
    v_lshrrev_b32 v116, 7, v116
    v_lshrrev_b32 v117, 7, v117
    v_lshrrev_b32 v118, 7, v118
    v_lshrrev_b32 v119, 7, v119
    v_lshrrev_b32 v120, 7, v120
    v_lshrrev_b32 v121, 7, v121
    v_lshrrev_b32 v122, 7, v122
    v_lshrrev_b32 v123, 7, v123
    v_lshrrev_b32 v124, 7, v124
    v_lshrrev_b32 v125, 7, v125
    v_lshrrev_b32 v126, 7, v126
    v_lshrrev_b32 v127, 7, v127
    v_lshrrev_b32 v128, 7, v128
    v_lshrrev_b32 v129, 7, v129
    v_lshrrev_b32 v130, 7, v130
    v_lshrrev_b32 v131, 7, v131
    s_waitcnt vmcnt(0)
    v_lshrrev_b32 v132, 7, v132
    v_lshrrev_b32 v133, 7, v133
    v_readfirstlane_b32 s67, v100
    s_nop 1
    s_and_b32 s67, s67, 0xffffff
L_pick_l:
    s_add_u32 s67, s67, 1
    v_xor_b32 v134, s67, v100
    v_xor_b32 v135, s67, v101
    v_xor_b32 v136, s67, v102
    v_min3_u32 v134, v134, v135, v136
    v_xor_b32 v135, s67, v103
    v_xor_b32 v136, s67, v104
    v_min3_u32 v134, v134, v135, v136
    v_xor_b32 v135, s67, v105
    v_xor_b32 v136, s67, v106
    v_min3_u32 v134, v134, v135, v136
    v_xor_b32 v135, s67, v107
    v_xor_b32 v136, s67, v108
    v_min3_u32 v134, v134, v135, v136
    v_xor_b32 v135, s67, v109
    v_xor_b32 v136, s67, v110
    v_min3_u32 v134, v134, v135, v136
    v_xor_b32 v135, s67, v111
    v_xor_b32 v136, s67, v112
    v_min3_u32 v134, v134, v135, v136
    v_xor_b32 v135, s67, v113
    v_xor_b32 v136, s67, v114
    v_min3_u32 v134, v134, v135, v136
    v_xor_b32 v135, s67, v115
    v_xor_b32 v136, s67, v116
    v_min3_u32 v134, v134, v135, v136
    v_xor_b32 v135, s67, v117
    v_xor_b32 v136, s67, v118
    v_min3_u32 v134, v134, v135, v136
    v_xor_b32 v135, s67, v119
    v_xor_b32 v136, s67, v120
    v_min3_u32 v134, v134, v135, v136
    v_xor_b32 v135, s67, v121
    v_xor_b32 v136, s67, v122
    v_min3_u32 v134, v134, v135, v136
    v_xor_b32 v135, s67, v123
    v_xor_b32 v136, s67, v124
    v_min3_u32 v134, v134, v135, v136
    v_xor_b32 v135, s67, v125
    v_xor_b32 v136, s67, v126
    v_min3_u32 v134, v134, v135, v136
    v_xor_b32 v135, s67, v127
    v_xor_b32 v136, s67, v128
    v_min3_u32 v134, v134, v135, v136
    v_xor_b32 v135, s67, v129
    v_xor_b32 v136, s67, v130
    v_min3_u32 v134, v134, v135, v136
    v_xor_b32 v135, s67, v131
    v_xor_b32 v136, s67, v132
    v_min3_u32 v134, v134, v135, v136
    v_xor_b32 v135, s67, v133
    v_min_u32 v134, v134, v135
    v_cmp_eq_u32 vcc, 0, v134
    s_nop 1
    s_cmp_lg_u64 vcc, 0
    s_cbranch_scc1 L_pick_l
    s_lshl_b32 s67, s67, 7
    v_mov_b32 v100, s67
    buffer_store_dword v100, v99, s[32:35], 0 offen sc1
    s_branch L_pick_back
L_nslow_25:
    s_mov_b32 s78, 131079
L_nslow_25_l:
    s_sleep 2
    buffer_load_dword v199, v30, s[32:35], 0 offen sc1
    s_waitcnt vmcnt(0)
    v_readfirstlane_b32 s66, v199
    s_nop 1
    s_cmp_lg_u32 s66, 0
    s_cbranch_scc1 L_nback_26
    s_sub_u32 s78, s78, 1
    s_cmp_lg_u32 s78, 0
    s_cbranch_scc1 L_nslow_25_l
    s_branch L_nback_26
L_slow_27:
    s_mov_b32 s78, 131079
    v_mov_b32 v29, 0
L_loop_29_l:
    s_and_b32 s100, s78, 7
    s_cbranch_scc1 L_loop_29_p
    s_movk_i32 s100, 0x1000
    buffer_load_dword v29, v22, s[36:39], s100 offen sc1
    s_waitcnt vmcnt(0)
    v_subrev_u32 v29, s66, v29
    v_cmp_gt_u32 vcc, 8, v29
    s_nop 1
    v_cndmask_b32 v29, 0, v29, vcc
L_loop_29_p:
    buffer_load_dword v23, v22, s[36:39], 0 offen sc1
    s_waitcnt vmcnt(0)
    v_subrev_u32 v23, s101, v23
    v_cmp_gt_u32 vcc, 8, v23
    s_nop 1
    v_cndmask_b32 v23, 0, v23, vcc
    s_cmp_eq_u64 vcc, -1
    s_cselect_b32 s1, 1, s1
    v_max_u32 v23, v23, v29
    v_cmp_lt_u32 vcc, v23, v28
    s_nop 1
    s_cbranch_vccz L_back_28
    s_sub_u32 s78, s78, 1
    s_cmp_lg_u32 s78, 0
    s_cbranch_scc1 L_loop_29_l
    s_branch L_back_28
L_slow_30:
    s_mov_b32 s78, 131079
    v_mov_b32 v29, 0
L_loop_32_l:
    s_and_b32 s100, s78, 7
    s_cbranch_scc1 L_loop_32_p
    s_movk_i32 s100, 0x1000
    buffer_load_dword v29, v22, s[36:39], s100 offen sc1
    s_waitcnt vmcnt(0)
    v_subrev_u32 v29, s66, v29
    v_cmp_gt_u32 vcc, 8, v29
    s_nop 1
    v_cndmask_b32 v29, 0, v29, vcc
L_loop_32_p:
    buffer_load_dword v23, v22, s[36:39], 0 offen sc1
    s_waitcnt vmcnt(0)
    v_subrev_u32 v23, s101, v23
    v_cmp_gt_u32 vcc, 8, v23
    s_nop 1
    v_cndmask_b32 v23, 0, v23, vcc
    s_cmp_eq_u64 vcc, -1
    s_cselect_b32 s1, 1, s1
    v_max_u32 v23, v23, v29
    v_cmp_lt_u32 vcc, v23, v28
    s_nop 1
    s_cbranch_vccz L_back_31
    s_sub_u32 s78, s78, 1
    s_cmp_lg_u32 s78, 0
    s_cbranch_scc1 L_loop_32_l
    s_branch L_back_31
L_slow_33:
    s_mov_b32 s78, 131079
L_loop_35_l:
    s_sleep 4
    buffer_load_dword v223, v206, s[36:39], 0 offen sc1
    s_waitcnt vmcnt(0)
    v_subrev_u32 v223, s66, v223
    v_cmp_gt_u32 vcc, 8, v223
    s_nop 1
    v_cndmask_b32 v223, 0, v223, vcc
    v_cmp_lt_u32 vcc, v223, v15
    s_nop 1
    s_cbranch_vccz L_back_34
    s_sub_u32 s78, s78, 1
    s_cmp_lg_u32 s78, 0
    s_cbranch_scc1 L_loop_35_l
    s_branch L_back_34
L_fq_36:
    buffer_store_dword v31, v32, s[36:39], 0 offen sc1
    s_branch L_fqb_37
L_slow_38:
    s_mov_b32 s78, 131079
L_loop_40_l:
    s_sleep 4
    buffer_load_dword v223, v206, s[36:39], 0 offen sc1
    s_waitcnt vmcnt(0)
    v_subrev_u32 v223, s66, v223
    v_cmp_gt_u32 vcc, 8, v223
    s_nop 1
    v_cndmask_b32 v223, 0, v223, vcc
    v_cmp_lt_u32 vcc, v223, v20
    s_nop 1
    s_cbranch_vccz L_back_39
    s_sub_u32 s78, s78, 1
    s_cmp_lg_u32 s78, 0
    s_cbranch_scc1 L_loop_40_l
    s_branch L_back_39
L_slow_41:
    s_mov_b32 s78, 131079
    v_mov_b32 v29, 0
L_loop_43_l:
    s_and_b32 s100, s78, 7
    s_cbranch_scc1 L_loop_43_p
    s_movk_i32 s100, 0x1000
    buffer_load_dword v29, v22, s[36:39], s100 offen sc1
    s_waitcnt vmcnt(0)
    v_subrev_u32 v29, s66, v29
    v_cmp_gt_u32 vcc, 8, v29
    s_nop 1
    v_cndmask_b32 v29, 0, v29, vcc
L_loop_43_p:
    buffer_load_dword v23, v22, s[36:39], 0 offen sc1
    s_waitcnt vmcnt(0)
    v_subrev_u32 v23, s101, v23
    v_cmp_gt_u32 vcc, 8, v23
    s_nop 1
    v_cndmask_b32 v23, 0, v23, vcc
    v_max_u32 v23, v23, v29
    v_cmp_lt_u32 vcc, v23, v11
    s_nop 1
    s_cbranch_vccz L_back_42
    s_sub_u32 s78, s78, 1
    s_cmp_lg_u32 s78, 0
    s_cbranch_scc1 L_loop_43_l
    s_branch L_back_42
L_fq_44:
    buffer_store_dword v31, v32, s[36:39], 0 offen sc1
    s_branch L_fqb_45
L_slow_46:
    s_mov_b32 s78, 131079
    v_mov_b32 v29, 0
L_loop_48_l:
    s_and_b32 s100, s78, 7
    s_cbranch_scc1 L_loop_48_p
    s_movk_i32 s100, 0x1000
    buffer_load_dword v29, v22, s[36:39], s100 offen sc1
    s_waitcnt vmcnt(0)
    v_subrev_u32 v29, s66, v29
    v_cmp_gt_u32 vcc, 8, v29
    s_nop 1
    v_cndmask_b32 v29, 0, v29, vcc
L_loop_48_p:
    buffer_load_dword v23, v22, s[36:39], 0 offen sc1
    s_waitcnt vmcnt(0)
    v_subrev_u32 v23, s101, v23
    v_cmp_gt_u32 vcc, 8, v23
    s_nop 1
    v_cndmask_b32 v23, 0, v23, vcc
    v_max_u32 v23, v23, v29
    v_cmp_lt_u32 vcc, v23, v12
    s_nop 1
    s_cbranch_vccz L_back_47
    s_sub_u32 s78, s78, 1
    s_cmp_lg_u32 s78, 0
    s_cbranch_scc1 L_loop_48_l
    s_branch L_back_47
L_exit:
    s_endpgm
L_code_end:
.section .rodata,"a"
.p2align 6
.amdhsa_kernel parallel_sum__linear_attn_block__mixer_s_mlp__prompt_kernel
  .amdhsa_next_free_vgpr 512
  .amdhsa_next_free_sgpr 102
  .amdhsa_accum_offset 256
  .amdhsa_group_segment_fixed_size 0
  .amdhsa_kernarg_size 88
  .amdhsa_user_sgpr_count 2
  .amdhsa_user_sgpr_kernarg_segment_ptr 1
  .amdhsa_system_sgpr_workgroup_id_x 1
.end_amdhsa_kernel
```
